```python
import torch

def _softmax(x, axis=-1):
    return torch.softmax(x, dim=axis)
def _gelu(x):
    return torch.nn.functional.gelu(x, approximate="tanh")
def _silu(x):
    return torch.nn.functional.silu(x)
def _sigmoid(x):
    return torch.sigmoid(x)
def _layernorm(x, axis=-1, eps=1e-5):
    m = x.mean(dim=axis, keepdim=True)
    v = x.var(dim=axis, keepdim=True, unbiased=False)
    return (x - m) / torch.sqrt(v + eps)
def _scatter_add(tgt, idx, src, axis=0):
    return tgt.clone().index_add_(axis, idx, src)
def _segment_sum(src, seg, n):
    out = torch.zeros((n,) + src.shape[1:], dtype=src.dtype)
    return out.index_add_(0, seg, src)
def _pad(x, pw):
    flat = tuple(v for pair in reversed(pw) for v in pair)
    return torch.nn.functional.pad(x, flat)

kernel_name = 'recurrent_scan__ssm_conv_s4__mixer_s_mlp__prompt'

def setup_inputs():

    _w = (lambda a: (lambda t: t.to(torch.bfloat16) if t.is_floating_point() else t)(torch.as_tensor(a)))
    def _A_setup():
        B, L, D, N = 1, 2048, 640, 192
        A_re = -(lambda _x: torch.exp(torch.as_tensor(_x)))((lambda *s: torch.randn(*s, dtype=torch.bfloat16) * 3.2)(D, N))
        A_im = torch.pi * (lambda *s: torch.randn(*s, dtype=torch.bfloat16) * 0.05)(D, N)
        B_re = (lambda *s: torch.randn(*s, dtype=torch.bfloat16) * 0.1)(D, N)
        B_im = (lambda *s: torch.randn(*s, dtype=torch.bfloat16) * 0.1)(D, N)
        C_re = (lambda *s: torch.randn(*s, dtype=torch.bfloat16) * 0.1)(D, N)
        C_im = (lambda *s: torch.randn(*s, dtype=torch.bfloat16) * 0.1)(D, N)
        log_dt = (lambda *s: torch.randn(*s, dtype=torch.bfloat16) * 0.05)(D) * 0.5 - 4.0
        Dskip = (lambda *s: torch.randn(*s, dtype=torch.bfloat16) * 0.05)(D)
        return {
            "u": _w((lambda *s: torch.randn(*s, dtype=torch.bfloat16) * 0.05)(B, L, D)),
            "A_re": _w(A_re),
            "A_im": _w(A_im),
            "B_re": _w(B_re),
            "B_im": _w(B_im),
            "C_re": _w(C_re),
            "C_im": _w(C_im),
            "log_dt": _w(log_dt),
            "Dskip": _w(Dskip),
        }
    _A_in = _A_setup()

    def _B_setup():
        B, S, D, F = 1, 2048, 640, 1536
        return {
            "x":  _w((lambda *s: torch.randn(*s, dtype=torch.bfloat16) * 0.05)(B, S, D)),
            "w1": _w((lambda *s: torch.randn(*s, dtype=torch.bfloat16) * 3.2)(D, D) * (D ** -0.5)),
            "w2": _w((lambda *s: torch.randn(*s, dtype=torch.bfloat16) * 3.2)(D, D) * (D ** -0.5)),
            "w3": _w((lambda *s: torch.randn(*s, dtype=torch.bfloat16) * 3.2)(D, F) * (D ** -0.5)),
            "w4": _w((lambda *s: torch.randn(*s, dtype=torch.bfloat16) * 3.2)(F, D) * (F ** -0.5)),
        }
    _B_in = _B_setup()

    return {
        "A_u": _A_in["u"],
        "A_A_re": _A_in["A_re"],
        "A_A_im": _A_in["A_im"],
        "A_B_re": _A_in["B_re"],
        "A_B_im": _A_in["B_im"],
        "A_C_re": _A_in["C_re"],
        "A_C_im": _A_in["C_im"],
        "A_log_dt": _A_in["log_dt"],
        "A_Dskip": _A_in["Dskip"],
        "B_x": _B_in["x"],
        "B_w1": _B_in["w1"],
        "B_w2": _B_in["w2"],
        "B_w3": _B_in["w3"],
        "B_w4": _B_in["w4"],
    }

def reference(A_u, A_A_re, A_A_im, A_B_re, A_B_im, A_C_re, A_C_im, A_log_dt, A_Dskip, B_x, B_w1, B_w2, B_w3, B_w4):
    def _A_ref(u, A_re, A_im, B_re, B_im, C_re, C_im, log_dt, Dskip):
        Bsz, L, D = u.shape
        dt = torch.exp(log_dt)[:, None]
        A = A_re + 1j * A_im
        Bc = B_re + 1j * B_im
        Cc = C_re + 1j * C_im
        logdA = dt * A
        dB = dt * Bc
        l = (lambda x, dt: x.to(dt))(torch.arange(L), A_re.dtype)
        P = torch.exp(logdA[:, :, None] * l[None, None, :])
        K = torch.einsum("dn,dnl,dn->dl", Cc, P, dB).real
        L2 = 2 * L
        Kp = _pad(K, ((0, 0), (0, L)))
        up = (lambda x, *d: x.permute(*d))(u, 0, 2, 1)
        up = _pad(up, ((0, 0), (0, 0), (0, L)))
        Kf = (lambda x, axes=(-2,-1): torch.fft.rfft2(x.float(), dim=axes))(Kp[:, None, :], axes=(-2, -1))
        Uf = (lambda x, axes=(-2,-1): torch.fft.rfft2(x.float(), dim=axes))(up[:, :, None, :], axes=(-2, -1))
        Yf = Uf * Kf[None, :, :, :]
        y = (lambda x, s, axes=(-2,-1): torch.fft.irfft2(x, s=s, dim=axes).to(torch.bfloat16))(Yf, (1, L2), axes=(-2, -1))[:, :, 0, :L]
        y = (lambda x, *d: x.permute(*d))(y, 0, 2, 1) + u * Dskip[None, None, :]
        return y

    def _B_ref(x, w1, w2, w3, w4):
        B, S, D = x.shape
        h = _gelu(_layernorm(x, axis=-1) @ w1)
        c = D // 4
        g0 = _pad(h[:, :, 0*c:1*c], ((0, 0), (1, 0), (0, 0)))[:, :S, :]
        g1 = _pad(h[:, :, 1*c:2*c], ((0, 0), (0, 1), (0, 0)))[:, 1:, :]
        g2 = _pad(h[:, :, 2*c:3*c], ((0, 0), (2, 0), (0, 0)))[:, :S, :]
        g3 = _pad(h[:, :, 3*c:   ], ((0, 0), (0, 2), (0, 0)))[:, 2:, :]
        hs = torch.concatenate([g0, g1, g2, g3], axis=-1) @ w2
        x1 = x + hs
        h2 = _gelu(_layernorm(x1, axis=-1) @ w3) @ w4
        return x1 + h2

    x = A_u
    xn = _layernorm(x, axis=-1)
    s = _A_ref(xn, A_A_re, A_A_im, A_B_re, A_B_im, A_C_re, A_C_im, A_log_dt, A_Dskip)
    g = _silu(_B_ref(xn, B_w1, B_w2, B_w3, B_w4))
    return x + s * g
```

```asm
; @launch grid=(512,1,1) block=(256,1,1) lds=81920
.amdgcn_target "amdgcn-amd-amdhsa--gfx950"
.text
.globl recurrent_scan__ssm_conv_s4__mixer_s_mlp__prompt_kernel
.p2align 8
.type recurrent_scan__ssm_conv_s4__mixer_s_mlp__prompt_kernel,@function
recurrent_scan__ssm_conv_s4__mixer_s_mlp__prompt_kernel:
    s_cmp_ge_u32 s2, 512
    s_cbranch_scc1 L_end
    s_cmp_ge_u32 s2, 256
    s_cbranch_scc1 L_ssm
    s_load_dwordx2 s[4:5], s[0:1], 0
    s_load_dwordx2 s[8:9], s[0:1], 80
    s_load_dwordx2 s[24:25], s[0:1], 128
    s_load_dwordx2 s[32:33], s[0:1], 120
    s_load_dwordx2 s[12:13], s[0:1], 88
    s_load_dwordx2 s[16:17], s[0:1], 96
    s_load_dwordx2 s[20:21], s[0:1], 104
    s_load_dwordx2 s[28:29], s[0:1], 112
    s_setprio 2
    v_lshrrev_b32 v1, 6, v0
    v_and_b32 v0, 63, v0
    s_and_b32 s46, s2, 7
    v_readfirstlane_b32 s36, v1
    s_lshr_b32 s47, s2, 3
    s_mul_i32 s48, s47, 52
    s_lshr_b32 s57, s48, 8
    s_mul_i32 s49, s57, 5
    s_sub_u32 s40, s47, s49
    s_bitcmp1_b32 s2, 0
    s_cselect_b32 s49, 5, 0
    s_add_u32 s40, s40, s49
    s_lshl_b32 s48, s57, 2
    s_lshr_b32 s49, s46, 1
    s_add_u32 s39, s48, s49
    s_sub_u32 s48, s57, 3
    s_cselect_b32 s57, s57, s48
    s_mul_i32 s41, s39, 96
    s_lshl_b32 s42, s40, 6
    s_lshr_b32 s37, s36, 1
    s_and_b32 s38, s36, 1
    s_lshl_b32 s52, s36, 11
    s_mul_i32 s53, s36, 3072
    s_mov_b32 s6, 0x280000
    s_mov_b32 s7, 0x20000
    s_mov_b32 s10, 0xc8000
    s_mov_b32 s11, 0x20000
    v_and_b32 v1, 15, v0
    v_lshrrev_b32 v32, 4, v0
    s_cmp_ge_u32 s39, 22
    s_cbranch_scc1 L_p3only
    v_lshrrev_b32 v48, 3, v0
    s_mul_i32 s48, s36, 24
    s_add_u32 s48, s48, s41
    v_add_u32 v48, s48, v48
    v_mul_u32_u24 v48, 1280, v48
    v_and_b32 v49, 7, v0
    s_lshl_b32 s48, s36, 2
    v_add_u32 v50, s48, v32
    v_add_u32 v51, 0, v50
    v_and_b32 v51, 7, v51
    v_xor_b32 v51, v51, v49
    v_lshl_add_u32 v45, v51, 4, v48
    v_add_u32 v51, 4, v50
    v_and_b32 v51, 7, v51
    v_xor_b32_e64 v51, v51, v49
    v_lshl_add_u32 v46, v51, 4, v48
    v_add_u32 v46, 9216, v46
    v_add_u32 v51, 8, v50
    v_and_b32 v51, 7, v51
    v_xor_b32_e64 v51, v51, v49
    v_lshl_add_u32 v47, v51, 4, v48
    v_add_u32 v47, 18432, v47
    v_lshrrev_b32 v48, 3, v0
    s_lshl_b32 s48, s36, 4
    v_add_u32_e64 v48, s48, v48
    v_mul_u32_u24 v48, 1280, v48
    s_lshl_b32 s48, s42, 1
    v_add_u32 v48, s48, v48
    v_and_b32 v50, 1, v32
    v_lshlrev_b32 v50, 1, v50
    v_xor_b32_e64 v50, v50, v49
    v_lshl_add_u32 v26, v50, 4, v48
    v_xor_b32_e64 v50, 4, v50
    v_lshl_add_u32 v27, v50, 4, v48
    v_add_u32 v27, 9216, v27
    s_mul_i32 s49, s57, 3
    s_add_u32 s49, s49, s40
    s_sub_u32 s48, s49, 10
    s_cselect_b32 s49, s49, s48
    s_waitcnt lgkmcnt(0)
    s_lshl_b32 s54, s49, 7
    s_mul_i32 s55, s49, 81920
    s_add_u32 m0, s53, 0
    s_nop 0
    buffer_load_dwordx4 v45, s[4:7], s54 offen offset:0 lds
    buffer_load_dwordx4 v46, s[4:7], s54 offen offset:1024 lds
    buffer_load_dwordx4 v47, s[4:7], s54 offen offset:2048 lds
    s_add_u32 m0, s52, 12288
    s_add_u32 s54, s54, 128
    buffer_load_dwordx4 v26, s[8:11], s55 offen offset:0 lds
    buffer_load_dwordx4 v27, s[8:11], s55 offen offset:1024 lds
    s_add_u32 s55, s55, 81920
    s_cmp_eq_u32 s54, 1280
    s_cselect_b32 s54, 0, s54
    s_cselect_b32 s55, 0, s55
    s_add_u32 m0, s53, 20480
    s_nop 0
    s_nop 0
    buffer_load_dwordx4 v45, s[4:7], s54 offen offset:0 lds
    buffer_load_dwordx4 v46, s[4:7], s54 offen offset:1024 lds
    buffer_load_dwordx4 v47, s[4:7], s54 offen offset:2048 lds
    s_add_u32 m0, s52, 32768
    s_add_u32 s54, s54, 128
    buffer_load_dwordx4 v26, s[8:11], s55 offen offset:0 lds
    buffer_load_dwordx4 v27, s[8:11], s55 offen offset:1024 lds
    s_add_u32 s55, s55, 81920
    s_cmp_eq_u32 s54, 1280
    s_cselect_b32 s54, 0, s54
    s_cselect_b32 s55, 0, s55
    s_mov_b32 s26, 0x10000000
    s_mov_b32 s27, 0x20000
    s_mov_b32 s34, 0x100
    s_mov_b32 s35, 0x20000
    s_mov_b32 s14, 0xc8000
    s_mov_b32 s15, 0x20000
    s_mov_b32 s18, 0x1e0000
    s_mov_b32 s19, 0x20000
    s_mov_b32 s22, 0x1e0000
    s_mov_b32 s23, 0x20000
    s_mov_b32 s30, 0x280000
    s_mov_b32 s31, 0x20000
    s_lshr_b32 s48, s47, 3
    s_lshr_b32 s43, s46, 1
    s_lshl_b32 s43, s43, 2
    s_add_u32 s43, s43, s48
    s_and_b32 s44, s47, 7
    s_and_b32 s48, s46, 1
    s_lshl_b32 s48, s48, 3
    s_add_u32 s44, s44, s48
    v_mov_b32 v28, 0xc0135761
    v_mov_b32 v29, 0xc0135761
    s_mov_b32 s66, 0xbdd2d3e8
    s_mov_b32 s67, 0xbdd2d3e8
    s_xor_b32 s50, s37, s38
    s_mul_i32 s48, s37, 48
    v_add_u32 v48, s48, v1
    v_lshlrev_b32 v48, 7, v48
    v_lshrrev_b32 v49, 1, v1
    s_lshl_b32 s48, s50, 2
    v_add_u32 v50, s48, v32
    v_xor_b32 v50, v50, v49
    v_lshl_add_u32 v52, v50, 4, v48
    v_add_u32 v53, 4096, v52
    v_xor_b32_e64 v54, 64, v52
    v_add_u32 v55, 4096, v54
    s_lshl_b32 s48, s38, 2
    s_add_u32 s48, s48, 0
    v_lshrrev_b32 v50, 1, v32
    v_add_u32 v50, s48, v50
    v_xor_b32_e64 v50, v50, v49
    v_lshl_add_u32 v60, v50, 4, v48
    v_and_b32_e64 v50, 1, v32
    v_lshl_add_u32 v60, v50, 3, v60
    s_lshl_b32 s48, s38, 2
    s_add_u32 s48, s48, 2
    v_lshrrev_b32 v50, 1, v32
    v_add_u32 v50, s48, v50
    v_xor_b32_e64 v50, v50, v49
    v_lshl_add_u32 v61, v50, 4, v48
    v_and_b32_e64 v50, 1, v32
    v_lshl_add_u32 v61, v50, 3, v61
    v_bfe_u32 v48, v0, 2, 2
    v_lshl_add_u32 v49, v32, 3, v48
    v_lshlrev_b32 v49, 7, v49
    v_and_b32 v50, 1, v0
    v_lshl_add_u32 v49, v50, 3, v49
    v_and_b32 v48, 2, v48
    v_and_b32 v50, 1, v32
    v_lshl_add_u32 v48, v50, 2, v48
    v_bfe_u32 v50, v0, 1, 1
    v_xor_b32 v48, v48, v50
    v_mov_b32 v62, v49
    v_mov_b32 v63, v48
    s_lshl_b32 s48, s38, 2
    s_add_u32 s48, s48, 0
    v_xor_b32 v50, s48, v48
    v_lshl_add_u32 v50, v50, 4, v49
    s_lshl_b32 s48, s50, 12
    s_add_u32 s51, s48, 12288
    v_add_u32 v56, s51, v50
    s_xor_b32 s48, s48, 4096
    s_add_u32 s51, s48, 12288
    v_add_u32 v58, s51, v50
    s_lshl_b32 s48, s38, 2
    s_add_u32 s48, s48, 2
    v_xor_b32 v50, s48, v48
    v_lshl_add_u32 v50, v50, 4, v49
    s_lshl_b32 s48, s50, 12
    s_add_u32 s51, s48, 12288
    v_add_u32 v57, s51, v50
    s_xor_b32 s48, s48, 4096
    s_add_u32 s51, s48, 12288
    v_add_u32 v59, s51, v50
    s_lshl_b32 s48, s40, 2
    s_lshl_b32 s51, s38, 1
    s_add_u32 s48, s48, s51
    v_and_b32 v48, 1, v32
    v_add_u32 v48, s48, v48
    v_mul_u32_u24 v48, 67840, v48
    v_lshrrev_b32_e64 v50, 1, v32
    v_lshl_add_u32 v48, v50, 4, v48
    s_mul_i32 s51, s37, 48
    s_add_u32 s51, s51, s41
    v_add_u32_e64 v49, s51, v1
    v_lshl_add_u32 v48, v49, 5, v48
    v_add_u32 v66, 7340160, v48
    s_mov_b32 s51, 1048704
    s_cmp_ge_u32 s48, 20
    s_cselect_b32 s51, 1048768, s51
    s_cmp_ge_u32 s48, 30
    s_cselect_b32 s51, 1048640, s51
    v_add_u32_e64 v64, s51, v48
    v_mov_b32 v51, 0x7ffffff0
    v_bfe_u32 v48, v0, 3, 1
    v_add_u32_e64 v48, s48, v48
    v_mul_u32_u24 v48, 67840, v48
    v_and_b32_e64 v50, 7, v0
    v_lshl_add_u32 v48, v50, 4, v48
    s_mov_b32 vcc_lo, 0
    s_mov_b32 s51, 1048576
    s_cmp_lt_u32 s48, 10
    s_cselect_b32 vcc_lo, 0xffff, vcc_lo
    s_sub_u32 s48, s48, 20
    s_cmp_lt_u32 s48, 10
    s_cselect_b32 vcc_lo, 0x0f0f, vcc_lo
    s_cselect_b32 s51, 1048704, s51
    s_add_u32 s48, s39, s37
    s_cmp_eq_u32 s48, 0
    s_cselect_b32 vcc_lo, vcc_lo, 0
    s_mov_b32 vcc_hi, 0
    v_add_u32 v48, s51, v48
    v_cndmask_b32 v65, v51, v48, vcc
    s_add_u32 s48, s52, 65536
    v_lshl_add_u32 v48, v1, 6, s48
    v_lshrrev_b32 v49, 1, v1
    v_xor_b32 v50, v32, v49
    v_lshl_add_u32 v67, v50, 3, v48
    v_xor_b32 v68, 32, v67
    v_lshrrev_b32 v48, 2, v0
    v_lshl_add_u32 v50, v48, 6, s48
    v_lshrrev_b32 v48, 1, v48
    v_and_b32 v49, 3, v0
    v_xor_b32_e64 v48, v48, v49
    v_lshl_add_u32 v69, v48, 3, v50
    v_xor_b32 v70, 32, v69
    s_mul_i32 s48, s39, 6
    s_mul_i32 s51, s37, 3
    s_add_u32 s48, s48, s51
    s_mul_i32 s48, s48, 20480
    s_lshl_b32 s51, s38, 5
    s_add_u32 s51, s51, s42
    s_lshl_b32 s51, s51, 5
    s_add_u32 s48, s48, s51
    v_and_b32_e64 v48, 31, v0
    v_lshl_add_u32 v48, v48, 5, s48
    v_lshrrev_b32_e64 v49, 5, v0
    v_lshl_add_u32 v71, v49, 4, v48
    v_lshrrev_b32_e64 v48, 2, v1
    v_cmp_eq_u32 s[60:61], v48, v32
    v_cmp_eq_u32 s[62:63], 0, v1
    v_mov_b32 v72, 0x3f803f80
    v_mov_b32 v73, 0x3f803f80
    v_mov_b32 v74, 0x3f803f80
    v_mov_b32 v75, 0x3f803f80
    s_mul_i32 s48, s39, 10
    s_add_u32 s48, s48, s40
    s_lshl_b32 s48, s48, 2
    s_add_u32 s48, s48, s36
    s_lshl_b32 s51, s48, 10
    v_lshl_add_u32 v48, v0, 7, s51
    v_cmp_gt_u32 vcc, 8, v0
    s_mul_i32 s51, s48, 2304
    v_lshl_add_u32 v49, v0, 7, s51
    v_cndmask_b32 v172, v51, v48, vcc
    v_cmp_gt_u32 vcc, 18, v0
    s_nop 1
    v_cndmask_b32 v173, v51, v49, vcc
    s_add_u32 m0, s53, 40960
    s_nop 0
    s_nop 0
    buffer_load_dwordx4 v45, s[4:7], s54 offen offset:0 lds
    buffer_load_dwordx4 v46, s[4:7], s54 offen offset:1024 lds
    buffer_load_dwordx4 v47, s[4:7], s54 offen offset:2048 lds
    s_add_u32 m0, s52, 53248
    s_add_u32 s54, s54, 128
    buffer_load_dwordx4 v26, s[8:11], s55 offen offset:0 lds
    buffer_load_dwordx4 v27, s[8:11], s55 offen offset:1024 lds
    s_add_u32 s55, s55, 81920
    s_cmp_eq_u32 s54, 1280
    s_cselect_b32 s54, 0, s54
    s_cselect_b32 s55, 0, s55
    s_waitcnt vmcnt(10)
    s_barrier
    ds_read_b64_tr_b16 v[144:145], v56 offset:0
    ds_read_b64_tr_b16 v[146:147], v56 offset:512
    ds_read_b128 v[132:135], v52 offset:0
    ds_read_b64_tr_b16 v[148:149], v57 offset:0
    ds_read_b64_tr_b16 v[150:151], v57 offset:512
    ds_read_b128 v[136:139], v52 offset:2048
    ds_read_b128 v[140:143], v53 offset:0
    s_cmp_lg_u32 s57, 0
    s_cbranch_scc1 L_ownx_1
    v_add_u32 v60, 0, v60
    v_add_u32 v61, 0, v61
    ds_read_b64 v[2:3], v60 offset:0
    ds_read_b64 v[4:5], v61 offset:0
    ds_read_b64 v[6:7], v60 offset:2048
    ds_read_b64 v[8:9], v61 offset:2048
    ds_read_b64 v[10:11], v60 offset:4096
    ds_read_b64 v[12:13], v61 offset:4096
    s_waitcnt lgkmcnt(0)
L_ownx_1:
    s_waitcnt lgkmcnt(0)
    v_mfma_f32_16x16x32_bf16 v[76:79], v[144:147], v[132:135], 0
    ds_read_b64_tr_b16 v[164:165], v58 offset:0
    v_mfma_f32_16x16x32_bf16 v[80:83], v[148:151], v[132:135], 0
    ds_read_b64_tr_b16 v[166:167], v58 offset:512
    v_mfma_f32_16x16x32_bf16 v[84:87], v[144:147], v[136:139], 0
    ds_read_b128 v[152:155], v54 offset:0
    v_mfma_f32_16x16x32_bf16 v[88:91], v[148:151], v[136:139], 0
    ds_read_b64_tr_b16 v[168:169], v59 offset:0
    v_mfma_f32_16x16x32_bf16 v[92:95], v[144:147], v[140:143], 0
    ds_read_b64_tr_b16 v[170:171], v59 offset:512
    v_mfma_f32_16x16x32_bf16 v[96:99], v[148:151], v[140:143], 0
    ds_read_b128 v[156:159], v54 offset:2048
    v_mfma_f32_16x16x32_bf16 v[100:103], v[72:75], v[132:135], 0
    ds_read_b128 v[160:163], v55 offset:0
    v_mfma_f32_16x16x32_bf16 v[104:107], v[72:75], v[136:139], 0
    v_mfma_f32_16x16x32_bf16 v[108:111], v[72:75], v[140:143], 0
    v_mfma_f32_16x16x32_bf16 v[112:115], v[132:135], v[132:135], 0
    v_mfma_f32_16x16x32_bf16 v[116:119], v[136:139], v[136:139], 0
    v_mfma_f32_16x16x32_bf16 v[120:123], v[140:143], v[140:143], 0
    v_mfma_f32_16x16x32_bf16 v[124:127], v[144:147], v[72:75], 0
    v_mfma_f32_16x16x32_bf16 v[128:131], v[148:151], v[72:75], 0
    s_waitcnt lgkmcnt(0)
    s_waitcnt vmcnt(5)
    s_barrier
    s_nop 0
    v_mfma_f32_16x16x32_bf16 v[76:79], v[164:167], v[152:155], v[76:79]
    ds_read_b64_tr_b16 v[144:145], v56 offset:20480
    ds_read_b64_tr_b16 v[146:147], v56 offset:20992
    v_mfma_f32_16x16x32_bf16 v[80:83], v[168:171], v[152:155], v[80:83]
    ds_read_b128 v[132:135], v52 offset:20480
    ds_read_b64_tr_b16 v[148:149], v57 offset:20480
    v_mfma_f32_16x16x32_bf16 v[84:87], v[164:167], v[156:159], v[84:87]
    ds_read_b64_tr_b16 v[150:151], v57 offset:20992
    ds_read_b128 v[136:139], v52 offset:22528
    v_mfma_f32_16x16x32_bf16 v[88:91], v[168:171], v[156:159], v[88:91]
    ds_read_b128 v[140:143], v53 offset:20480
    v_mfma_f32_16x16x32_bf16 v[92:95], v[164:167], v[160:163], v[92:95]
    v_mfma_f32_16x16x32_bf16 v[96:99], v[168:171], v[160:163], v[96:99]
    s_waitcnt lgkmcnt(0)
    s_nop 0
    v_mfma_f32_16x16x32_bf16 v[76:79], v[144:147], v[132:135], v[76:79]
    ds_read_b64_tr_b16 v[164:165], v58 offset:20480
    v_mfma_f32_16x16x32_bf16 v[80:83], v[148:151], v[132:135], v[80:83]
    ds_read_b64_tr_b16 v[166:167], v58 offset:20992
    v_mfma_f32_16x16x32_bf16 v[84:87], v[144:147], v[136:139], v[84:87]
    ds_read_b128 v[152:155], v54 offset:20480
    v_mfma_f32_16x16x32_bf16 v[88:91], v[148:151], v[136:139], v[88:91]
    ds_read_b64_tr_b16 v[168:169], v59 offset:20480
    v_mfma_f32_16x16x32_bf16 v[92:95], v[144:147], v[140:143], v[92:95]
    ds_read_b64_tr_b16 v[170:171], v59 offset:20992
    v_mfma_f32_16x16x32_bf16 v[96:99], v[148:151], v[140:143], v[96:99]
    ds_read_b128 v[156:159], v54 offset:22528
    v_mfma_f32_16x16x32_bf16 v[100:103], v[72:75], v[132:135], v[100:103]
    ds_read_b128 v[160:163], v55 offset:20480
    v_mfma_f32_16x16x32_bf16 v[104:107], v[72:75], v[136:139], v[104:107]
    s_add_u32 m0, s53, 61440
    v_mfma_f32_16x16x32_bf16 v[108:111], v[72:75], v[140:143], v[108:111]
    buffer_load_dwordx4 v45, s[4:7], s54 offen offset:0 lds
    v_mfma_f32_16x16x32_bf16 v[112:115], v[132:135], v[132:135], v[112:115]
    buffer_load_dwordx4 v46, s[4:7], s54 offen offset:1024 lds
    v_mfma_f32_16x16x32_bf16 v[116:119], v[136:139], v[136:139], v[116:119]
    buffer_load_dwordx4 v47, s[4:7], s54 offen offset:2048 lds
    s_add_u32 m0, s52, 73728
    v_mfma_f32_16x16x32_bf16 v[120:123], v[140:143], v[140:143], v[120:123]
    s_add_u32 s54, s54, 128
    buffer_load_dwordx4 v26, s[8:11], s55 offen offset:0 lds
    v_mfma_f32_16x16x32_bf16 v[124:127], v[144:147], v[72:75], v[124:127]
    buffer_load_dwordx4 v27, s[8:11], s55 offen offset:1024 lds
    s_add_u32 s55, s55, 81920
    v_mfma_f32_16x16x32_bf16 v[128:131], v[148:151], v[72:75], v[128:131]
    s_cmp_eq_u32 s54, 1280
    s_cselect_b32 s54, 0, s54
    s_cselect_b32 s55, 0, s55
    s_waitcnt lgkmcnt(0)
    s_waitcnt vmcnt(5)
    s_barrier
    s_nop 0
    v_mfma_f32_16x16x32_bf16 v[76:79], v[164:167], v[152:155], v[76:79]
    ds_read_b64_tr_b16 v[144:145], v56 offset:40960
    ds_read_b64_tr_b16 v[146:147], v56 offset:41472
    v_mfma_f32_16x16x32_bf16 v[80:83], v[168:171], v[152:155], v[80:83]
    ds_read_b128 v[132:135], v52 offset:40960
    ds_read_b64_tr_b16 v[148:149], v57 offset:40960
    v_mfma_f32_16x16x32_bf16 v[84:87], v[164:167], v[156:159], v[84:87]
    ds_read_b64_tr_b16 v[150:151], v57 offset:41472
    ds_read_b128 v[136:139], v52 offset:43008
    v_mfma_f32_16x16x32_bf16 v[88:91], v[168:171], v[156:159], v[88:91]
    ds_read_b128 v[140:143], v53 offset:40960
    v_mfma_f32_16x16x32_bf16 v[92:95], v[164:167], v[160:163], v[92:95]
    v_mfma_f32_16x16x32_bf16 v[96:99], v[168:171], v[160:163], v[96:99]
    s_waitcnt lgkmcnt(0)
    s_nop 0
    v_mfma_f32_16x16x32_bf16 v[76:79], v[144:147], v[132:135], v[76:79]
    ds_read_b64_tr_b16 v[164:165], v58 offset:40960
    v_mfma_f32_16x16x32_bf16 v[80:83], v[148:151], v[132:135], v[80:83]
    ds_read_b64_tr_b16 v[166:167], v58 offset:41472
    v_mfma_f32_16x16x32_bf16 v[84:87], v[144:147], v[136:139], v[84:87]
    ds_read_b128 v[152:155], v54 offset:40960
    v_mfma_f32_16x16x32_bf16 v[88:91], v[148:151], v[136:139], v[88:91]
    ds_read_b64_tr_b16 v[168:169], v59 offset:40960
    v_mfma_f32_16x16x32_bf16 v[92:95], v[144:147], v[140:143], v[92:95]
    ds_read_b64_tr_b16 v[170:171], v59 offset:41472
    v_mfma_f32_16x16x32_bf16 v[96:99], v[148:151], v[140:143], v[96:99]
    ds_read_b128 v[156:159], v54 offset:43008
    v_mfma_f32_16x16x32_bf16 v[100:103], v[72:75], v[132:135], v[100:103]
    ds_read_b128 v[160:163], v55 offset:40960
    v_mfma_f32_16x16x32_bf16 v[104:107], v[72:75], v[136:139], v[104:107]
    s_add_u32 m0, s53, 0
    s_nop 0
    v_mfma_f32_16x16x32_bf16 v[108:111], v[72:75], v[140:143], v[108:111]
    buffer_load_dwordx4 v45, s[4:7], s54 offen offset:0 lds
    v_mfma_f32_16x16x32_bf16 v[112:115], v[132:135], v[132:135], v[112:115]
    buffer_load_dwordx4 v46, s[4:7], s54 offen offset:1024 lds
    v_mfma_f32_16x16x32_bf16 v[116:119], v[136:139], v[136:139], v[116:119]
    buffer_load_dwordx4 v47, s[4:7], s54 offen offset:2048 lds
    s_add_u32 m0, s52, 12288
    v_mfma_f32_16x16x32_bf16 v[120:123], v[140:143], v[140:143], v[120:123]
    s_add_u32 s54, s54, 128
    buffer_load_dwordx4 v26, s[8:11], s55 offen offset:0 lds
    v_mfma_f32_16x16x32_bf16 v[124:127], v[144:147], v[72:75], v[124:127]
    buffer_load_dwordx4 v27, s[8:11], s55 offen offset:1024 lds
    s_add_u32 s55, s55, 81920
    v_mfma_f32_16x16x32_bf16 v[128:131], v[148:151], v[72:75], v[128:131]
    s_cmp_eq_u32 s54, 1280
    s_cselect_b32 s54, 0, s54
    s_cselect_b32 s55, 0, s55
    s_waitcnt lgkmcnt(0)
    s_waitcnt vmcnt(5)
    s_barrier
    s_nop 0
    v_mfma_f32_16x16x32_bf16 v[76:79], v[164:167], v[152:155], v[76:79]
    ds_read_b64_tr_b16 v[144:145], v56 offset:61440
    ds_read_b64_tr_b16 v[146:147], v56 offset:61952
    v_mfma_f32_16x16x32_bf16 v[80:83], v[168:171], v[152:155], v[80:83]
    ds_read_b128 v[132:135], v52 offset:61440
    ds_read_b64_tr_b16 v[148:149], v57 offset:61440
    v_mfma_f32_16x16x32_bf16 v[84:87], v[164:167], v[156:159], v[84:87]
    ds_read_b64_tr_b16 v[150:151], v57 offset:61952
    ds_read_b128 v[136:139], v52 offset:63488
    v_mfma_f32_16x16x32_bf16 v[88:91], v[168:171], v[156:159], v[88:91]
    ds_read_b128 v[140:143], v53 offset:61440
    v_mfma_f32_16x16x32_bf16 v[92:95], v[164:167], v[160:163], v[92:95]
    v_mfma_f32_16x16x32_bf16 v[96:99], v[168:171], v[160:163], v[96:99]
    s_waitcnt lgkmcnt(0)
    s_nop 0
    v_mfma_f32_16x16x32_bf16 v[76:79], v[144:147], v[132:135], v[76:79]
    ds_read_b64_tr_b16 v[164:165], v58 offset:61440
    v_mfma_f32_16x16x32_bf16 v[80:83], v[148:151], v[132:135], v[80:83]
    ds_read_b64_tr_b16 v[166:167], v58 offset:61952
    v_mfma_f32_16x16x32_bf16 v[84:87], v[144:147], v[136:139], v[84:87]
    ds_read_b128 v[152:155], v54 offset:61440
    v_mfma_f32_16x16x32_bf16 v[88:91], v[148:151], v[136:139], v[88:91]
    ds_read_b64_tr_b16 v[168:169], v59 offset:61440
    v_mfma_f32_16x16x32_bf16 v[92:95], v[144:147], v[140:143], v[92:95]
    ds_read_b64_tr_b16 v[170:171], v59 offset:61952
    v_mfma_f32_16x16x32_bf16 v[96:99], v[148:151], v[140:143], v[96:99]
    ds_read_b128 v[156:159], v54 offset:63488
    v_mfma_f32_16x16x32_bf16 v[100:103], v[72:75], v[132:135], v[100:103]
    ds_read_b128 v[160:163], v55 offset:61440
    v_mfma_f32_16x16x32_bf16 v[104:107], v[72:75], v[136:139], v[104:107]
    s_add_u32 m0, s53, 20480
    v_mfma_f32_16x16x32_bf16 v[108:111], v[72:75], v[140:143], v[108:111]
    buffer_load_dwordx4 v45, s[4:7], s54 offen offset:0 lds
    v_mfma_f32_16x16x32_bf16 v[112:115], v[132:135], v[132:135], v[112:115]
    buffer_load_dwordx4 v46, s[4:7], s54 offen offset:1024 lds
    v_mfma_f32_16x16x32_bf16 v[116:119], v[136:139], v[136:139], v[116:119]
    buffer_load_dwordx4 v47, s[4:7], s54 offen offset:2048 lds
    s_add_u32 m0, s52, 32768
    v_mfma_f32_16x16x32_bf16 v[120:123], v[140:143], v[140:143], v[120:123]
    s_add_u32 s54, s54, 128
    buffer_load_dwordx4 v26, s[8:11], s55 offen offset:0 lds
    v_mfma_f32_16x16x32_bf16 v[124:127], v[144:147], v[72:75], v[124:127]
    buffer_load_dwordx4 v27, s[8:11], s55 offen offset:1024 lds
    s_add_u32 s55, s55, 81920
    v_mfma_f32_16x16x32_bf16 v[128:131], v[148:151], v[72:75], v[128:131]
    s_cmp_eq_u32 s54, 1280
    s_cselect_b32 s54, 0, s54
    s_cselect_b32 s55, 0, s55
    s_waitcnt lgkmcnt(0)
    s_waitcnt vmcnt(5)
    s_barrier
    s_nop 0
    v_mfma_f32_16x16x32_bf16 v[76:79], v[164:167], v[152:155], v[76:79]
    ds_read_b64_tr_b16 v[144:145], v56 offset:0
    ds_read_b64_tr_b16 v[146:147], v56 offset:512
    v_mfma_f32_16x16x32_bf16 v[80:83], v[168:171], v[152:155], v[80:83]
    ds_read_b128 v[132:135], v52 offset:0
    ds_read_b64_tr_b16 v[148:149], v57 offset:0
    v_mfma_f32_16x16x32_bf16 v[84:87], v[164:167], v[156:159], v[84:87]
    ds_read_b64_tr_b16 v[150:151], v57 offset:512
    ds_read_b128 v[136:139], v52 offset:2048
    v_mfma_f32_16x16x32_bf16 v[88:91], v[168:171], v[156:159], v[88:91]
    ds_read_b128 v[140:143], v53 offset:0
    v_mfma_f32_16x16x32_bf16 v[92:95], v[164:167], v[160:163], v[92:95]
    v_mfma_f32_16x16x32_bf16 v[96:99], v[168:171], v[160:163], v[96:99]
    s_cmp_lg_u32 s57, 2
    s_cbranch_scc1 L_ownx_2
    v_add_u32 v60, 0, v60
    v_add_u32 v61, 0, v61
    ds_read_b64 v[2:3], v60 offset:0
    ds_read_b64 v[4:5], v61 offset:0
    ds_read_b64 v[6:7], v60 offset:2048
    ds_read_b64 v[8:9], v61 offset:2048
    ds_read_b64 v[10:11], v60 offset:4096
    ds_read_b64 v[12:13], v61 offset:4096
    s_waitcnt lgkmcnt(0)
L_ownx_2:
    s_waitcnt lgkmcnt(0)
    v_mfma_f32_16x16x32_bf16 v[76:79], v[144:147], v[132:135], v[76:79]
    ds_read_b64_tr_b16 v[164:165], v58 offset:0
    v_mfma_f32_16x16x32_bf16 v[80:83], v[148:151], v[132:135], v[80:83]
    ds_read_b64_tr_b16 v[166:167], v58 offset:512
    v_mfma_f32_16x16x32_bf16 v[84:87], v[144:147], v[136:139], v[84:87]
    ds_read_b128 v[152:155], v54 offset:0
    v_mfma_f32_16x16x32_bf16 v[88:91], v[148:151], v[136:139], v[88:91]
    ds_read_b64_tr_b16 v[168:169], v59 offset:0
    v_mfma_f32_16x16x32_bf16 v[92:95], v[144:147], v[140:143], v[92:95]
    ds_read_b64_tr_b16 v[170:171], v59 offset:512
    v_mfma_f32_16x16x32_bf16 v[96:99], v[148:151], v[140:143], v[96:99]
    ds_read_b128 v[156:159], v54 offset:2048
    v_mfma_f32_16x16x32_bf16 v[100:103], v[72:75], v[132:135], v[100:103]
    ds_read_b128 v[160:163], v55 offset:0
    v_mfma_f32_16x16x32_bf16 v[104:107], v[72:75], v[136:139], v[104:107]
    s_add_u32 m0, s53, 40960
    v_mfma_f32_16x16x32_bf16 v[108:111], v[72:75], v[140:143], v[108:111]
    buffer_load_dwordx4 v45, s[4:7], s54 offen offset:0 lds
    v_mfma_f32_16x16x32_bf16 v[112:115], v[132:135], v[132:135], v[112:115]
    buffer_load_dwordx4 v46, s[4:7], s54 offen offset:1024 lds
    v_mfma_f32_16x16x32_bf16 v[116:119], v[136:139], v[136:139], v[116:119]
    buffer_load_dwordx4 v47, s[4:7], s54 offen offset:2048 lds
    s_add_u32 m0, s52, 53248
    v_mfma_f32_16x16x32_bf16 v[120:123], v[140:143], v[140:143], v[120:123]
    s_add_u32 s54, s54, 128
    buffer_load_dwordx4 v26, s[8:11], s55 offen offset:0 lds
    v_mfma_f32_16x16x32_bf16 v[124:127], v[144:147], v[72:75], v[124:127]
    buffer_load_dwordx4 v27, s[8:11], s55 offen offset:1024 lds
    s_add_u32 s55, s55, 81920
    v_mfma_f32_16x16x32_bf16 v[128:131], v[148:151], v[72:75], v[128:131]
    s_cmp_eq_u32 s54, 1280
    s_cselect_b32 s54, 0, s54
    s_cselect_b32 s55, 0, s55
    s_waitcnt lgkmcnt(0)
    s_waitcnt vmcnt(5)
    s_barrier
    s_nop 0
    v_mfma_f32_16x16x32_bf16 v[76:79], v[164:167], v[152:155], v[76:79]
    ds_read_b64_tr_b16 v[144:145], v56 offset:20480
    ds_read_b64_tr_b16 v[146:147], v56 offset:20992
    v_mfma_f32_16x16x32_bf16 v[80:83], v[168:171], v[152:155], v[80:83]
    ds_read_b128 v[132:135], v52 offset:20480
    ds_read_b64_tr_b16 v[148:149], v57 offset:20480
    v_mfma_f32_16x16x32_bf16 v[84:87], v[164:167], v[156:159], v[84:87]
    ds_read_b64_tr_b16 v[150:151], v57 offset:20992
    ds_read_b128 v[136:139], v52 offset:22528
    v_mfma_f32_16x16x32_bf16 v[88:91], v[168:171], v[156:159], v[88:91]
    ds_read_b128 v[140:143], v53 offset:20480
    v_mfma_f32_16x16x32_bf16 v[92:95], v[164:167], v[160:163], v[92:95]
    v_mfma_f32_16x16x32_bf16 v[96:99], v[168:171], v[160:163], v[96:99]
    s_waitcnt lgkmcnt(0)
    s_nop 0
    v_mfma_f32_16x16x32_bf16 v[76:79], v[144:147], v[132:135], v[76:79]
    ds_read_b64_tr_b16 v[164:165], v58 offset:20480
    v_mfma_f32_16x16x32_bf16 v[80:83], v[148:151], v[132:135], v[80:83]
    ds_read_b64_tr_b16 v[166:167], v58 offset:20992
    v_mfma_f32_16x16x32_bf16 v[84:87], v[144:147], v[136:139], v[84:87]
    ds_read_b128 v[152:155], v54 offset:20480
    v_mfma_f32_16x16x32_bf16 v[88:91], v[148:151], v[136:139], v[88:91]
    ds_read_b64_tr_b16 v[168:169], v59 offset:20480
    v_mfma_f32_16x16x32_bf16 v[92:95], v[144:147], v[140:143], v[92:95]
    ds_read_b64_tr_b16 v[170:171], v59 offset:20992
    v_mfma_f32_16x16x32_bf16 v[96:99], v[148:151], v[140:143], v[96:99]
    ds_read_b128 v[156:159], v54 offset:22528
    v_mfma_f32_16x16x32_bf16 v[100:103], v[72:75], v[132:135], v[100:103]
    ds_read_b128 v[160:163], v55 offset:20480
    v_mfma_f32_16x16x32_bf16 v[104:107], v[72:75], v[136:139], v[104:107]
    s_add_u32 m0, s53, 61440
    v_mfma_f32_16x16x32_bf16 v[108:111], v[72:75], v[140:143], v[108:111]
    buffer_load_dwordx4 v45, s[4:7], s54 offen offset:0 lds
    v_mfma_f32_16x16x32_bf16 v[112:115], v[132:135], v[132:135], v[112:115]
    buffer_load_dwordx4 v46, s[4:7], s54 offen offset:1024 lds
    v_mfma_f32_16x16x32_bf16 v[116:119], v[136:139], v[136:139], v[116:119]
    buffer_load_dwordx4 v47, s[4:7], s54 offen offset:2048 lds
    s_add_u32 m0, s52, 73728
    v_mfma_f32_16x16x32_bf16 v[120:123], v[140:143], v[140:143], v[120:123]
    s_add_u32 s54, s54, 128
    buffer_load_dwordx4 v26, s[8:11], s55 offen offset:0 lds
    v_mfma_f32_16x16x32_bf16 v[124:127], v[144:147], v[72:75], v[124:127]
    buffer_load_dwordx4 v27, s[8:11], s55 offen offset:1024 lds
    s_add_u32 s55, s55, 81920
    v_mfma_f32_16x16x32_bf16 v[128:131], v[148:151], v[72:75], v[128:131]
    s_cmp_eq_u32 s54, 1280
    s_cselect_b32 s54, 0, s54
    s_cselect_b32 s55, 0, s55
    s_waitcnt lgkmcnt(0)
    s_waitcnt vmcnt(5)
    s_barrier
    s_nop 0
    v_mfma_f32_16x16x32_bf16 v[76:79], v[164:167], v[152:155], v[76:79]
    ds_read_b64_tr_b16 v[144:145], v56 offset:40960
    ds_read_b64_tr_b16 v[146:147], v56 offset:41472
    v_mfma_f32_16x16x32_bf16 v[80:83], v[168:171], v[152:155], v[80:83]
    ds_read_b128 v[132:135], v52 offset:40960
    ds_read_b64_tr_b16 v[148:149], v57 offset:40960
    v_mfma_f32_16x16x32_bf16 v[84:87], v[164:167], v[156:159], v[84:87]
    ds_read_b64_tr_b16 v[150:151], v57 offset:41472
    ds_read_b128 v[136:139], v52 offset:43008
    v_mfma_f32_16x16x32_bf16 v[88:91], v[168:171], v[156:159], v[88:91]
    ds_read_b128 v[140:143], v53 offset:40960
    v_mfma_f32_16x16x32_bf16 v[92:95], v[164:167], v[160:163], v[92:95]
    v_mfma_f32_16x16x32_bf16 v[96:99], v[168:171], v[160:163], v[96:99]
    s_waitcnt lgkmcnt(0)
    s_nop 0
    v_mfma_f32_16x16x32_bf16 v[76:79], v[144:147], v[132:135], v[76:79]
    ds_read_b64_tr_b16 v[164:165], v58 offset:40960
    v_mfma_f32_16x16x32_bf16 v[80:83], v[148:151], v[132:135], v[80:83]
    ds_read_b64_tr_b16 v[166:167], v58 offset:41472
    v_mfma_f32_16x16x32_bf16 v[84:87], v[144:147], v[136:139], v[84:87]
    ds_read_b128 v[152:155], v54 offset:40960
    v_mfma_f32_16x16x32_bf16 v[88:91], v[148:151], v[136:139], v[88:91]
    ds_read_b64_tr_b16 v[168:169], v59 offset:40960
    v_mfma_f32_16x16x32_bf16 v[92:95], v[144:147], v[140:143], v[92:95]
    ds_read_b64_tr_b16 v[170:171], v59 offset:41472
    v_mfma_f32_16x16x32_bf16 v[96:99], v[148:151], v[140:143], v[96:99]
    ds_read_b128 v[156:159], v54 offset:43008
    v_mfma_f32_16x16x32_bf16 v[100:103], v[72:75], v[132:135], v[100:103]
    ds_read_b128 v[160:163], v55 offset:40960
    v_mfma_f32_16x16x32_bf16 v[104:107], v[72:75], v[136:139], v[104:107]
    s_add_u32 m0, s53, 0
    s_nop 0
    v_mfma_f32_16x16x32_bf16 v[108:111], v[72:75], v[140:143], v[108:111]
    buffer_load_dwordx4 v45, s[4:7], s54 offen offset:0 lds
    v_mfma_f32_16x16x32_bf16 v[112:115], v[132:135], v[132:135], v[112:115]
    buffer_load_dwordx4 v46, s[4:7], s54 offen offset:1024 lds
    v_mfma_f32_16x16x32_bf16 v[116:119], v[136:139], v[136:139], v[116:119]
    buffer_load_dwordx4 v47, s[4:7], s54 offen offset:2048 lds
    s_add_u32 m0, s52, 12288
    v_mfma_f32_16x16x32_bf16 v[120:123], v[140:143], v[140:143], v[120:123]
    s_add_u32 s54, s54, 128
    buffer_load_dwordx4 v26, s[8:11], s55 offen offset:0 lds
    v_mfma_f32_16x16x32_bf16 v[124:127], v[144:147], v[72:75], v[124:127]
    buffer_load_dwordx4 v27, s[8:11], s55 offen offset:1024 lds
    s_add_u32 s55, s55, 81920
    v_mfma_f32_16x16x32_bf16 v[128:131], v[148:151], v[72:75], v[128:131]
    s_cmp_eq_u32 s54, 1280
    s_cselect_b32 s54, 0, s54
    s_cselect_b32 s55, 0, s55
    s_waitcnt lgkmcnt(0)
    s_waitcnt vmcnt(5)
    s_barrier
    s_nop 0
    v_mfma_f32_16x16x32_bf16 v[76:79], v[164:167], v[152:155], v[76:79]
    ds_read_b64_tr_b16 v[144:145], v56 offset:61440
    ds_read_b64_tr_b16 v[146:147], v56 offset:61952
    v_mfma_f32_16x16x32_bf16 v[80:83], v[168:171], v[152:155], v[80:83]
    ds_read_b128 v[132:135], v52 offset:61440
    ds_read_b64_tr_b16 v[148:149], v57 offset:61440
    v_mfma_f32_16x16x32_bf16 v[84:87], v[164:167], v[156:159], v[84:87]
    ds_read_b64_tr_b16 v[150:151], v57 offset:61952
    ds_read_b128 v[136:139], v52 offset:63488
    v_mfma_f32_16x16x32_bf16 v[88:91], v[168:171], v[156:159], v[88:91]
    ds_read_b128 v[140:143], v53 offset:61440
    v_mfma_f32_16x16x32_bf16 v[92:95], v[164:167], v[160:163], v[92:95]
    v_mfma_f32_16x16x32_bf16 v[96:99], v[168:171], v[160:163], v[96:99]
    s_cmp_lg_u32 s57, 1
    s_cbranch_scc1 L_ownx_3
    v_add_u32 v60, 61440, v60
    v_add_u32 v61, 61440, v61
    ds_read_b64 v[2:3], v60 offset:0
    ds_read_b64 v[4:5], v61 offset:0
    ds_read_b64 v[6:7], v60 offset:2048
    ds_read_b64 v[8:9], v61 offset:2048
    ds_read_b64 v[10:11], v60 offset:4096
    ds_read_b64 v[12:13], v61 offset:4096
    s_waitcnt lgkmcnt(0)
L_ownx_3:
    s_waitcnt lgkmcnt(0)
    v_mfma_f32_16x16x32_bf16 v[76:79], v[144:147], v[132:135], v[76:79]
    ds_read_b64_tr_b16 v[164:165], v58 offset:61440
    v_mfma_f32_16x16x32_bf16 v[80:83], v[148:151], v[132:135], v[80:83]
    ds_read_b64_tr_b16 v[166:167], v58 offset:61952
    v_mfma_f32_16x16x32_bf16 v[84:87], v[144:147], v[136:139], v[84:87]
    ds_read_b128 v[152:155], v54 offset:61440
    v_mfma_f32_16x16x32_bf16 v[88:91], v[148:151], v[136:139], v[88:91]
    ds_read_b64_tr_b16 v[168:169], v59 offset:61440
    v_mfma_f32_16x16x32_bf16 v[92:95], v[144:147], v[140:143], v[92:95]
    ds_read_b64_tr_b16 v[170:171], v59 offset:61952
    v_mfma_f32_16x16x32_bf16 v[96:99], v[148:151], v[140:143], v[96:99]
    ds_read_b128 v[156:159], v54 offset:63488
    v_mfma_f32_16x16x32_bf16 v[100:103], v[72:75], v[132:135], v[100:103]
    ds_read_b128 v[160:163], v55 offset:61440
    v_mfma_f32_16x16x32_bf16 v[104:107], v[72:75], v[136:139], v[104:107]
    s_add_u32 m0, s53, 20480
    v_mfma_f32_16x16x32_bf16 v[108:111], v[72:75], v[140:143], v[108:111]
    buffer_load_dwordx4 v45, s[4:7], s54 offen offset:0 lds
    v_mfma_f32_16x16x32_bf16 v[112:115], v[132:135], v[132:135], v[112:115]
    buffer_load_dwordx4 v46, s[4:7], s54 offen offset:1024 lds
    v_mfma_f32_16x16x32_bf16 v[116:119], v[136:139], v[136:139], v[116:119]
    buffer_load_dwordx4 v47, s[4:7], s54 offen offset:2048 lds
    s_add_u32 m0, s52, 32768
    v_mfma_f32_16x16x32_bf16 v[120:123], v[140:143], v[140:143], v[120:123]
    s_add_u32 s54, s54, 128
    buffer_load_dwordx4 v26, s[8:11], s55 offen offset:0 lds
    v_mfma_f32_16x16x32_bf16 v[124:127], v[144:147], v[72:75], v[124:127]
    buffer_load_dwordx4 v27, s[8:11], s55 offen offset:1024 lds
    s_add_u32 s55, s55, 81920
    v_mfma_f32_16x16x32_bf16 v[128:131], v[148:151], v[72:75], v[128:131]
    s_cmp_eq_u32 s54, 1280
    s_cselect_b32 s54, 0, s54
    s_cselect_b32 s55, 0, s55
    s_waitcnt lgkmcnt(0)
    s_waitcnt vmcnt(5)
    s_barrier
    s_nop 0
    v_mfma_f32_16x16x32_bf16 v[76:79], v[164:167], v[152:155], v[76:79]
    ds_read_b64_tr_b16 v[144:145], v56 offset:0
    ds_read_b64_tr_b16 v[146:147], v56 offset:512
    v_mfma_f32_16x16x32_bf16 v[80:83], v[168:171], v[152:155], v[80:83]
    ds_read_b128 v[132:135], v52 offset:0
    ds_read_b64_tr_b16 v[148:149], v57 offset:0
    v_mfma_f32_16x16x32_bf16 v[84:87], v[164:167], v[156:159], v[84:87]
    ds_read_b64_tr_b16 v[150:151], v57 offset:512
    ds_read_b128 v[136:139], v52 offset:2048
    v_mfma_f32_16x16x32_bf16 v[88:91], v[168:171], v[156:159], v[88:91]
    ds_read_b128 v[140:143], v53 offset:0
    v_mfma_f32_16x16x32_bf16 v[92:95], v[164:167], v[160:163], v[92:95]
    v_mfma_f32_16x16x32_bf16 v[96:99], v[168:171], v[160:163], v[96:99]
    s_waitcnt lgkmcnt(0)
    s_nop 0
    v_mfma_f32_16x16x32_bf16 v[76:79], v[144:147], v[132:135], v[76:79]
    ds_read_b64_tr_b16 v[164:165], v58 offset:0
    v_mfma_f32_16x16x32_bf16 v[80:83], v[148:151], v[132:135], v[80:83]
    ds_read_b64_tr_b16 v[166:167], v58 offset:512
    v_mfma_f32_16x16x32_bf16 v[84:87], v[144:147], v[136:139], v[84:87]
    ds_read_b128 v[152:155], v54 offset:0
    v_mfma_f32_16x16x32_bf16 v[88:91], v[148:151], v[136:139], v[88:91]
    ds_read_b64_tr_b16 v[168:169], v59 offset:0
    v_mfma_f32_16x16x32_bf16 v[92:95], v[144:147], v[140:143], v[92:95]
    ds_read_b64_tr_b16 v[170:171], v59 offset:512
    v_mfma_f32_16x16x32_bf16 v[96:99], v[148:151], v[140:143], v[96:99]
    ds_read_b128 v[156:159], v54 offset:2048
    v_mfma_f32_16x16x32_bf16 v[100:103], v[72:75], v[132:135], v[100:103]
    ds_read_b128 v[160:163], v55 offset:0
    v_mfma_f32_16x16x32_bf16 v[104:107], v[72:75], v[136:139], v[104:107]
    buffer_load_dwordx2 v[30:31], off, s[32:35], 0 sc1
    v_mfma_f32_16x16x32_bf16 v[108:111], v[72:75], v[140:143], v[108:111]
    s_add_u32 m0, s52, 40960
    s_mov_b32 s55, 409600
    buffer_load_dwordx4 v26, s[12:15], s55 offen lds
    v_mfma_f32_16x16x32_bf16 v[112:115], v[132:135], v[132:135], v[112:115]
    buffer_load_dwordx4 v27, s[12:15], s55 offen offset:1024 lds
    v_mfma_f32_16x16x32_bf16 v[116:119], v[136:139], v[136:139], v[116:119]
    s_add_u32 m0, s52, 49152
    s_mov_b32 s55, 491520
    buffer_load_dwordx4 v26, s[12:15], s55 offen lds
    v_mfma_f32_16x16x32_bf16 v[120:123], v[140:143], v[140:143], v[120:123]
    buffer_load_dwordx4 v27, s[12:15], s55 offen offset:1024 lds
    v_mfma_f32_16x16x32_bf16 v[124:127], v[144:147], v[72:75], v[124:127]
    v_mfma_f32_16x16x32_bf16 v[128:131], v[148:151], v[72:75], v[128:131]
    s_waitcnt lgkmcnt(0)
    s_waitcnt vmcnt(5)
    s_barrier
    s_nop 0
    v_mfma_f32_16x16x32_bf16 v[76:79], v[164:167], v[152:155], v[76:79]
    ds_read_b64_tr_b16 v[144:145], v56 offset:20480
    ds_read_b64_tr_b16 v[146:147], v56 offset:20992
    v_mfma_f32_16x16x32_bf16 v[80:83], v[168:171], v[152:155], v[80:83]
    ds_read_b128 v[132:135], v52 offset:20480
    ds_read_b64_tr_b16 v[148:149], v57 offset:20480
    v_mfma_f32_16x16x32_bf16 v[84:87], v[164:167], v[156:159], v[84:87]
    ds_read_b64_tr_b16 v[150:151], v57 offset:20992
    ds_read_b128 v[136:139], v52 offset:22528
    v_mfma_f32_16x16x32_bf16 v[88:91], v[168:171], v[156:159], v[88:91]
    ds_read_b128 v[140:143], v53 offset:20480
    v_mfma_f32_16x16x32_bf16 v[92:95], v[164:167], v[160:163], v[92:95]
    v_mfma_f32_16x16x32_bf16 v[96:99], v[168:171], v[160:163], v[96:99]
    s_waitcnt lgkmcnt(0)
    s_nop 0
    v_mfma_f32_16x16x32_bf16 v[76:79], v[144:147], v[132:135], v[76:79]
    ds_read_b64_tr_b16 v[164:165], v58 offset:20480
    v_mfma_f32_16x16x32_bf16 v[80:83], v[148:151], v[132:135], v[80:83]
    ds_read_b64_tr_b16 v[166:167], v58 offset:20992
    v_mfma_f32_16x16x32_bf16 v[84:87], v[144:147], v[136:139], v[84:87]
    ds_read_b128 v[152:155], v54 offset:20480
    v_mfma_f32_16x16x32_bf16 v[88:91], v[148:151], v[136:139], v[88:91]
    ds_read_b64_tr_b16 v[168:169], v59 offset:20480
    v_mfma_f32_16x16x32_bf16 v[92:95], v[144:147], v[140:143], v[92:95]
    ds_read_b64_tr_b16 v[170:171], v59 offset:20992
    v_mfma_f32_16x16x32_bf16 v[96:99], v[148:151], v[140:143], v[96:99]
    ds_read_b128 v[156:159], v54 offset:22528
    v_mfma_f32_16x16x32_bf16 v[100:103], v[72:75], v[132:135], v[100:103]
    ds_read_b128 v[160:163], v55 offset:20480
    v_mfma_f32_16x16x32_bf16 v[104:107], v[72:75], v[136:139], v[104:107]
    s_add_u32 m0, s52, 57344
    s_mov_b32 s55, 573440
    buffer_load_dwordx4 v26, s[12:15], s55 offen lds
    v_mfma_f32_16x16x32_bf16 v[108:111], v[72:75], v[140:143], v[108:111]
    buffer_load_dwordx4 v27, s[12:15], s55 offen offset:1024 lds
    v_mfma_f32_16x16x32_bf16 v[112:115], v[132:135], v[132:135], v[112:115]
    v_mfma_f32_16x16x32_bf16 v[116:119], v[136:139], v[136:139], v[116:119]
    v_mfma_f32_16x16x32_bf16 v[120:123], v[140:143], v[140:143], v[120:123]
    v_mfma_f32_16x16x32_bf16 v[124:127], v[144:147], v[72:75], v[124:127]
    v_mfma_f32_16x16x32_bf16 v[128:131], v[148:151], v[72:75], v[128:131]
    s_waitcnt lgkmcnt(0)
    s_nop 0
    v_mfma_f32_16x16x32_bf16 v[76:79], v[164:167], v[152:155], v[76:79]
    v_mfma_f32_16x16x32_bf16 v[80:83], v[168:171], v[152:155], v[80:83]
    v_mfma_f32_16x16x32_bf16 v[84:87], v[164:167], v[156:159], v[84:87]
    v_mfma_f32_16x16x32_bf16 v[88:91], v[168:171], v[156:159], v[88:91]
    v_mfma_f32_16x16x32_bf16 v[92:95], v[164:167], v[160:163], v[92:95]
    v_mfma_f32_16x16x32_bf16 v[96:99], v[168:171], v[160:163], v[96:99]
    s_lshl_b32 s48, s36, 10
    v_lshl_add_u32 v45, v1, 3, s48
    v_lshl_add_u32 v46, v32, 4, s48
    v_and_b32 v48, 1, v1
    v_cmp_eq_u32 s[72:73], 1, v48
    v_and_b32 v48, 2, v1
    v_cmp_eq_u32 vcc, 2, v48
    v_cndmask_b32 v48, v112, v113, s[72:73]
    v_cndmask_b32 v49, v114, v115, s[72:73]
    v_cndmask_b32 v53, v48, v49, vcc
    v_mov_b32 v52, v100
    v_cndmask_b32 v48, v116, v117, s[72:73]
    v_cndmask_b32 v49, v118, v119, s[72:73]
    v_cndmask_b32 v55, v48, v49, vcc
    v_mov_b32 v54, v104
    v_cndmask_b32 v48, v120, v121, s[72:73]
    v_cndmask_b32 v49, v122, v123, s[72:73]
    v_cndmask_b32 v57, v48, v49, vcc
    v_mov_b32_e64 v56, v108
    s_mov_b64 exec, s[60:61]
    ds_write_b64 v45, v[52:53] offset:0
    ds_write_b64 v45, v[54:55] offset:128
    ds_write_b64 v45, v[56:57] offset:256
    s_mov_b64 exec, s[62:63]
    ds_write_b128 v46, v[124:127] offset:512
    ds_write_b128 v46, v[128:131] offset:576
    s_mov_b64 exec, -1
    v_xor_b32 v47, 1024, v45
    v_xor_b32 v46, 2048, v46
    s_waitcnt lgkmcnt(0)
    s_barrier
    ds_read_b64 v[52:53], v45 offset:0
    ds_read_b64 v[132:133], v47 offset:0
    ds_read_b64 v[54:55], v45 offset:128
    ds_read_b64 v[134:135], v47 offset:128
    ds_read_b64 v[56:57], v45 offset:256
    ds_read_b64 v[136:137], v47 offset:256
    ds_read_b128 v[138:141], v46 offset:512
    ds_read_b128 v[142:145], v46 offset:576
    s_mov_b32 s64, 0x3acccccd
    s_mov_b32 s65, 0x3acccccd
    s_mov_b32 s70, 0x3727c5ac
    s_waitcnt lgkmcnt(2)
    s_nop 0
    v_pk_add_f32 v[52:53], v[52:53], v[132:133]
    v_pk_add_f32 v[54:55], v[54:55], v[134:135]
    v_pk_add_f32 v[56:57], v[56:57], v[136:137]
    v_pk_mul_f32 v[52:53], v[52:53], s[64:65]
    v_pk_mul_f32 v[54:55], v[54:55], s[64:65]
    v_pk_mul_f32 v[56:57], v[56:57], s[64:65]
    v_fma_f32 v53, -v52, v52, v53
    v_fma_f32 v55, -v54, v54, v55
    v_fma_f32 v57, -v56, v56, v57
    v_max_f32 v53, 0, v53
    v_max_f32 v55, 0, v55
    v_max_f32 v57, 0, v57
    v_add_f32 v132, s70, v53
    v_add_f32 v134, s70, v55
    v_add_f32 v136, s70, v57
    v_rsq_f32 v148, v132
    v_rsq_f32 v152, v134
    v_rsq_f32 v156, v136
    v_mul_f32 v132, v148, v148
    v_mul_f32 v134, v152, v152
    v_mul_f32 v136, v156, v156
    v_fma_f32 v132, v132, v53, s70
    v_fma_f32 v134, v134, v55, s70
    v_fma_f32 v136, v136, v57, s70
    v_rsq_f32 v132, v132
    v_rsq_f32 v134, v134
    v_rsq_f32 v136, v136
    v_mul_f32 v149, v52, v148
    v_mul_f32 v153, v54, v152
    v_mul_f32 v157, v56, v156
    v_mul_f32 v146, v148, v132
    v_mul_f32 v150, v152, v134
    v_mul_f32 v154, v156, v136
    v_mul_f32 v147, v52, v146
    v_mul_f32 v151, v54, v150
    v_mul_f32_e64 v155, v56, v154
    s_waitcnt lgkmcnt(0)
    v_pk_add_f32 v[124:125], v[124:125], v[138:139]
    v_pk_add_f32 v[126:127], v[126:127], v[140:141]
    v_pk_add_f32 v[128:129], v[128:129], v[142:143]
    v_pk_add_f32 v[130:131], v[130:131], v[144:145]
    v_mov_b32 v52, 0
    v_mov_b32 v53, 0
    v_mov_b32 v54, 0
    v_mov_b32 v55, 0
    v_pk_mul_f32 v[76:77], v[76:77], v[146:147] op_sel_hi:[1,0]
    v_pk_mul_f32 v[78:79], v[78:79], v[146:147] op_sel_hi:[1,0]
    v_pk_mul_f32 v[80:81], v[80:81], v[146:147] op_sel_hi:[1,0]
    s_add_u32 m0, s52, 8192
    s_mov_b32 s55, 81920
    buffer_load_dwordx4 v26, s[12:15], s55 offen lds
    v_pk_mul_f32 v[82:83], v[82:83], v[146:147] op_sel_hi:[1,0]
    v_pk_fma_f32 v[76:77], v[124:125], v[146:147], v[76:77] op_sel:[0,1,0] op_sel_hi:[1,1,1] neg_lo:[0,1,0] neg_hi:[0,1,0]
    v_pk_fma_f32 v[78:79], v[126:127], v[146:147], v[78:79] op_sel:[0,1,0] op_sel_hi:[1,1,1] neg_lo:[0,1,0] neg_hi:[0,1,0]
    v_pk_fma_f32 v[80:81], v[128:129], v[146:147], v[80:81] op_sel:[0,1,0] op_sel_hi:[1,1,1] neg_lo:[0,1,0] neg_hi:[0,1,0]
    v_pk_fma_f32 v[82:83], v[130:131], v[146:147], v[82:83] op_sel:[0,1,0] op_sel_hi:[1,1,1] neg_lo:[0,1,0] neg_hi:[0,1,0]
    v_pk_mul_f32 v[100:101], v[76:77], v[76:77]
    v_pk_mul_f32 v[102:103], v[78:79], v[78:79]
    v_pk_mul_f32 v[104:105], v[80:81], v[80:81]
    v_pk_mul_f32 v[106:107], v[82:83], v[82:83]
    v_pk_fma_f32 v[100:101], v[100:101], s[66:67], v[28:29]
    buffer_load_dwordx4 v27, s[12:15], s55 offen offset:1024 lds
    v_pk_fma_f32 v[102:103], v[102:103], s[66:67], v[28:29]
    v_pk_fma_f32 v[104:105], v[104:105], s[66:67], v[28:29]
    v_pk_fma_f32 v[106:107], v[106:107], s[66:67], v[28:29]
    v_pk_mul_f32 v[100:101], v[100:101], v[76:77]
    v_pk_mul_f32 v[102:103], v[102:103], v[78:79]
    v_pk_mul_f32 v[104:105], v[104:105], v[80:81]
    v_pk_mul_f32 v[106:107], v[106:107], v[82:83]
    v_exp_f32 v100, v100
    v_exp_f32 v101, v101
    v_exp_f32_e64 v102, v102
    s_add_u32 m0, s52, 16384
    s_mov_b32 s55, 163840
    buffer_load_dwordx4 v26, s[12:15], s55 offen lds
    v_exp_f32 v103, v103
    v_exp_f32 v104, v104
    v_exp_f32 v105, v105
    v_exp_f32 v106, v106
    v_exp_f32_e64 v107, v107
    v_pk_add_f32 v[100:101], v[100:101], 1.0 op_sel_hi:[1,0]
    v_pk_add_f32 v[102:103], v[102:103], 1.0 op_sel_hi:[1,0]
    v_pk_add_f32 v[104:105], v[104:105], 1.0 op_sel_hi:[1,0]
    v_pk_add_f32 v[106:107], v[106:107], 1.0 op_sel_hi:[1,0]
    v_rcp_f32_e64 v100, v100
    buffer_load_dwordx4 v27, s[12:15], s55 offen offset:1024 lds
    v_rcp_f32 v101, v101
    v_rcp_f32 v102, v102
    v_rcp_f32 v103, v103
    v_rcp_f32 v104, v104
    v_rcp_f32 v105, v105
    v_rcp_f32 v106, v106
    v_rcp_f32_e64 v107, v107
    v_pk_mul_f32 v[100:101], v[100:101], v[76:77]
    v_pk_mul_f32 v[102:103], v[102:103], v[78:79]
    v_pk_mul_f32 v[104:105], v[104:105], v[80:81]
    v_pk_mul_f32 v[106:107], v[106:107], v[82:83]
    v_cvt_pk_bf16_f32 v132, v100, v101
    v_cvt_pk_bf16_f32 v133, v102, v103
    v_cvt_pk_bf16_f32 v134, v104, v105
    v_cvt_pk_bf16_f32 v135, v106, v107
    s_nop 0
    v_permlane16_swap_b32 v132, v134
    v_permlane16_swap_b32 v133, v135
    s_nop 0
    buffer_store_dwordx4 v[132:135], v64, s[24:27], 0 offen offset:0 sc1
    v_pk_mul_f32 v[84:85], v[84:85], v[150:151] op_sel_hi:[1,0]
    v_pk_mul_f32 v[86:87], v[86:87], v[150:151] op_sel_hi:[1,0]
    v_pk_mul_f32 v[88:89], v[88:89], v[150:151] op_sel_hi:[1,0]
    s_add_u32 m0, s52, 24576
    s_mov_b32 s55, 245760
    buffer_load_dwordx4 v26, s[12:15], s55 offen lds
    v_pk_mul_f32 v[90:91], v[90:91], v[150:151] op_sel_hi:[1,0]
    v_pk_fma_f32 v[84:85], v[124:125], v[150:151], v[84:85] op_sel:[0,1,0] op_sel_hi:[1,1,1] neg_lo:[0,1,0] neg_hi:[0,1,0]
    v_pk_fma_f32 v[86:87], v[126:127], v[150:151], v[86:87] op_sel:[0,1,0] op_sel_hi:[1,1,1] neg_lo:[0,1,0] neg_hi:[0,1,0]
    v_pk_fma_f32 v[88:89], v[128:129], v[150:151], v[88:89] op_sel:[0,1,0] op_sel_hi:[1,1,1] neg_lo:[0,1,0] neg_hi:[0,1,0]
    v_pk_fma_f32 v[90:91], v[130:131], v[150:151], v[90:91] op_sel:[0,1,0] op_sel_hi:[1,1,1] neg_lo:[0,1,0] neg_hi:[0,1,0]
    v_pk_mul_f32 v[100:101], v[84:85], v[84:85]
    v_pk_mul_f32 v[102:103], v[86:87], v[86:87]
    v_pk_mul_f32 v[104:105], v[88:89], v[88:89]
    v_pk_mul_f32 v[106:107], v[90:91], v[90:91]
    v_pk_fma_f32 v[100:101], v[100:101], s[66:67], v[28:29]
    buffer_load_dwordx4 v27, s[12:15], s55 offen offset:1024 lds
    v_pk_fma_f32 v[102:103], v[102:103], s[66:67], v[28:29]
    v_pk_fma_f32 v[104:105], v[104:105], s[66:67], v[28:29]
    v_pk_fma_f32 v[106:107], v[106:107], s[66:67], v[28:29]
    v_pk_mul_f32 v[100:101], v[100:101], v[84:85]
    v_pk_mul_f32 v[102:103], v[102:103], v[86:87]
    v_pk_mul_f32 v[104:105], v[104:105], v[88:89]
    v_pk_mul_f32 v[106:107], v[106:107], v[90:91]
    v_exp_f32 v100, v100
    v_exp_f32 v101, v101
    v_exp_f32_e64 v102, v102
    s_add_u32 m0, s52, 32768
    s_mov_b32 s55, 327680
    buffer_load_dwordx4 v26, s[12:15], s55 offen lds
    v_exp_f32 v103, v103
    v_exp_f32 v104, v104
    v_exp_f32 v105, v105
    v_exp_f32 v106, v106
    v_exp_f32_e64 v107, v107
    v_pk_add_f32 v[100:101], v[100:101], 1.0 op_sel_hi:[1,0]
    v_pk_add_f32 v[102:103], v[102:103], 1.0 op_sel_hi:[1,0]
    v_pk_add_f32 v[104:105], v[104:105], 1.0 op_sel_hi:[1,0]
    v_pk_add_f32 v[106:107], v[106:107], 1.0 op_sel_hi:[1,0]
    v_rcp_f32_e64 v100, v100
    buffer_load_dwordx4 v27, s[12:15], s55 offen offset:1024 lds
    v_rcp_f32 v101, v101
    v_rcp_f32 v102, v102
    v_rcp_f32 v103, v103
    v_rcp_f32 v104, v104
    v_rcp_f32 v105, v105
    v_rcp_f32 v106, v106
    v_rcp_f32_e64 v107, v107
    v_pk_mul_f32 v[100:101], v[100:101], v[84:85]
    v_pk_mul_f32 v[102:103], v[102:103], v[86:87]
    v_pk_mul_f32 v[104:105], v[104:105], v[88:89]
    v_pk_mul_f32 v[106:107], v[106:107], v[90:91]
    v_cvt_pk_bf16_f32 v136, v100, v101
    v_cvt_pk_bf16_f32 v137, v102, v103
    v_cvt_pk_bf16_f32 v138, v104, v105
    v_cvt_pk_bf16_f32 v139, v106, v107
    s_nop 0
    v_permlane16_swap_b32 v136, v138
    v_permlane16_swap_b32 v137, v139
    s_nop 0
    buffer_store_dwordx4 v[136:139], v64, s[24:27], 0 offen offset:512 sc1
    v_pk_mul_f32 v[92:93], v[92:93], v[154:155] op_sel_hi:[1,0]
    v_pk_mul_f32 v[94:95], v[94:95], v[154:155] op_sel_hi:[1,0]
    v_pk_mul_f32 v[96:97], v[96:97], v[154:155] op_sel_hi:[1,0]
    v_pk_mul_f32 v[98:99], v[98:99], v[154:155] op_sel_hi:[1,0]
    v_pk_fma_f32 v[92:93], v[124:125], v[154:155], v[92:93] op_sel:[0,1,0] op_sel_hi:[1,1,1] neg_lo:[0,1,0] neg_hi:[0,1,0]
    v_pk_fma_f32 v[94:95], v[126:127], v[154:155], v[94:95] op_sel:[0,1,0] op_sel_hi:[1,1,1] neg_lo:[0,1,0] neg_hi:[0,1,0]
    v_pk_fma_f32 v[96:97], v[128:129], v[154:155], v[96:97] op_sel:[0,1,0] op_sel_hi:[1,1,1] neg_lo:[0,1,0] neg_hi:[0,1,0]
    v_pk_fma_f32 v[98:99], v[130:131], v[154:155], v[98:99] op_sel:[0,1,0] op_sel_hi:[1,1,1] neg_lo:[0,1,0] neg_hi:[0,1,0]
    v_pk_mul_f32 v[100:101], v[92:93], v[92:93]
    v_pk_mul_f32 v[102:103], v[94:95], v[94:95]
    v_pk_mul_f32 v[104:105], v[96:97], v[96:97]
    v_pk_mul_f32 v[106:107], v[98:99], v[98:99]
    v_pk_fma_f32 v[100:101], v[100:101], s[66:67], v[28:29]
    v_pk_fma_f32 v[102:103], v[102:103], s[66:67], v[28:29]
    v_pk_fma_f32 v[104:105], v[104:105], s[66:67], v[28:29]
    v_pk_fma_f32 v[106:107], v[106:107], s[66:67], v[28:29]
    v_pk_mul_f32 v[100:101], v[100:101], v[92:93]
    v_pk_mul_f32 v[102:103], v[102:103], v[94:95]
    v_pk_mul_f32 v[104:105], v[104:105], v[96:97]
    v_pk_mul_f32 v[106:107], v[106:107], v[98:99]
    v_exp_f32 v100, v100
    v_exp_f32 v101, v101
    v_exp_f32 v102, v102
    v_exp_f32 v103, v103
    v_exp_f32 v104, v104
    v_exp_f32 v105, v105
    v_exp_f32 v106, v106
    v_exp_f32 v107, v107
    v_pk_add_f32 v[100:101], v[100:101], 1.0 op_sel_hi:[1,0]
    v_pk_add_f32 v[102:103], v[102:103], 1.0 op_sel_hi:[1,0]
    v_pk_add_f32 v[104:105], v[104:105], 1.0 op_sel_hi:[1,0]
    v_pk_add_f32 v[106:107], v[106:107], 1.0 op_sel_hi:[1,0]
    v_rcp_f32 v100, v100
    v_rcp_f32 v101, v101
    v_rcp_f32 v102, v102
    v_rcp_f32 v103, v103
    v_rcp_f32 v104, v104
    v_rcp_f32 v105, v105
    v_rcp_f32 v106, v106
    v_rcp_f32 v107, v107
    v_pk_mul_f32 v[100:101], v[100:101], v[92:93]
    v_pk_mul_f32 v[102:103], v[102:103], v[94:95]
    v_pk_mul_f32 v[104:105], v[104:105], v[96:97]
    v_pk_mul_f32 v[106:107], v[106:107], v[98:99]
    v_cvt_pk_bf16_f32 v140, v100, v101
    v_cvt_pk_bf16_f32 v141, v102, v103
    v_cvt_pk_bf16_f32 v142, v104, v105
    v_cvt_pk_bf16_f32 v143, v106, v107
    s_nop 0
    v_permlane16_swap_b32 v140, v142
    v_permlane16_swap_b32 v141, v143
    buffer_store_dwordx4 v[140:143], v64, s[24:27], 0 offen offset:1024 sc1
    buffer_store_dwordx4 v[52:55], v65, s[24:27], 0 offen sc1
    s_waitcnt vmcnt(0)
    s_mov_b32 s56, 0
L_nv_4:
    v_readfirstlane_b32 s48, v31
    v_readfirstlane_b32 s45, v30
    s_add_u32 s56, s56, 1
    s_cmp_lg_u32 s48, 0
    s_cbranch_scc1 L_nvok_5
    s_sleep 2
    buffer_load_dwordx2 v[30:31], off, s[32:35], 0 sc1
    s_waitcnt vmcnt(0)
    s_cmp_lt_u32 s56, 100000
    s_cbranch_scc1 L_nv_4
L_nvok_5:
    s_barrier
    s_lshl_b32 s48, s39, 11
    s_lshl_b32 s49, s40, 7
    s_add_u32 s48, s48, s49
    s_add_u32 s48, s48, 20971520
    s_cmp_lg_u32 s36, 0
    s_cbranch_scc1 L_sig_6
    v_mov_b32 v48, s45
    s_mov_b64 s[58:59], exec
    s_mov_b64 exec, 1
    buffer_store_dword v48, off, s[24:27], s48 sc1
    s_mov_b64 exec, s[58:59]
L_sig_6:
    s_add_u32 m0, s52, 0
    s_mov_b32 s55, 0
    buffer_load_dwordx4 v26, s[12:15], s55 offen lds
    buffer_load_dwordx4 v27, s[12:15], s55 offen offset:1024 lds
    v_lshlrev_b32 v100, 16, v2
    v_and_b32 v101, 0xffff0000, v2
    v_lshlrev_b32_e64 v102, 16, v3
    v_and_b32 v103, 0xffff0000, v3
    v_lshlrev_b32_e64 v104, 16, v4
    v_and_b32 v105, 0xffff0000, v4
    v_lshlrev_b32_e64 v106, 16, v5
    v_and_b32 v107, 0xffff0000, v5
    v_pk_fma_f32 v[100:101], v[100:101], v[148:149], v[148:149] op_sel:[0,0,1] op_sel_hi:[1,0,1] neg_lo:[0,0,1] neg_hi:[0,0,1]
    v_pk_fma_f32 v[102:103], v[102:103], v[148:149], v[148:149] op_sel:[0,0,1] op_sel_hi:[1,0,1] neg_lo:[0,0,1] neg_hi:[0,0,1]
    v_pk_fma_f32 v[104:105], v[104:105], v[148:149], v[148:149] op_sel:[0,0,1] op_sel_hi:[1,0,1] neg_lo:[0,0,1] neg_hi:[0,0,1]
    v_pk_fma_f32 v[106:107], v[106:107], v[148:149], v[148:149] op_sel:[0,0,1] op_sel_hi:[1,0,1] neg_lo:[0,0,1] neg_hi:[0,0,1]
    v_cvt_pk_bf16_f32 v14, v100, v101
    v_cvt_pk_bf16_f32 v15, v102, v103
    v_cvt_pk_bf16_f32 v16, v104, v105
    v_cvt_pk_bf16_f32 v17, v106, v107
    v_lshlrev_b32_e64 v100, 16, v6
    v_and_b32 v101, 0xffff0000, v6
    v_lshlrev_b32_e64 v102, 16, v7
    v_and_b32 v103, 0xffff0000, v7
    v_lshlrev_b32_e64 v104, 16, v8
    v_and_b32 v105, 0xffff0000, v8
    v_lshlrev_b32_e64 v106, 16, v9
    v_and_b32 v107, 0xffff0000, v9
    v_pk_fma_f32 v[100:101], v[100:101], v[152:153], v[152:153] op_sel:[0,0,1] op_sel_hi:[1,0,1] neg_lo:[0,0,1] neg_hi:[0,0,1]
    v_pk_fma_f32 v[102:103], v[102:103], v[152:153], v[152:153] op_sel:[0,0,1] op_sel_hi:[1,0,1] neg_lo:[0,0,1] neg_hi:[0,0,1]
    v_pk_fma_f32 v[104:105], v[104:105], v[152:153], v[152:153] op_sel:[0,0,1] op_sel_hi:[1,0,1] neg_lo:[0,0,1] neg_hi:[0,0,1]
    v_pk_fma_f32 v[106:107], v[106:107], v[152:153], v[152:153] op_sel:[0,0,1] op_sel_hi:[1,0,1] neg_lo:[0,0,1] neg_hi:[0,0,1]
    v_cvt_pk_bf16_f32 v18, v100, v101
    v_cvt_pk_bf16_f32 v19, v102, v103
    v_cvt_pk_bf16_f32 v20, v104, v105
    v_cvt_pk_bf16_f32 v21, v106, v107
    v_lshlrev_b32_e64 v100, 16, v10
    v_and_b32 v101, 0xffff0000, v10
    v_lshlrev_b32_e64 v102, 16, v11
    v_and_b32 v103, 0xffff0000, v11
    v_lshlrev_b32_e64 v104, 16, v12
    v_and_b32 v105, 0xffff0000, v12
    v_lshlrev_b32_e64 v106, 16, v13
    v_and_b32 v107, 0xffff0000, v13
    v_pk_fma_f32 v[100:101], v[100:101], v[156:157], v[156:157] op_sel:[0,0,1] op_sel_hi:[1,0,1] neg_lo:[0,0,1] neg_hi:[0,0,1]
    v_pk_fma_f32 v[102:103], v[102:103], v[156:157], v[156:157] op_sel:[0,0,1] op_sel_hi:[1,0,1] neg_lo:[0,0,1] neg_hi:[0,0,1]
    v_pk_fma_f32 v[104:105], v[104:105], v[156:157], v[156:157] op_sel:[0,0,1] op_sel_hi:[1,0,1] neg_lo:[0,0,1] neg_hi:[0,0,1]
    v_pk_fma_f32 v[106:107], v[106:107], v[156:157], v[156:157] op_sel:[0,0,1] op_sel_hi:[1,0,1] neg_lo:[0,0,1] neg_hi:[0,0,1]
    v_cvt_pk_bf16_f32 v22, v100, v101
    v_cvt_pk_bf16_f32 v23, v102, v103
    v_cvt_pk_bf16_f32 v24, v104, v105
    v_cvt_pk_bf16_f32 v25, v106, v107
    ds_write_b64 v67, v[14:15] offset:0
    ds_write_b64 v68, v[16:17] offset:0
    ds_write_b64 v67, v[18:19] offset:1024
    ds_write_b64 v68, v[20:21] offset:1024
    ds_write_b64 v67, v[22:23] offset:8192
    ds_write_b64 v68, v[24:25] offset:8192
    s_waitcnt lgkmcnt(0)
    s_nop 0
    ds_read_b64_tr_b16 v[72:73], v69 offset:0
    ds_read_b64_tr_b16 v[74:75], v70 offset:0
    ds_read_b64_tr_b16 v[76:77], v69 offset:1024
    ds_read_b64_tr_b16 v[78:79], v70 offset:1024
    ds_read_b64_tr_b16 v[80:81], v69 offset:8192
    ds_read_b64_tr_b16 v[82:83], v70 offset:8192
    s_waitcnt lgkmcnt(4)
    v_permlane16_swap_b32 v72, v74
    v_permlane16_swap_b32 v73, v75
    s_mov_b32 s54, 0x400000
    buffer_store_dwordx4 v[72:75], v71, s[24:27], s54 offen sc1
    s_waitcnt lgkmcnt(2)
    v_permlane16_swap_b32 v76, v78
    v_permlane16_swap_b32 v77, v79
    s_mov_b32 s54, 0x405000
    buffer_store_dwordx4 v[76:79], v71, s[24:27], s54 offen sc1
    s_waitcnt lgkmcnt(0)
    v_permlane16_swap_b32 v80, v82
    v_permlane16_swap_b32 v81, v83
    s_nop 0
    s_mov_b32 s54, 0x40a000
    buffer_store_dwordx4 v[80:83], v71, s[24:27], s54 offen sc1
    s_add_u32 m0, s52, 65536
    s_mov_b32 s55, 655360
    buffer_load_dwordx4 v26, s[12:15], s55 offen lds
    buffer_load_dwordx4 v27, s[12:15], s55 offen offset:1024 lds
    s_add_u32 m0, s52, 73728
    s_mov_b32 s55, 737280
    buffer_load_dwordx4 v26, s[12:15], s55 offen lds
    buffer_load_dwordx4 v27, s[12:15], s55 offen offset:1024 lds
    s_lshl_b32 s48, s38, 2
    s_xor_b32 s48, s48, 0
    v_xor_b32_e64 v45, s48, v63
    v_lshl_add_u32 v45, v45, 4, v62
    s_lshl_b32 s48, s38, 12
    v_add_u32 v33, s48, v45
    v_add_u32 v37, 0x8000, v33
    s_lshl_b32 s48, s38, 2
    s_xor_b32 s48, s48, 2
    v_xor_b32_e64 v45, s48, v63
    v_lshl_add_u32 v45, v45, 4, v62
    s_lshl_b32 s48, s38, 12
    v_add_u32 v34, s48, v45
    v_add_u32 v38, 0x8000, v34
    s_lshl_b32 s48, s38, 2
    s_xor_b32 s48, s48, 4
    v_xor_b32_e64 v45, s48, v63
    v_lshl_add_u32 v45, v45, 4, v62
    s_lshl_b32 s48, s38, 12
    v_add_u32 v35, s48, v45
    v_add_u32 v39, 0x8000, v35
    s_lshl_b32 s48, s38, 2
    s_xor_b32 s48, s48, 6
    v_xor_b32_e64 v45, s48, v63
    v_lshl_add_u32 v45, v45, 4, v62
    s_lshl_b32 s48, s38, 12
    v_add_u32 v36, s48, v45
    v_add_u32 v40, 0x8000, v36
    s_mul_i32 s48, s37, 48
    s_add_u32 s48, s48, s41
    v_add_u32 v41, s48, v1
    v_lshlrev_b32 v41, 5, v41
    v_and_b32_e64 v45, 1, v32
    v_lshl_add_u32 v41, v45, 4, v41
    v_lshrrev_b32 v45, 1, v32
    s_mul_i32 s48, s38, 2
    v_add_u32_e64 v45, s48, v45
    v_mul_u32_u24 v45, 67840, v45
    v_add_u32_e64 v41, v41, v45
    s_mul_i32 s48, s37, 48
    s_add_u32 s48, s48, s41
    v_mov_b32 v47, 0x7ffffff0
    v_add_u32 v45, s48, v0
    v_cmp_gt_u32 vcc, 48, v0
    s_lshl_b32 s48, s40, 1
    s_add_u32 s48, s48, s38
    s_mul_i32 s48, s48, 16896
    s_add_u32 s48, s48, 524288
    v_lshl_add_u32 v45, v45, 3, s48
    v_cndmask_b32 v48, v47, v45, vcc
    s_lshl_b32 s48, s39, 11
    s_add_u32 s48, s48, 20969472
    v_lshl_add_u32 v45, v0, 7, s48
    s_mov_b32 s50, 0x03ff00e7
    s_cmp_eq_u32 s39, 0
    s_cselect_b32 s50, 0x03ff0000, s50
    s_cmp_eq_u32 s39, 21
    s_cselect_b32 s51, 0, 0x39c
    v_lshlrev_b32_e64 v140, 16, v14
    v_and_b32 v141, 0xffff0000, v14
    v_lshlrev_b32_e64 v142, 16, v15
    v_and_b32 v143, 0xffff0000, v15
    v_lshlrev_b32_e64 v144, 16, v16
    v_and_b32 v145, 0xffff0000, v16
    v_lshlrev_b32_e64 v146, 16, v17
    v_and_b32 v147, 0xffff0000, v17
    v_lshlrev_b32_e64 v156, 16, v18
    v_and_b32 v157, 0xffff0000, v18
    v_lshlrev_b32_e64 v158, 16, v19
    v_and_b32 v159, 0xffff0000, v19
    v_lshlrev_b32_e64 v160, 16, v20
    v_and_b32 v161, 0xffff0000, v20
    v_lshlrev_b32_e64 v162, 16, v21
    v_and_b32 v163, 0xffff0000, v21
    v_lshlrev_b32_e64 v172, 16, v22
    v_and_b32 v173, 0xffff0000, v22
    v_lshlrev_b32_e64 v174, 16, v23
    v_and_b32 v175, 0xffff0000, v23
    v_lshlrev_b32_e64 v176, 16, v24
    v_and_b32 v177, 0xffff0000, v24
    v_lshlrev_b32_e64 v178, 16, v25
    v_and_b32 v179, 0xffff0000, v25
    s_mul_i32 s48, s36, 6144
    s_add_u32 s48, s48, 0
    v_lshl_add_u32 v204, v0, 4, s48
    s_xor_b32 s48, s36, 1
    s_mul_i32 s48, s48, 6144
    s_add_u32 s48, s48, 0
    v_lshl_add_u32 v205, v0, 4, s48
    s_mul_i32 s48, s44, 192
    v_add_u32 v49, 0, v0
    v_mul_u32_u24 v67, 5462, v49
    v_lshrrev_b32 v67, 16, v67
    v_mul_u32_u24 v42, 12, v67
    v_sub_u32_e64 v49, v49, v42
    v_mul_u32_u24 v67, 3072, v67
    v_lshl_add_u32 v49, v49, 4, v67
    v_add_u32 v42, s48, v49
    v_add_u32 v49, 64, v0
    v_mul_u32_u24 v67, 5462, v49
    v_lshrrev_b32 v67, 16, v67
    v_mul_u32_u24 v43, 12, v67
    v_sub_u32_e64 v49, v49, v43
    v_mul_u32_u24 v67, 3072, v67
    v_lshl_add_u32 v49, v49, 4, v67
    v_add_u32_e64 v43, s48, v49
    v_subrev_u32 v43, 1024, v43
    v_add_u32 v49, 128, v0
    v_mul_u32_u24 v67, 5462, v49
    v_lshrrev_b32 v67, 16, v67
    v_mul_u32_u24 v44, 12, v67
    v_sub_u32_e64 v49, v49, v44
    v_mul_u32_u24 v67, 3072, v67
    v_lshl_add_u32 v49, v49, 4, v67
    v_add_u32_e64 v44, s48, v49
    v_subrev_u32 v44, 2048, v44
    s_lshl_b32 s48, s40, 12
    s_lshl_b32 s49, s39, 7
    s_add_u32 s48, s48, s49
    s_add_u32 s3, s48, 21102592
    s_waitcnt vmcnt(4)
    s_waitcnt lgkmcnt(0)
    s_barrier
    s_cmp_lg_u32 s36, 0
    s_cbranch_scc1 L_sig_7
    v_mov_b32_e64 v46, s45
    s_mov_b64 s[58:59], exec
    s_mov_b64 exec, 1
    buffer_store_dword v46, off, s[24:27], s3 sc1
    s_mov_b64 exec, s[58:59]
L_sig_7:
    s_cmp_lg_u32 s36, 0
    s_cbranch_scc1 L_np_8
    s_mov_b64 s[58:59], exec
    s_mov_b32 exec_lo, s50
    s_mov_b32 exec_hi, s51
    s_mov_b32 s56, 0
L_poll_9:
    buffer_load_dword v46, v45, s[24:27], 0 offen sc1
    s_waitcnt vmcnt(0)
    v_cmp_ne_u32 vcc, s45, v46
    s_add_u32 s56, s56, 1
    s_nop 2
    s_cbranch_vccz L_polled_10
    s_cmp_lt_u32 s56, 100000
    s_cbranch_scc1 L_poll_9
L_polled_10:
    s_mov_b64 exec, s[58:59]
L_np_8:
    s_barrier
    s_nop 0
    s_mov_b32 s54, 0x100060
    buffer_load_dwordx4 v[68:71], v41, s[24:27], s54 offen offset:0 sc1
    buffer_load_dwordx4 v[72:75], v41, s[24:27], s54 offen offset:512 sc1
    buffer_load_dwordx4 v[76:79], v41, s[24:27], s54 offen offset:1024 sc1
    s_mov_b32 s54, 0x142460
    buffer_load_dwordx4 v[80:83], v41, s[24:27], s54 offen offset:0 sc1
    buffer_load_dwordx4 v[84:87], v41, s[24:27], s54 offen offset:512 sc1
    buffer_load_dwordx4 v[88:91], v41, s[24:27], s54 offen offset:1024 sc1
    s_lshl_b32 s54, s38, 6
    s_nop 0
    s_add_u32 s54, s54, 0x184860
    buffer_load_dwordx4 v[92:95], v41, s[24:27], s54 offen offset:0 sc1
    buffer_load_dwordx4 v[96:99], v41, s[24:27], s54 offen offset:512 sc1
    buffer_load_dwordx4 v[100:103], v41, s[24:27], s54 offen offset:1024 sc1
    s_mov_b32 s54, 0x1c6ca0
    buffer_load_dwordx4 v[104:107], v41, s[24:27], s54 offen offset:0 sc1
    buffer_load_dwordx4 v[108:111], v41, s[24:27], s54 offen offset:512 sc1
    buffer_load_dwordx4 v[112:115], v41, s[24:27], s54 offen offset:1024 sc1
    ds_read_b64_tr_b16 v[50:51], v33 offset:0
    ds_read_b64_tr_b16 v[52:53], v33 offset:512
    ds_read_b64_tr_b16 v[54:55], v34 offset:0
    ds_read_b64_tr_b16 v[56:57], v34 offset:512
    ds_read_b64_tr_b16 v[58:59], v35 offset:0
    ds_read_b64_tr_b16 v[60:61], v35 offset:512
    ds_read_b64_tr_b16 v[62:63], v36 offset:0
    ds_read_b64_tr_b16 v[64:65], v36 offset:512
    s_waitcnt vmcnt(9) lgkmcnt(0)
    s_nop 0
    v_mfma_f32_16x16x32_bf16 v[140:143], v[50:53], v[68:71], v[140:143]
    ds_read_b64_tr_b16 v[188:189], v33 offset:8192
    v_mfma_f32_16x16x32_bf16 v[156:159], v[50:53], v[72:75], v[156:159]
    ds_read_b64_tr_b16 v[190:191], v33 offset:8704
    v_mfma_f32_16x16x32_bf16 v[172:175], v[50:53], v[76:79], v[172:175]
    ds_read_b64_tr_b16 v[192:193], v34 offset:8192
    s_mov_b32 s54, 0x2090a0
    buffer_load_dwordx4 v[116:119], v41, s[24:27], s54 offen offset:0 sc1
    v_mfma_f32_16x16x32_bf16 v[144:147], v[54:57], v[68:71], v[144:147]
    ds_read_b64_tr_b16 v[194:195], v34 offset:8704
    v_mfma_f32_16x16x32_bf16 v[160:163], v[54:57], v[72:75], v[160:163]
    ds_read_b64_tr_b16 v[196:197], v35 offset:8192
    v_mfma_f32_16x16x32_bf16 v[176:179], v[54:57], v[76:79], v[176:179]
    ds_read_b64_tr_b16 v[198:199], v35 offset:8704
    v_mfma_f32_16x16x32_bf16 v[148:151], v[58:61], v[68:71], 0
    ds_read_b64_tr_b16 v[200:201], v36 offset:8192
    buffer_load_dwordx4 v[120:123], v41, s[24:27], s54 offen offset:512 sc1
    v_mfma_f32_16x16x32_bf16 v[164:167], v[58:61], v[72:75], 0
    ds_read_b64_tr_b16 v[202:203], v36 offset:8704
    v_mfma_f32_16x16x32_bf16 v[180:183], v[58:61], v[76:79], 0
    v_mfma_f32_16x16x32_bf16 v[152:155], v[62:65], v[68:71], 0
    v_mfma_f32_16x16x32_bf16 v[168:171], v[62:65], v[72:75], 0
    buffer_load_dwordx4 v[124:127], v41, s[24:27], s54 offen offset:1024 sc1
    v_mfma_f32_16x16x32_bf16 v[184:187], v[62:65], v[76:79], 0
    s_waitcnt vmcnt(9) lgkmcnt(0)
    s_nop 0
    v_mfma_f32_16x16x32_bf16 v[140:143], v[188:191], v[80:83], v[140:143]
    ds_read_b64_tr_b16 v[50:51], v33 offset:16384
    v_mfma_f32_16x16x32_bf16 v[156:159], v[188:191], v[84:87], v[156:159]
    ds_read_b64_tr_b16 v[52:53], v33 offset:16896
    v_mfma_f32_16x16x32_bf16 v[172:175], v[188:191], v[88:91], v[172:175]
    ds_read_b64_tr_b16 v[54:55], v34 offset:16384
    s_mov_b32 s54, 0x24b480
    buffer_load_dwordx4 v[128:131], v41, s[24:27], s54 offen offset:0 sc1
    v_mfma_f32_16x16x32_bf16 v[144:147], v[192:195], v[80:83], v[144:147]
    ds_read_b64_tr_b16 v[56:57], v34 offset:16896
    v_mfma_f32_16x16x32_bf16 v[160:163], v[192:195], v[84:87], v[160:163]
    ds_read_b64_tr_b16 v[58:59], v35 offset:16384
    v_mfma_f32_16x16x32_bf16 v[176:179], v[192:195], v[88:91], v[176:179]
    ds_read_b64_tr_b16 v[60:61], v35 offset:16896
    v_mfma_f32_16x16x32_bf16 v[148:151], v[196:199], v[80:83], v[148:151]
    ds_read_b64_tr_b16 v[62:63], v36 offset:16384
    buffer_load_dwordx4 v[132:135], v41, s[24:27], s54 offen offset:512 sc1
    v_mfma_f32_16x16x32_bf16 v[164:167], v[196:199], v[84:87], v[164:167]
    ds_read_b64_tr_b16 v[64:65], v36 offset:16896
    v_mfma_f32_16x16x32_bf16 v[180:183], v[196:199], v[88:91], v[180:183]
    v_mfma_f32_16x16x32_bf16 v[152:155], v[200:203], v[80:83], v[152:155]
    v_mfma_f32_16x16x32_bf16 v[168:171], v[200:203], v[84:87], v[168:171]
    buffer_load_dwordx4 v[136:139], v41, s[24:27], s54 offen offset:1024 sc1
    v_mfma_f32_16x16x32_bf16 v[184:187], v[200:203], v[88:91], v[184:187]
    s_waitcnt vmcnt(9) lgkmcnt(0)
    s_nop 0
    v_mfma_f32_16x16x32_bf16 v[140:143], v[50:53], v[92:95], v[140:143]
    ds_read_b64_tr_b16 v[188:189], v33 offset:24576
    v_mfma_f32_16x16x32_bf16 v[156:159], v[50:53], v[96:99], v[156:159]
    ds_read_b64_tr_b16 v[190:191], v33 offset:25088
    v_mfma_f32_16x16x32_bf16 v[172:175], v[50:53], v[100:103], v[172:175]
    ds_read_b64_tr_b16 v[192:193], v34 offset:24576
    s_mov_b32 s54, 0x28d880
    buffer_load_dwordx4 v[68:71], v41, s[24:27], s54 offen offset:0 sc1
    v_mfma_f32_16x16x32_bf16 v[144:147], v[54:57], v[92:95], v[144:147]
    ds_read_b64_tr_b16 v[194:195], v34 offset:25088
    v_mfma_f32_16x16x32_bf16 v[160:163], v[54:57], v[96:99], v[160:163]
    ds_read_b64_tr_b16 v[196:197], v35 offset:24576
    v_mfma_f32_16x16x32_bf16 v[176:179], v[54:57], v[100:103], v[176:179]
    ds_read_b64_tr_b16 v[198:199], v35 offset:25088
    v_mfma_f32_16x16x32_bf16 v[148:151], v[58:61], v[92:95], v[148:151]
    ds_read_b64_tr_b16 v[200:201], v36 offset:24576
    buffer_load_dwordx4 v[72:75], v41, s[24:27], s54 offen offset:512 sc1
    v_mfma_f32_16x16x32_bf16 v[164:167], v[58:61], v[96:99], v[164:167]
    ds_read_b64_tr_b16 v[202:203], v36 offset:25088
    v_mfma_f32_16x16x32_bf16 v[180:183], v[58:61], v[100:103], v[180:183]
    v_mfma_f32_16x16x32_bf16 v[152:155], v[62:65], v[92:95], v[152:155]
    v_mfma_f32_16x16x32_bf16 v[168:171], v[62:65], v[96:99], v[168:171]
    buffer_load_dwordx4 v[76:79], v41, s[24:27], s54 offen offset:1024 sc1
    v_mfma_f32_16x16x32_bf16 v[184:187], v[62:65], v[100:103], v[184:187]
    s_waitcnt vmcnt(9) lgkmcnt(0)
    s_nop 0
    v_mfma_f32_16x16x32_bf16 v[140:143], v[188:191], v[104:107], v[140:143]
    ds_read_b64_tr_b16 v[50:51], v37 offset:0
    v_mfma_f32_16x16x32_bf16 v[156:159], v[188:191], v[108:111], v[156:159]
    ds_read_b64_tr_b16 v[52:53], v37 offset:512
    v_mfma_f32_16x16x32_bf16 v[172:175], v[188:191], v[112:115], v[172:175]
    ds_read_b64_tr_b16 v[54:55], v38 offset:0
    s_mov_b32 s54, 0x2cfc80
    buffer_load_dwordx4 v[80:83], v41, s[24:27], s54 offen offset:0 sc1
    v_mfma_f32_16x16x32_bf16 v[144:147], v[192:195], v[104:107], v[144:147]
    ds_read_b64_tr_b16 v[56:57], v38 offset:512
    v_mfma_f32_16x16x32_bf16 v[160:163], v[192:195], v[108:111], v[160:163]
    ds_read_b64_tr_b16 v[58:59], v39 offset:0
    v_mfma_f32_16x16x32_bf16 v[176:179], v[192:195], v[112:115], v[176:179]
    ds_read_b64_tr_b16 v[60:61], v39 offset:512
    v_mfma_f32_16x16x32_bf16 v[148:151], v[196:199], v[104:107], v[148:151]
    ds_read_b64_tr_b16 v[62:63], v40 offset:0
    buffer_load_dwordx4 v[84:87], v41, s[24:27], s54 offen offset:512 sc1
    v_mfma_f32_16x16x32_bf16 v[164:167], v[196:199], v[108:111], v[164:167]
    ds_read_b64_tr_b16 v[64:65], v40 offset:512
    v_mfma_f32_16x16x32_bf16 v[180:183], v[196:199], v[112:115], v[180:183]
    v_mfma_f32_16x16x32_bf16 v[152:155], v[200:203], v[104:107], v[152:155]
    v_mfma_f32_16x16x32_bf16 v[168:171], v[200:203], v[108:111], v[168:171]
    buffer_load_dwordx4 v[88:91], v41, s[24:27], s54 offen offset:1024 sc1
    v_mfma_f32_16x16x32_bf16 v[184:187], v[200:203], v[112:115], v[184:187]
    s_waitcnt vmcnt(9) lgkmcnt(0)
    s_barrier
    v_mfma_f32_16x16x32_bf16 v[140:143], v[50:53], v[116:119], v[140:143]
    ds_read_b64_tr_b16 v[188:189], v37 offset:8192
    v_mfma_f32_16x16x32_bf16 v[156:159], v[50:53], v[120:123], v[156:159]
    ds_read_b64_tr_b16 v[190:191], v37 offset:8704
    v_mfma_f32_16x16x32_bf16 v[172:175], v[50:53], v[124:127], v[172:175]
    ds_read_b64_tr_b16 v[192:193], v38 offset:8192
    s_mov_b32 s54, 0x312080
    buffer_load_dwordx4 v[92:95], v41, s[24:27], s54 offen offset:0 sc1
    v_mfma_f32_16x16x32_bf16 v[144:147], v[54:57], v[116:119], v[144:147]
    ds_read_b64_tr_b16 v[194:195], v38 offset:8704
    v_mfma_f32_16x16x32_bf16 v[160:163], v[54:57], v[120:123], v[160:163]
    ds_read_b64_tr_b16 v[196:197], v39 offset:8192
    v_mfma_f32_16x16x32_bf16 v[176:179], v[54:57], v[124:127], v[176:179]
    ds_read_b64_tr_b16 v[198:199], v39 offset:8704
    v_mfma_f32_16x16x32_bf16 v[148:151], v[58:61], v[116:119], v[148:151]
    ds_read_b64_tr_b16 v[200:201], v40 offset:8192
    buffer_load_dwordx4 v[96:99], v41, s[24:27], s54 offen offset:512 sc1
    v_mfma_f32_16x16x32_bf16 v[164:167], v[58:61], v[120:123], v[164:167]
    ds_read_b64_tr_b16 v[202:203], v40 offset:8704
    v_mfma_f32_16x16x32_bf16 v[180:183], v[58:61], v[124:127], v[180:183]
    v_mfma_f32_16x16x32_bf16 v[152:155], v[62:65], v[116:119], v[152:155]
    v_mfma_f32_16x16x32_bf16 v[168:171], v[62:65], v[120:123], v[168:171]
    buffer_load_dwordx4 v[100:103], v41, s[24:27], s54 offen offset:1024 sc1
    v_mfma_f32_16x16x32_bf16 v[184:187], v[62:65], v[124:127], v[184:187]
    s_waitcnt vmcnt(9) lgkmcnt(0)
    s_nop 0
    v_mfma_f32_16x16x32_bf16 v[140:143], v[188:191], v[128:131], v[140:143]
    ds_read_b64_tr_b16 v[50:51], v37 offset:16384
    v_mfma_f32_16x16x32_bf16 v[156:159], v[188:191], v[132:135], v[156:159]
    ds_read_b64_tr_b16 v[52:53], v37 offset:16896
    v_mfma_f32_16x16x32_bf16 v[172:175], v[188:191], v[136:139], v[172:175]
    ds_read_b64_tr_b16 v[54:55], v38 offset:16384
    s_mov_b32 s54, 0x354480
    buffer_load_dwordx4 v[104:107], v41, s[24:27], s54 offen offset:0 sc1
    v_mfma_f32_16x16x32_bf16 v[144:147], v[192:195], v[128:131], v[144:147]
    ds_read_b64_tr_b16 v[56:57], v38 offset:16896
    v_mfma_f32_16x16x32_bf16 v[160:163], v[192:195], v[132:135], v[160:163]
    ds_read_b64_tr_b16 v[58:59], v39 offset:16384
    v_mfma_f32_16x16x32_bf16 v[176:179], v[192:195], v[136:139], v[176:179]
    ds_read_b64_tr_b16 v[60:61], v39 offset:16896
    v_mfma_f32_16x16x32_bf16 v[148:151], v[196:199], v[128:131], v[148:151]
    ds_read_b64_tr_b16 v[62:63], v40 offset:16384
    buffer_load_dwordx4 v[108:111], v41, s[24:27], s54 offen offset:512 sc1
    v_mfma_f32_16x16x32_bf16 v[164:167], v[196:199], v[132:135], v[164:167]
    ds_read_b64_tr_b16 v[64:65], v40 offset:16896
    v_mfma_f32_16x16x32_bf16 v[180:183], v[196:199], v[136:139], v[180:183]
    v_mfma_f32_16x16x32_bf16 v[152:155], v[200:203], v[128:131], v[152:155]
    v_mfma_f32_16x16x32_bf16 v[168:171], v[200:203], v[132:135], v[168:171]
    buffer_load_dwordx4 v[112:115], v41, s[24:27], s54 offen offset:1024 sc1
    v_mfma_f32_16x16x32_bf16 v[184:187], v[200:203], v[136:139], v[184:187]
    s_waitcnt vmcnt(9) lgkmcnt(0)
    s_nop 0
    v_mfma_f32_16x16x32_bf16 v[140:143], v[50:53], v[68:71], v[140:143]
    ds_read_b64_tr_b16 v[188:189], v37 offset:24576
    v_mfma_f32_16x16x32_bf16 v[156:159], v[50:53], v[72:75], v[156:159]
    ds_read_b64_tr_b16 v[190:191], v37 offset:25088
    v_mfma_f32_16x16x32_bf16 v[172:175], v[50:53], v[76:79], v[172:175]
    ds_read_b64_tr_b16 v[192:193], v38 offset:24576
    v_mfma_f32_16x16x32_bf16 v[144:147], v[54:57], v[68:71], v[144:147]
    ds_read_b64_tr_b16 v[194:195], v38 offset:25088
    v_mfma_f32_16x16x32_bf16 v[160:163], v[54:57], v[72:75], v[160:163]
    ds_read_b64_tr_b16 v[196:197], v39 offset:24576
    v_mfma_f32_16x16x32_bf16 v[176:179], v[54:57], v[76:79], v[176:179]
    ds_read_b64_tr_b16 v[198:199], v39 offset:25088
    v_mfma_f32_16x16x32_bf16 v[148:151], v[58:61], v[68:71], v[148:151]
    ds_read_b64_tr_b16 v[200:201], v40 offset:24576
    v_mfma_f32_16x16x32_bf16 v[164:167], v[58:61], v[72:75], v[164:167]
    ds_read_b64_tr_b16 v[202:203], v40 offset:25088
    v_mfma_f32_16x16x32_bf16 v[180:183], v[58:61], v[76:79], v[180:183]
    v_mfma_f32_16x16x32_bf16 v[152:155], v[62:65], v[68:71], v[152:155]
    v_mfma_f32_16x16x32_bf16 v[168:171], v[62:65], v[72:75], v[168:171]
    v_mfma_f32_16x16x32_bf16 v[184:187], v[62:65], v[76:79], v[184:187]
    s_waitcnt vmcnt(6) lgkmcnt(0)
    s_nop 0
    v_mfma_f32_16x16x32_bf16 v[140:143], v[188:191], v[80:83], v[140:143]
    ds_read_b64_tr_b16 v[50:51], v37 offset:32768
    v_mfma_f32_16x16x32_bf16 v[156:159], v[188:191], v[84:87], v[156:159]
    ds_read_b64_tr_b16 v[52:53], v37 offset:33280
    v_mfma_f32_16x16x32_bf16 v[172:175], v[188:191], v[88:91], v[172:175]
    ds_read_b64_tr_b16 v[54:55], v38 offset:32768
    v_mfma_f32_16x16x32_bf16 v[144:147], v[192:195], v[80:83], v[144:147]
    ds_read_b64_tr_b16 v[56:57], v38 offset:33280
    v_mfma_f32_16x16x32_bf16 v[160:163], v[192:195], v[84:87], v[160:163]
    ds_read_b64_tr_b16 v[58:59], v39 offset:32768
    v_mfma_f32_16x16x32_bf16 v[176:179], v[192:195], v[88:91], v[176:179]
    ds_read_b64_tr_b16 v[60:61], v39 offset:33280
    v_mfma_f32_16x16x32_bf16 v[148:151], v[196:199], v[80:83], v[148:151]
    ds_read_b64_tr_b16 v[62:63], v40 offset:32768
    v_mfma_f32_16x16x32_bf16 v[164:167], v[196:199], v[84:87], v[164:167]
    ds_read_b64_tr_b16 v[64:65], v40 offset:33280
    v_mfma_f32_16x16x32_bf16 v[180:183], v[196:199], v[88:91], v[180:183]
    v_mfma_f32_16x16x32_bf16 v[152:155], v[200:203], v[80:83], v[152:155]
    v_mfma_f32_16x16x32_bf16 v[168:171], v[200:203], v[84:87], v[168:171]
    v_mfma_f32_16x16x32_bf16 v[184:187], v[200:203], v[88:91], v[184:187]
    s_waitcnt vmcnt(3) lgkmcnt(0)
    s_nop 0
    v_mfma_f32_16x16x32_bf16 v[140:143], v[50:53], v[92:95], v[140:143]
    ds_read_b64_tr_b16 v[188:189], v37 offset:40960
    v_mfma_f32_16x16x32_bf16 v[156:159], v[50:53], v[96:99], v[156:159]
    ds_read_b64_tr_b16 v[190:191], v37 offset:41472
    v_mfma_f32_16x16x32_bf16 v[172:175], v[50:53], v[100:103], v[172:175]
    ds_read_b64_tr_b16 v[192:193], v38 offset:40960
    v_mfma_f32_16x16x32_bf16 v[144:147], v[54:57], v[92:95], v[144:147]
    ds_read_b64_tr_b16 v[194:195], v38 offset:41472
    v_mfma_f32_16x16x32_bf16 v[160:163], v[54:57], v[96:99], v[160:163]
    ds_read_b64_tr_b16 v[196:197], v39 offset:40960
    v_mfma_f32_16x16x32_bf16 v[176:179], v[54:57], v[100:103], v[176:179]
    ds_read_b64_tr_b16 v[198:199], v39 offset:41472
    v_mfma_f32_16x16x32_bf16 v[148:151], v[58:61], v[92:95], v[148:151]
    ds_read_b64_tr_b16 v[200:201], v40 offset:40960
    v_mfma_f32_16x16x32_bf16 v[164:167], v[58:61], v[96:99], v[164:167]
    ds_read_b64_tr_b16 v[202:203], v40 offset:41472
    v_mfma_f32_16x16x32_bf16 v[180:183], v[58:61], v[100:103], v[180:183]
    v_mfma_f32_16x16x32_bf16 v[152:155], v[62:65], v[92:95], v[152:155]
    v_mfma_f32_16x16x32_bf16 v[168:171], v[62:65], v[96:99], v[168:171]
    v_mfma_f32_16x16x32_bf16 v[184:187], v[62:65], v[100:103], v[184:187]
    s_waitcnt vmcnt(0) lgkmcnt(0)
    s_nop 0
    v_mfma_f32_16x16x32_bf16 v[148:151], v[196:199], v[104:107], v[148:151]
    v_mfma_f32_16x16x32_bf16 v[164:167], v[196:199], v[108:111], v[164:167]
    v_mfma_f32_16x16x32_bf16 v[180:183], v[196:199], v[112:115], v[180:183]
    v_mfma_f32_16x16x32_bf16 v[152:155], v[200:203], v[104:107], v[152:155]
    v_mfma_f32_16x16x32_bf16 v[168:171], v[200:203], v[108:111], v[168:171]
    v_mfma_f32_16x16x32_bf16 v[184:187], v[200:203], v[112:115], v[184:187]
    v_mfma_f32_16x16x32_bf16 v[140:143], v[188:191], v[104:107], v[140:143]
    v_mfma_f32_16x16x32_bf16 v[156:159], v[188:191], v[108:111], v[156:159]
    v_mfma_f32_16x16x32_bf16 v[172:175], v[188:191], v[112:115], v[172:175]
    ds_write_b128 v204, v[148:151] offset:0
    v_mfma_f32_16x16x32_bf16 v[144:147], v[192:195], v[104:107], v[144:147]
    ds_write_b128 v204, v[164:167] offset:2048
    v_mfma_f32_16x16x32_bf16 v[160:163], v[192:195], v[108:111], v[160:163]
    ds_write_b128 v204, v[180:183] offset:4096
    v_mfma_f32_16x16x32_bf16 v[176:179], v[192:195], v[112:115], v[176:179]
    ds_write_b128 v204, v[152:155] offset:1024
    ds_write_b128 v204, v[168:171] offset:3072
    ds_write_b128 v204, v[184:187] offset:5120
    s_waitcnt lgkmcnt(0)
    s_barrier
    ds_read_b128 v[206:209], v205 offset:0
    ds_read_b128 v[210:213], v205 offset:1024
    ds_read_b128 v[214:217], v205 offset:2048
    ds_read_b128 v[218:221], v205 offset:3072
    ds_read_b128 v[222:225], v205 offset:4096
    ds_read_b128 v[226:229], v205 offset:5120
    s_waitcnt lgkmcnt(4)
    v_add_f32 v140, v140, v206
    v_add_f32 v141, v141, v207
    v_add_f32 v142, v142, v208
    v_add_f32 v143, v143, v209
    v_add_f32 v144, v144, v210
    v_add_f32 v145, v145, v211
    v_add_f32 v146, v146, v212
    v_add_f32_e64 v147, v147, v213
    v_cvt_pk_bf16_f32 v68, v140, v141
    v_cvt_pk_bf16_f32 v69, v142, v143
    v_cvt_pk_bf16_f32 v70, v144, v145
    v_cvt_pk_bf16_f32 v71, v146, v147
    v_cvt_pk_bf16_f32 v14, v140, v141
    v_cvt_pk_bf16_f32 v15, v142, v143
    v_cvt_pk_bf16_f32 v16, v144, v145
    v_cvt_pk_bf16_f32 v17, v146, v147
    v_permlane16_swap_b32 v68, v70
    v_permlane16_swap_b32 v69, v71
    buffer_store_dwordx4 v[68:71], v66, s[24:27], 0 offen offset:0 sc1
    s_waitcnt lgkmcnt(2)
    v_add_f32 v156, v156, v214
    v_add_f32 v157, v157, v215
    v_add_f32 v158, v158, v216
    v_add_f32 v159, v159, v217
    v_add_f32 v160, v160, v218
    v_add_f32 v161, v161, v219
    v_add_f32 v162, v162, v220
    v_add_f32_e64 v163, v163, v221
    v_cvt_pk_bf16_f32 v72, v156, v157
    v_cvt_pk_bf16_f32 v73, v158, v159
    v_cvt_pk_bf16_f32 v74, v160, v161
    v_cvt_pk_bf16_f32 v75, v162, v163
    v_cvt_pk_bf16_f32 v18, v156, v157
    v_cvt_pk_bf16_f32 v19, v158, v159
    v_cvt_pk_bf16_f32 v20, v160, v161
    v_cvt_pk_bf16_f32 v21, v162, v163
    v_permlane16_swap_b32 v72, v74
    v_permlane16_swap_b32 v73, v75
    buffer_store_dwordx4 v[72:75], v66, s[24:27], 0 offen offset:512 sc1
    s_waitcnt lgkmcnt(0)
    v_add_f32 v172, v172, v222
    v_add_f32 v173, v173, v223
    v_add_f32 v174, v174, v224
    v_add_f32 v175, v175, v225
    v_add_f32 v176, v176, v226
    v_add_f32 v177, v177, v227
    v_add_f32 v178, v178, v228
    v_add_f32_e64 v179, v179, v229
    v_cvt_pk_bf16_f32 v76, v172, v173
    v_cvt_pk_bf16_f32 v77, v174, v175
    v_cvt_pk_bf16_f32 v78, v176, v177
    v_cvt_pk_bf16_f32 v79, v178, v179
    v_cvt_pk_bf16_f32 v22, v172, v173
    v_cvt_pk_bf16_f32 v23, v174, v175
    v_cvt_pk_bf16_f32 v24, v176, v177
    v_cvt_pk_bf16_f32 v25, v178, v179
    v_permlane16_swap_b32 v76, v78
    v_permlane16_swap_b32 v77, v79
    buffer_store_dwordx4 v[76:79], v66, s[24:27], 0 offen offset:1024 sc1
    v_add_f32 v80, v140, v141
    v_mul_f32 v84, v140, v140
    v_add_f32 v50, v142, v143
    v_mul_f32 v51, v141, v141
    v_add_f32 v80, v80, v144
    v_fmac_f32 v84, v142, v142
    v_add_f32 v50, v50, v145
    v_fmac_f32 v51, v143, v143
    v_add_f32 v80, v80, v146
    v_fmac_f32 v84, v144, v144
    v_add_f32 v50, v50, v147
    v_fmac_f32 v51, v145, v145
    v_fmac_f32 v84, v146, v146
    v_fmac_f32 v51, v147, v147
    v_add_f32 v80, v80, v50
    v_add_f32 v84, v84, v51
    v_add_f32 v81, v156, v157
    v_mul_f32 v85, v156, v156
    v_add_f32 v50, v158, v159
    v_mul_f32 v51, v157, v157
    v_add_f32 v81, v81, v160
    v_fmac_f32 v85, v158, v158
    v_add_f32 v50, v50, v161
    v_fmac_f32 v51, v159, v159
    v_add_f32 v81, v81, v162
    v_fmac_f32 v85, v160, v160
    v_add_f32 v50, v50, v163
    v_fmac_f32 v51, v161, v161
    v_fmac_f32 v85, v162, v162
    v_fmac_f32 v51, v163, v163
    v_add_f32 v81, v81, v50
    v_add_f32 v85, v85, v51
    v_add_f32 v82, v172, v173
    v_mul_f32 v86, v172, v172
    v_add_f32 v50, v174, v175
    v_mul_f32 v51, v173, v173
    v_add_f32 v82, v82, v176
    v_fmac_f32 v86, v174, v174
    v_add_f32 v50, v50, v177
    v_fmac_f32 v51, v175, v175
    v_add_f32 v82, v82, v178
    v_fmac_f32 v86, v176, v176
    v_add_f32 v50, v50, v179
    v_fmac_f32 v51, v177, v177
    v_fmac_f32 v86, v178, v178
    v_fmac_f32 v51, v179, v179
    v_add_f32 v82, v82, v50
    v_add_f32 v86, v86, v51
    v_mov_b32 v83, 0
    v_mov_b32 v87, 0
    v_permlane32_swap_b32 v80, v82
    v_permlane32_swap_b32 v81, v83
    v_permlane32_swap_b32 v84, v86
    v_permlane32_swap_b32 v85, v87
    v_add_f32 v80, v80, v82
    v_add_f32 v81, v81, v83
    v_add_f32 v84, v84, v86
    v_add_f32 v85, v85, v87
    v_permlane16_swap_b32 v80, v81
    s_nop 0
    v_permlane16_swap_b32 v84, v85
    v_add_f32 v58, v80, v81
    v_add_f32_e64 v59, v84, v85
    buffer_store_dwordx2 v[58:59], v48, s[24:27], 0 offen sc1
    s_add_u32 s48, s36, 8
    s_mul_i32 s55, s48, 49152
    s_mul_i32 m0, s48, 3072
    s_nop 0
    buffer_load_dwordx4 v42, s[16:19], s55 offen offset:0 lds
    buffer_load_dwordx4 v43, s[16:19], s55 offen offset:1024 lds
    buffer_load_dwordx4 v44, s[16:19], s55 offen offset:2048 lds
    s_add_u32 s48, s36, 12
    s_mul_i32 s55, s48, 49152
    s_mul_i32 m0, s48, 3072
    s_nop 0
    buffer_load_dwordx4 v42, s[16:19], s55 offen offset:0 lds
    buffer_load_dwordx4 v43, s[16:19], s55 offen offset:1024 lds
    buffer_load_dwordx4 v44, s[16:19], s55 offen offset:2048 lds
    s_add_u32 s48, s36, 16
    s_mul_i32 s55, s48, 49152
    s_mul_i32 m0, s48, 3072
    s_nop 0
    buffer_load_dwordx4 v42, s[16:19], s55 offen offset:0 lds
    buffer_load_dwordx4 v43, s[16:19], s55 offen offset:1024 lds
    buffer_load_dwordx4 v44, s[16:19], s55 offen offset:2048 lds
    s_waitcnt vmcnt(9)
    s_barrier
    s_lshl_b32 s48, s39, 11
    s_lshl_b32 s49, s40, 7
    s_add_u32 s48, s48, s49
    s_add_u32 s48, s48, 21037056
    s_cmp_lg_u32 s36, 0
    s_cbranch_scc1 L_sig_11
    v_mov_b32 v45, s45
    s_mov_b64 s[58:59], exec
    s_mov_b64 exec, 1
    buffer_store_dword v45, off, s[24:27], s48 sc1
    s_mov_b64 exec, s[58:59]
L_sig_11:
    s_add_u32 s48, s36, 0
    s_mul_i32 s55, s48, 49152
    s_mul_i32 m0, s48, 3072
    s_nop 0
    buffer_load_dwordx4 v42, s[16:19], s55 offen offset:0 lds
    buffer_load_dwordx4 v43, s[16:19], s55 offen offset:1024 lds
    buffer_load_dwordx4 v44, s[16:19], s55 offen offset:2048 lds
    s_add_u32 s48, s36, 4
    s_mul_i32 s55, s48, 49152
    s_mul_i32 m0, s48, 3072
    s_nop 0
    buffer_load_dwordx4 v42, s[16:19], s55 offen offset:0 lds
    buffer_load_dwordx4 v43, s[16:19], s55 offen offset:1024 lds
    buffer_load_dwordx4 v44, s[16:19], s55 offen offset:2048 lds
    s_add_u32 s48, s36, 20
    s_mul_i32 s55, s48, 49152
    s_mul_i32 m0, s48, 3072
    s_nop 0
    buffer_load_dwordx4 v42, s[16:19], s55 offen offset:0 lds
    buffer_load_dwordx4 v43, s[16:19], s55 offen offset:1024 lds
    buffer_load_dwordx4 v44, s[16:19], s55 offen offset:2048 lds
    s_add_u32 s48, s36, 24
    s_min_u32 s48, s48, 25
    s_mul_i32 s55, s48, 49152
    s_mul_i32 m0, s48, 3072
    s_nop 0
    buffer_load_dwordx4 v42, s[16:19], s55 offen offset:0 lds
    buffer_load_dwordx4 v43, s[16:19], s55 offen offset:1024 lds
    buffer_load_dwordx4 v44, s[16:19], s55 offen offset:2048 lds
    s_branch L_p3
L_p3only:
    s_nop 0
    s_mov_b32 s26, 0x10000000
    s_mov_b32 s27, 0x20000
    s_mov_b32 s34, 0x100
    s_mov_b32 s35, 0x20000
    s_mov_b32 s14, 0xc8000
    s_mov_b32 s15, 0x20000
    s_mov_b32 s18, 0x1e0000
    s_mov_b32 s19, 0x20000
    s_mov_b32 s22, 0x1e0000
    s_mov_b32 s23, 0x20000
    s_mov_b32 s30, 0x280000
    s_mov_b32 s31, 0x20000
    s_lshr_b32 s48, s47, 3
    s_lshr_b32 s43, s46, 1
    s_lshl_b32 s43, s43, 2
    s_add_u32 s43, s43, s48
    s_and_b32 s44, s47, 7
    s_and_b32 s48, s46, 1
    s_lshl_b32 s48, s48, 3
    s_add_u32 s44, s44, s48
    v_mov_b32 v28, 0xc0135761
    v_mov_b32 v29, 0xc0135761
    s_mov_b32 s66, 0xbdd2d3e8
    s_mov_b32 s67, 0xbdd2d3e8
    v_mov_b32 v26, 0x7ffffff0
    v_mov_b32 v27, 0x7ffffff0
    v_mov_b32 v41, 0
    s_waitcnt vmcnt(0) lgkmcnt(0)
    s_cmp_ge_u32 s46, 4
    s_cselect_b32 s48, 25, 30
    s_cselect_b32 s69, 28, 8
    s_sub_u32 s48, s47, s48
    s_lshl_b32 s48, s48, 2
    s_add_u32 s68, s48, s36
    s_mov_b32 s56, s68
    s_lshr_b32 s49, s46, 1
    s_mul_i32 s49, s49, 12
    s_and_b32 s50, s46, 1
    s_mul_i32 s50, s50, 640
L_pf_12:
    s_cmp_ge_u32 s56, 50
    s_cbranch_scc1 L_pfe_13
    s_add_u32 s48, s56, s49
    s_sub_u32 s51, s48, 50
    s_cselect_b32 s48, s48, s51
    s_add_u32 s48, s48, 0
    s_lshl_b32 s48, s48, 6
    v_add_u32 v45, s48, v0
    v_mul_u32_u24 v46, 52429, v45
    v_lshrrev_b32 v46, 18, v46
    v_mul_u32_u24 v47, 5, v46
    v_sub_u32_e64 v45, v45, v47
    v_mul_u32_u24 v46, 1280, v46
    v_lshl_add_u32 v45, v45, 7, v46
    buffer_load_dword v47, v45, s[12:15], s50 offen
    s_add_u32 s56, s56, s69
    s_waitcnt vmcnt(1)
    s_branch L_pf_12
L_pfe_13:
    s_waitcnt vmcnt(0)
    s_mov_b32 s56, s68
    s_lshr_b32 s49, s46, 1
    s_mul_i32 s49, s49, 19
    s_and_b32 s50, s46, 1
    s_mul_i32 s50, s50, 1536
L_pf_14:
    s_cmp_ge_u32 s56, 78
    s_cbranch_scc1 L_pfe_15
    s_add_u32 s48, s56, s49
    s_sub_u32 s51, s48, 78
    s_cselect_b32 s48, s48, s51
    s_add_u32 s48, s48, 0
    s_lshl_b32 s48, s48, 6
    v_add_u32 v45, s48, v0
    v_mul_u32_u24 v46, 43691, v45
    v_lshrrev_b32 v46, 19, v46
    v_mul_u32_u24 v47, 12, v46
    v_sub_u32_e64 v45, v45, v47
    v_mul_u32_u24 v46, 3072, v46
    v_lshl_add_u32 v45, v45, 7, v46
    buffer_load_dword v47, v45, s[16:19], s50 offen
    s_add_u32 s56, s56, s69
    s_waitcnt vmcnt(1)
    s_branch L_pf_14
L_pfe_15:
    s_waitcnt vmcnt(0)
    s_mov_b32 s56, s68
    s_lshr_b32 s49, s46, 1
    s_mul_i32 s49, s49, 12
    s_and_b32 s50, s46, 1
    s_mul_i32 s50, s50, 640
L_pf_16:
    s_cmp_ge_u32 s56, 50
    s_cbranch_scc1 L_pfe_17
    s_add_u32 s48, s56, s49
    s_sub_u32 s51, s48, 50
    s_cselect_b32 s48, s48, s51
    s_add_u32 s48, s48, 0
    s_lshl_b32 s48, s48, 6
    v_add_u32 v45, s48, v0
    v_mul_u32_u24 v46, 52429, v45
    v_lshrrev_b32 v46, 18, v46
    v_mul_u32_u24 v47, 5, v46
    v_sub_u32_e64 v45, v45, v47
    v_bfe_u32 v47, v46, 5, 4
    v_mul_u32_u24 v47, 96, v47
    v_lshrrev_b32_e64 v48, 9, v46
    v_lshl_add_u32 v47, v48, 5, v47
    v_and_b32 v46, 31, v46
    v_add_u32 v46, v46, v47
    v_mul_u32_u24 v46, 1280, v46
    v_lshl_add_u32 v45, v45, 7, v46
    buffer_load_dword v47, v45, s[20:23], s50 offen
    s_add_u32 s56, s56, s69
    s_waitcnt vmcnt(1)
    s_branch L_pf_16
L_pfe_17:
    s_waitcnt vmcnt(0)
    s_mov_b32 s56, s68
    s_lshr_b32 s49, s46, 1
    s_mul_i32 s49, s49, 0
    s_and_b32 s50, s46, 1
    s_mul_i32 s50, s50, 1536
L_pf_18:
    s_cmp_ge_u32 s56, 42
    s_cbranch_scc1 L_pfe_19
    s_add_u32 s48, s56, s49
    s_sub_u32 s51, s48, 42
    s_cselect_b32 s48, s48, s51
    s_add_u32 s48, s48, 78
    s_lshl_b32 s48, s48, 6
    v_add_u32_e64 v45, s48, v0
    v_mul_u32_u24 v46, 43691, v45
    v_lshrrev_b32 v46, 19, v46
    v_mul_u32_u24 v47, 12, v46
    v_sub_u32_e64 v45, v45, v47
    v_mul_u32_u24 v46, 3072, v46
    v_lshl_add_u32 v45, v45, 7, v46
    buffer_load_dword v47, v45, s[16:19], s50 offen
    s_add_u32 s56, s56, s69
    s_waitcnt vmcnt(1)
    s_branch L_pf_18
L_pfe_19:
    s_waitcnt vmcnt(0)
    buffer_load_dwordx2 v[30:31], off, s[32:35], 0 sc1
    s_mul_i32 s48, s44, 192
    v_add_u32_e64 v45, 0, v0
    v_mul_u32_u24 v46, 5462, v45
    v_lshrrev_b32 v46, 16, v46
    v_mul_u32_u24 v42, 12, v46
    v_sub_u32_e64 v45, v45, v42
    v_mul_u32_u24 v46, 3072, v46
    v_lshl_add_u32 v45, v45, 4, v46
    v_add_u32 v42, s48, v45
    v_add_u32 v45, 64, v0
    v_mul_u32_u24 v46, 5462, v45
    v_lshrrev_b32 v46, 16, v46
    v_mul_u32_u24 v43, 12, v46
    v_sub_u32_e64 v45, v45, v43
    v_mul_u32_u24 v46, 3072, v46
    v_lshl_add_u32 v45, v45, 4, v46
    v_add_u32_e64 v43, s48, v45
    v_subrev_u32 v43, 1024, v43
    v_add_u32 v45, 128, v0
    v_mul_u32_u24 v46, 5462, v45
    v_lshrrev_b32 v46, 16, v46
    v_mul_u32_u24 v44, 12, v46
    v_sub_u32_e64 v45, v45, v44
    v_mul_u32_u24 v46, 3072, v46
    v_lshl_add_u32 v45, v45, 4, v46
    v_add_u32_e64 v44, s48, v45
    v_subrev_u32 v44, 2048, v44
    s_waitcnt vmcnt(0) lgkmcnt(0)
    s_mov_b32 s56, 0
L_nv_20:
    v_readfirstlane_b32 s48, v31
    v_readfirstlane_b32 s45, v30
    s_add_u32 s56, s56, 1
    s_cmp_lg_u32 s48, 0
    s_cbranch_scc1 L_nvok_21
    s_sleep 2
    buffer_load_dwordx2 v[30:31], off, s[32:35], 0 sc1
    s_waitcnt vmcnt(0)
    s_cmp_lt_u32 s56, 100000
    s_cbranch_scc1 L_nv_20
L_nvok_21:
    s_add_u32 s48, s36, 0
    s_mul_i32 s55, s48, 49152
    s_mul_i32 m0, s48, 3072
    s_nop 0
    buffer_load_dwordx4 v42, s[16:19], s55 offen offset:0 lds
    buffer_load_dwordx4 v43, s[16:19], s55 offen offset:1024 lds
    buffer_load_dwordx4 v44, s[16:19], s55 offen offset:2048 lds
    s_add_u32 s48, s36, 4
    s_mul_i32 s55, s48, 49152
    s_mul_i32 m0, s48, 3072
    s_nop 0
    buffer_load_dwordx4 v42, s[16:19], s55 offen offset:0 lds
    buffer_load_dwordx4 v43, s[16:19], s55 offen offset:1024 lds
    buffer_load_dwordx4 v44, s[16:19], s55 offen offset:2048 lds
    s_add_u32 s48, s36, 8
    s_mul_i32 s55, s48, 49152
    s_mul_i32 m0, s48, 3072
    s_nop 0
    buffer_load_dwordx4 v42, s[16:19], s55 offen offset:0 lds
    buffer_load_dwordx4 v43, s[16:19], s55 offen offset:1024 lds
    buffer_load_dwordx4 v44, s[16:19], s55 offen offset:2048 lds
    s_add_u32 s48, s36, 12
    s_mul_i32 s55, s48, 49152
    s_mul_i32 m0, s48, 3072
    s_nop 0
    buffer_load_dwordx4 v42, s[16:19], s55 offen offset:0 lds
    buffer_load_dwordx4 v43, s[16:19], s55 offen offset:1024 lds
    buffer_load_dwordx4 v44, s[16:19], s55 offen offset:2048 lds
    s_add_u32 s48, s36, 16
    s_mul_i32 s55, s48, 49152
    s_mul_i32 m0, s48, 3072
    s_nop 0
    buffer_load_dwordx4 v42, s[16:19], s55 offen offset:0 lds
    buffer_load_dwordx4 v43, s[16:19], s55 offen offset:1024 lds
    buffer_load_dwordx4 v44, s[16:19], s55 offen offset:2048 lds
    s_add_u32 s48, s36, 20
    s_mul_i32 s55, s48, 49152
    s_mul_i32 m0, s48, 3072
    s_nop 0
    buffer_load_dwordx4 v42, s[16:19], s55 offen offset:0 lds
    buffer_load_dwordx4 v43, s[16:19], s55 offen offset:1024 lds
    buffer_load_dwordx4 v44, s[16:19], s55 offen offset:2048 lds
    s_add_u32 s48, s36, 24
    s_min_u32 s48, s48, 25
    s_mul_i32 s55, s48, 49152
    s_mul_i32 m0, s48, 3072
    s_nop 0
    buffer_load_dwordx4 v42, s[16:19], s55 offen offset:0 lds
    buffer_load_dwordx4 v43, s[16:19], s55 offen offset:1024 lds
    buffer_load_dwordx4 v44, s[16:19], s55 offen offset:2048 lds
L_p3:
    s_mul_i32 s49, s36, 192
    s_lshl_b32 s48, s42, 12
    s_lshl_b32 s50, s41, 1
    s_add_u32 s48, s48, s50
    s_add_u32 s48, s48, 10485760
    v_add_u32 v45, s49, v0
    v_add_u32 v45, 0, v45
    v_mul_u32_u24 v46, 5462, v45
    v_lshrrev_b32 v46, 16, v46
    v_mul_u32_u24 v47, 12, v46
    v_sub_u32 v45, v45, v47
    v_lshlrev_b32 v46, 12, v46
    v_lshl_add_u32 v45, v45, 4, v46
    v_add_u32 v48, s48, v45
    v_add_u32 v45, s49, v0
    v_add_u32_e64 v45, 64, v45
    v_mul_u32_u24 v46, 5462, v45
    v_lshrrev_b32 v46, 16, v46
    v_mul_u32_u24 v47, 12, v46
    v_sub_u32 v45, v45, v47
    v_lshlrev_b32 v46, 12, v46
    v_lshl_add_u32 v45, v45, 4, v46
    v_add_u32_e64 v49, s48, v45
    v_subrev_u32 v49, 1024, v49
    v_add_u32_e64 v45, s49, v0
    v_add_u32 v45, 128, v45
    v_mul_u32_u24 v46, 5462, v45
    v_lshrrev_b32 v46, 16, v46
    v_mul_u32_u24 v47, 12, v46
    v_sub_u32 v45, v45, v47
    v_lshlrev_b32 v46, 12, v46
    v_lshl_add_u32 v45, v45, 4, v46
    v_add_u32_e64 v50, s48, v45
    v_subrev_u32 v50, 2048, v50
    v_bfe_u32 v45, v0, 2, 2
    v_lshl_add_u32 v45, v32, 2, v45
    s_lshl_b32 s48, s38, 5
    v_add_u32 v45, s48, v45
    v_mul_u32_u24 v45, 192, v45
    v_and_b32_e64 v46, 3, v0
    v_lshl_add_u32 v45, v46, 3, v45
    s_mul_i32 s48, s37, 96
    s_add_u32 s48, s48, 32768
    v_add_u32 v51, s48, v45
    s_lshl_b32 s48, s40, 11
    s_add_u32 s48, s48, 21168128
    s_cmp_eq_u32 s36, 0
    s_cselect_b32 s48, s48, 0x7efffff0
    v_lshl_add_u32 v52, v1, 7, s48
    s_mul_i32 s48, s36, 6144
    s_add_u32 s48, s48, 49152
    v_lshl_add_u32 v53, v0, 4, s48
    s_xor_b32 s48, s36, 1
    s_mul_i32 s48, s48, 6144
    s_add_u32 s48, s48, 49152
    v_lshl_add_u32 v54, v0, 4, s48
    s_mul_i32 s48, s37, 48
    s_add_u32 s48, s48, s41
    v_add_u32 v41, s48, v1
    v_lshlrev_b32 v41, 5, v41
    v_and_b32_e64 v55, 1, v32
    v_lshl_add_u32 v41, v55, 4, v41
    v_lshrrev_b32 v55, 1, v32
    s_mul_i32 s48, s38, 6
    v_add_u32_e64 v55, s48, v55
    v_mul_u32_u24 v55, 65536, v55
    v_add_u32_e64 v41, v41, v55
    v_lshl_add_u32 v45, v1, 6, s53
    v_bfe_u32 v46, v1, 1, 2
    v_lshrrev_b32 v47, 1, v32
    v_xor_b32 v46, v46, v47
    v_lshl_add_u32 v45, v46, 4, v45
    v_and_b32_e64 v47, 1, v32
    v_lshl_add_u32 v55, v47, 3, v45
    v_xor_b32 v56, 32, v55
    v_lshrrev_b32 v45, 2, v0
    v_bfe_u32 v46, v0, 3, 2
    v_and_b32 v47, 3, v0
    v_xor_b32 v46, v46, v47
    v_lshlrev_b32_e64 v46, 4, v46
    v_lshl_add_u32 v46, v45, 6, v46
    v_add_u32 v57, s53, v46
    s_mul_i32 s48, s37, 48
    s_add_u32 s48, s48, s41
    v_add_u32 v45, s48, v45
    v_mul_u32_u24 v45, 1280, v45
    v_lshl_add_u32 v45, v47, 4, v45
    s_lshl_b32 s48, s38, 5
    s_add_u32 s48, s48, s42
    s_lshl_b32 s48, s48, 1
    v_add_u32 v58, s48, v45
    s_lshl_b32 s48, s43, 7
    s_lshl_b32 s49, s36, 5
    s_add_u32 s48, s48, s49
    v_and_b32 v45, 31, v0
    v_add_u32 v45, s48, v45
    v_lshrrev_b32 v46, 5, v0
    v_lshlrev_b32_e64 v59, 5, v45
    v_lshl_add_u32 v59, v46, 4, v59
    s_mul_i32 s48, s44, 393216
    v_add_u32_e64 v63, s48, v59
    v_mul_u32_u24 v47, 168960, v46
    v_lshl_add_u32 v62, v45, 3, v47
    v_bfe_u32 v45, v0, 2, 2
    v_lshl_add_u32 v45, v46, 3, v45
    v_mul_u32_u24 v45, 192, v45
    v_bfe_u32 v47, v0, 4, 1
    v_lshl_add_u32 v45, v47, 5, v45
    v_and_b32_e64 v47, 3, v0
    v_lshl_add_u32 v60, v47, 3, v45
    v_add_u32 v61, 0x8000, v60
    s_mul_i32 s48, s43, 87424
    s_lshr_b32 s48, s48, 16
    s_lshl_b32 s48, s48, 11
    s_add_u32 s48, s48, 21037056
    v_lshl_add_u32 v45, v0, 7, s48
    s_mul_i32 s49, s44, 3
    s_lshr_b32 s49, s49, 1
    s_lshl_b32 s49, s49, 7
    s_add_u32 s49, s49, 21200896
    s_cmp_eq_u32 s36, 0
    s_cselect_b32 s49, s49, 0x7efffff0
    v_and_b32_e64 v47, 1, v0
    v_lshl_add_u32 v47, v47, 7, s49
    s_waitcnt vmcnt(0) lgkmcnt(0)
    s_cmp_lg_u32 s36, 0
    s_cbranch_scc1 L_np_22
    s_mov_b64 s[58:59], exec
    s_mov_b32 exec_lo, 0x03ff03ff
    s_mov_b32 exec_hi, 0
    s_mov_b32 s56, 0
L_poll_23:
    buffer_load_dword v46, v45, s[24:27], 0 offen sc1
    s_waitcnt vmcnt(0)
    v_cmp_ne_u32_e64 vcc, s45, v46
    s_add_u32 s56, s56, 1
    s_nop 2
    s_cbranch_vccz L_polled_24
    s_cmp_lt_u32 s56, 100000
    s_cbranch_scc1 L_poll_23
L_polled_24:
    s_mov_b64 exec, s[58:59]
L_np_22:
    s_barrier
    s_nop 0
    s_mov_b32 s54, 0x700080
    buffer_load_dwordx4 v[64:67], v59, s[24:27], s54 offen sc1
    s_mov_b32 s54, 0x710980
    buffer_load_dwordx4 v[68:71], v59, s[24:27], s54 offen sc1
    s_mov_b32 s54, 0x721280
    buffer_load_dwordx4 v[72:75], v59, s[24:27], s54 offen sc1
    s_mov_b32 s54, 0x731b80
    buffer_load_dwordx4 v[76:79], v59, s[24:27], s54 offen sc1
    s_mov_b32 s54, 0x742480
    buffer_load_dwordx4 v[80:83], v59, s[24:27], s54 offen sc1
    s_mov_b32 s54, 0x752d80
    buffer_load_dwordx4 v[84:87], v59, s[24:27], s54 offen sc1
    s_mov_b32 s54, 0x763680
    buffer_load_dwordx4 v[88:91], v59, s[24:27], s54 offen sc1
    s_mov_b32 s54, 0x773f80
    buffer_load_dwordx4 v[92:95], v59, s[24:27], s54 offen sc1
    s_mov_b32 s54, 0x784880
    buffer_load_dwordx4 v[96:99], v59, s[24:27], s54 offen sc1
    s_mov_b32 s54, 0x795180
    buffer_load_dwordx4 v[100:103], v59, s[24:27], s54 offen sc1
    s_mov_b32 s54, 0x7a5a80
    buffer_load_dwordx4 v[104:107], v59, s[24:27], s54 offen sc1
    s_mov_b32 s54, 0x7b6380
    buffer_load_dwordx4 v[108:111], v59, s[24:27], s54 offen sc1
    ds_read_b64_tr_b16 v[192:193], v60 offset:0
    ds_read_b64_tr_b16 v[194:195], v60 offset:768
    ds_read_b64_tr_b16 v[196:197], v60 offset:64
    ds_read_b64_tr_b16 v[198:199], v60 offset:832
    ds_read_b64_tr_b16 v[200:201], v60 offset:128
    ds_read_b64_tr_b16 v[202:203], v60 offset:896
    v_lshlrev_b32 v45, 4, v0
    v_lshrrev_b32_e64 v236, 5, v0
    s_lshl_b32 s49, s36, 9
    s_add_u32 s49, s49, 79872
    v_lshl_add_u32 v236, v236, 4, s49
    s_mov_b32 s64, 0x3acccccd
    s_mov_b32 s70, 0x3727c5ac
    s_waitcnt vmcnt(11) lgkmcnt(4)
    v_mfma_f32_32x32x16_bf16 v[144:159], v[192:195], v[64:67], 0
    ds_read_b64_tr_b16 v[204:205], v60 offset:3072
    ds_read_b64_tr_b16 v[206:207], v60 offset:3840
    s_waitcnt lgkmcnt(4)
    v_mfma_f32_32x32x16_bf16 v[160:175], v[196:199], v[64:67], 0
    ds_read_b64_tr_b16 v[208:209], v60 offset:3136
    ds_read_b64_tr_b16 v[210:211], v60 offset:3904
    s_waitcnt lgkmcnt(4)
    v_mfma_f32_32x32x16_bf16 v[176:191], v[200:203], v[64:67], 0
    ds_read_b64_tr_b16 v[212:213], v60 offset:3200
    ds_read_b64_tr_b16 v[214:215], v60 offset:3968
    s_mov_b32 s54, 0x7c6c80
    buffer_load_dwordx4 v[112:115], v59, s[24:27], s54 offen sc1
    s_waitcnt vmcnt(11) lgkmcnt(4)
    v_mfma_f32_32x32x16_bf16 v[144:159], v[204:207], v[68:71], v[144:159]
    ds_read_b64_tr_b16 v[192:193], v60 offset:6144
    ds_read_b64_tr_b16 v[194:195], v60 offset:6912
    s_waitcnt lgkmcnt(4)
    v_mfma_f32_32x32x16_bf16 v[160:175], v[208:211], v[68:71], v[160:175]
    ds_read_b64_tr_b16 v[196:197], v60 offset:6208
    ds_read_b64_tr_b16 v[198:199], v60 offset:6976
    s_waitcnt lgkmcnt(4)
    v_mfma_f32_32x32x16_bf16 v[176:191], v[212:215], v[68:71], v[176:191]
    ds_read_b64_tr_b16 v[200:201], v60 offset:6272
    ds_read_b64_tr_b16 v[202:203], v60 offset:7040
    s_mov_b32 s54, 0x7d7580
    buffer_load_dwordx4 v[116:119], v59, s[24:27], s54 offen sc1
    s_waitcnt vmcnt(11) lgkmcnt(4)
    v_mfma_f32_32x32x16_bf16 v[144:159], v[192:195], v[72:75], v[144:159]
    ds_read_b64_tr_b16 v[204:205], v60 offset:9216
    ds_read_b64_tr_b16 v[206:207], v60 offset:9984
    s_waitcnt lgkmcnt(4)
    v_mfma_f32_32x32x16_bf16 v[160:175], v[196:199], v[72:75], v[160:175]
    ds_read_b64_tr_b16 v[208:209], v60 offset:9280
    ds_read_b64_tr_b16 v[210:211], v60 offset:10048
    s_waitcnt lgkmcnt(4)
    v_mfma_f32_32x32x16_bf16 v[176:191], v[200:203], v[72:75], v[176:191]
    ds_read_b64_tr_b16 v[212:213], v60 offset:9344
    ds_read_b64_tr_b16 v[214:215], v60 offset:10112
    s_mov_b32 s54, 0x7e7e80
    buffer_load_dwordx4 v[120:123], v59, s[24:27], s54 offen sc1
    s_waitcnt vmcnt(11) lgkmcnt(4)
    v_mfma_f32_32x32x16_bf16 v[144:159], v[204:207], v[76:79], v[144:159]
    ds_read_b64_tr_b16 v[192:193], v60 offset:12288
    ds_read_b64_tr_b16 v[194:195], v60 offset:13056
    s_waitcnt lgkmcnt(4)
    v_mfma_f32_32x32x16_bf16 v[160:175], v[208:211], v[76:79], v[160:175]
    ds_read_b64_tr_b16 v[196:197], v60 offset:12352
    ds_read_b64_tr_b16 v[198:199], v60 offset:13120
    s_waitcnt lgkmcnt(4)
    v_mfma_f32_32x32x16_bf16 v[176:191], v[212:215], v[76:79], v[176:191]
    ds_read_b64_tr_b16 v[200:201], v60 offset:12416
    ds_read_b64_tr_b16 v[202:203], v60 offset:13184
    s_mov_b32 s54, 0x7f8780
    buffer_load_dwordx4 v[124:127], v59, s[24:27], s54 offen sc1
    s_waitcnt vmcnt(11) lgkmcnt(4)
    v_mfma_f32_32x32x16_bf16 v[144:159], v[192:195], v[80:83], v[144:159]
    ds_read_b64_tr_b16 v[204:205], v60 offset:15360
    ds_read_b64_tr_b16 v[206:207], v60 offset:16128
    s_waitcnt lgkmcnt(4)
    v_mfma_f32_32x32x16_bf16 v[160:175], v[196:199], v[80:83], v[160:175]
    ds_read_b64_tr_b16 v[208:209], v60 offset:15424
    ds_read_b64_tr_b16 v[210:211], v60 offset:16192
    s_waitcnt lgkmcnt(4)
    v_mfma_f32_32x32x16_bf16 v[176:191], v[200:203], v[80:83], v[176:191]
    ds_read_b64_tr_b16 v[212:213], v60 offset:15488
    ds_read_b64_tr_b16 v[214:215], v60 offset:16256
    s_mov_b32 s54, 0x809080
    buffer_load_dwordx4 v[64:67], v59, s[24:27], s54 offen sc1
    s_waitcnt vmcnt(11) lgkmcnt(4)
    v_mfma_f32_32x32x16_bf16 v[144:159], v[204:207], v[84:87], v[144:159]
    ds_read_b64_tr_b16 v[192:193], v60 offset:18432
    ds_read_b64_tr_b16 v[194:195], v60 offset:19200
    s_waitcnt lgkmcnt(4)
    v_mfma_f32_32x32x16_bf16 v[160:175], v[208:211], v[84:87], v[160:175]
    ds_read_b64_tr_b16 v[196:197], v60 offset:18496
    ds_read_b64_tr_b16 v[198:199], v60 offset:19264
    s_waitcnt lgkmcnt(4)
    v_mfma_f32_32x32x16_bf16 v[176:191], v[212:215], v[84:87], v[176:191]
    ds_read_b64_tr_b16 v[200:201], v60 offset:18560
    ds_read_b64_tr_b16 v[202:203], v60 offset:19328
    s_mov_b32 s54, 0x819980
    buffer_load_dwordx4 v[68:71], v59, s[24:27], s54 offen sc1
    s_waitcnt vmcnt(11) lgkmcnt(4)
    v_mfma_f32_32x32x16_bf16 v[144:159], v[192:195], v[88:91], v[144:159]
    ds_read_b64_tr_b16 v[204:205], v60 offset:21504
    ds_read_b64_tr_b16 v[206:207], v60 offset:22272
    s_waitcnt lgkmcnt(4)
    v_mfma_f32_32x32x16_bf16 v[160:175], v[196:199], v[88:91], v[160:175]
    ds_read_b64_tr_b16 v[208:209], v60 offset:21568
    ds_read_b64_tr_b16 v[210:211], v60 offset:22336
    s_waitcnt lgkmcnt(4)
    v_mfma_f32_32x32x16_bf16 v[176:191], v[200:203], v[88:91], v[176:191]
    ds_read_b64_tr_b16 v[212:213], v60 offset:21632
    ds_read_b64_tr_b16 v[214:215], v60 offset:22400
    s_mov_b32 s54, 0x82a280
    buffer_load_dwordx4 v[72:75], v59, s[24:27], s54 offen sc1
    s_waitcnt vmcnt(11) lgkmcnt(0)
    s_barrier
    v_mfma_f32_32x32x16_bf16 v[144:159], v[204:207], v[92:95], v[144:159]
    ds_read_b64_tr_b16 v[192:193], v60 offset:24576
    ds_read_b64_tr_b16 v[194:195], v60 offset:25344
    s_add_u32 s48, s36, 26
    s_mul_i32 s55, s48, 49152
    s_sub_u32 s48, s48, 26
    s_mul_i32 m0, s48, 3072
    s_nop 0
    buffer_load_dwordx4 v42, s[16:19], s55 offen offset:0 lds
    v_mfma_f32_32x32x16_bf16 v[160:175], v[208:211], v[92:95], v[160:175]
    ds_read_b64_tr_b16 v[196:197], v60 offset:24640
    ds_read_b64_tr_b16 v[198:199], v60 offset:25408
    v_mfma_f32_32x32x16_bf16 v[176:191], v[212:215], v[92:95], v[176:191]
    ds_read_b64_tr_b16 v[200:201], v60 offset:24704
    ds_read_b64_tr_b16 v[202:203], v60 offset:25472
    s_mov_b32 s54, 0x83ab80
    buffer_load_dwordx4 v[76:79], v59, s[24:27], s54 offen sc1
    s_waitcnt vmcnt(12) lgkmcnt(4)
    v_mfma_f32_32x32x16_bf16 v[144:159], v[192:195], v[96:99], v[144:159]
    ds_read_b64_tr_b16 v[204:205], v60 offset:27648
    ds_read_b64_tr_b16 v[206:207], v60 offset:28416
    buffer_load_dwordx4 v43, s[16:19], s55 offen offset:1024 lds
    s_waitcnt lgkmcnt(4)
    v_mfma_f32_32x32x16_bf16 v[160:175], v[196:199], v[96:99], v[160:175]
    ds_read_b64_tr_b16 v[208:209], v60 offset:27712
    ds_read_b64_tr_b16 v[210:211], v60 offset:28480
    s_waitcnt lgkmcnt(4)
    v_mfma_f32_32x32x16_bf16 v[176:191], v[200:203], v[96:99], v[176:191]
    ds_read_b64_tr_b16 v[212:213], v60 offset:27776
    ds_read_b64_tr_b16 v[214:215], v60 offset:28544
    s_mov_b32 s54, 0x84b480
    buffer_load_dwordx4 v[80:83], v59, s[24:27], s54 offen sc1
    s_waitcnt vmcnt(13) lgkmcnt(4)
    v_mfma_f32_32x32x16_bf16 v[144:159], v[204:207], v[100:103], v[144:159]
    ds_read_b64_tr_b16 v[192:193], v60 offset:30720
    ds_read_b64_tr_b16 v[194:195], v60 offset:31488
    buffer_load_dwordx4 v44, s[16:19], s55 offen offset:2048 lds
    s_waitcnt lgkmcnt(4)
    v_mfma_f32_32x32x16_bf16 v[160:175], v[208:211], v[100:103], v[160:175]
    ds_read_b64_tr_b16 v[196:197], v60 offset:30784
    ds_read_b64_tr_b16 v[198:199], v60 offset:31552
    s_waitcnt lgkmcnt(4)
    v_mfma_f32_32x32x16_bf16 v[176:191], v[212:215], v[100:103], v[176:191]
    ds_read_b64_tr_b16 v[200:201], v60 offset:30848
    ds_read_b64_tr_b16 v[202:203], v60 offset:31616
    s_mov_b32 s54, 0x85bd80
    buffer_load_dwordx4 v[84:87], v59, s[24:27], s54 offen sc1
    s_waitcnt vmcnt(14) lgkmcnt(4)
    v_mfma_f32_32x32x16_bf16 v[144:159], v[192:195], v[104:107], v[144:159]
    ds_read_b64_tr_b16 v[204:205], v61 offset:1024
    ds_read_b64_tr_b16 v[206:207], v61 offset:1792
    s_add_u32 s48, s36, 30
    s_mul_i32 s55, s48, 49152
    s_sub_u32 s48, s48, 26
    s_mul_i32 m0, s48, 3072
    s_nop 0
    buffer_load_dwordx4 v42, s[16:19], s55 offen offset:0 lds
    s_waitcnt lgkmcnt(4)
    v_mfma_f32_32x32x16_bf16 v[160:175], v[196:199], v[104:107], v[160:175]
    ds_read_b64_tr_b16 v[208:209], v61 offset:1088
    ds_read_b64_tr_b16 v[210:211], v61 offset:1856
    s_waitcnt lgkmcnt(4)
    v_mfma_f32_32x32x16_bf16 v[176:191], v[200:203], v[104:107], v[176:191]
    ds_read_b64_tr_b16 v[212:213], v61 offset:1152
    ds_read_b64_tr_b16 v[214:215], v61 offset:1920
    s_mov_b32 s54, 0x86c680
    buffer_load_dwordx4 v[88:91], v59, s[24:27], s54 offen sc1
    s_waitcnt vmcnt(15) lgkmcnt(4)
    v_mfma_f32_32x32x16_bf16 v[144:159], v[204:207], v[108:111], v[144:159]
    ds_read_b64_tr_b16 v[192:193], v61 offset:4096
    ds_read_b64_tr_b16 v[194:195], v61 offset:4864
    buffer_load_dwordx4 v43, s[16:19], s55 offen offset:1024 lds
    s_waitcnt lgkmcnt(4)
    v_mfma_f32_32x32x16_bf16 v[160:175], v[208:211], v[108:111], v[160:175]
    ds_read_b64_tr_b16 v[196:197], v61 offset:4160
    ds_read_b64_tr_b16 v[198:199], v61 offset:4928
    s_waitcnt lgkmcnt(4)
    v_mfma_f32_32x32x16_bf16 v[176:191], v[212:215], v[108:111], v[176:191]
    ds_read_b64_tr_b16 v[200:201], v61 offset:4224
    ds_read_b64_tr_b16 v[202:203], v61 offset:4992
    s_mov_b32 s54, 0x87cf80
    buffer_load_dwordx4 v[92:95], v59, s[24:27], s54 offen sc1
    s_waitcnt vmcnt(16) lgkmcnt(4)
    v_mfma_f32_32x32x16_bf16 v[144:159], v[192:195], v[112:115], v[144:159]
    ds_read_b64_tr_b16 v[204:205], v61 offset:7168
    ds_read_b64_tr_b16 v[206:207], v61 offset:7936
    buffer_load_dwordx4 v44, s[16:19], s55 offen offset:2048 lds
    s_waitcnt lgkmcnt(4)
    v_mfma_f32_32x32x16_bf16 v[160:175], v[196:199], v[112:115], v[160:175]
    ds_read_b64_tr_b16 v[208:209], v61 offset:7232
    ds_read_b64_tr_b16 v[210:211], v61 offset:8000
    s_waitcnt lgkmcnt(4)
    v_mfma_f32_32x32x16_bf16 v[176:191], v[200:203], v[112:115], v[176:191]
    ds_read_b64_tr_b16 v[212:213], v61 offset:7296
    ds_read_b64_tr_b16 v[214:215], v61 offset:8064
    s_mov_b32 s54, 0x88d880
    buffer_load_dwordx4 v[96:99], v59, s[24:27], s54 offen sc1
    s_waitcnt vmcnt(17) lgkmcnt(0)
    s_barrier
    v_mfma_f32_32x32x16_bf16 v[144:159], v[204:207], v[116:119], v[144:159]
    ds_read_b64_tr_b16 v[192:193], v61 offset:10240
    ds_read_b64_tr_b16 v[194:195], v61 offset:11008
    s_add_u32 s48, s36, 34
    s_mul_i32 s55, s48, 49152
    s_sub_u32 s48, s48, 26
    s_mul_i32 m0, s48, 3072
    s_nop 0
    s_nop 0
    buffer_load_dwordx4 v42, s[16:19], s55 offen offset:0 lds
    v_mfma_f32_32x32x16_bf16 v[160:175], v[208:211], v[116:119], v[160:175]
    ds_read_b64_tr_b16 v[196:197], v61 offset:10304
    ds_read_b64_tr_b16 v[198:199], v61 offset:11072
    v_mfma_f32_32x32x16_bf16 v[176:191], v[212:215], v[116:119], v[176:191]
    ds_read_b64_tr_b16 v[200:201], v61 offset:10368
    ds_read_b64_tr_b16 v[202:203], v61 offset:11136
    s_mov_b32 s54, 0x89e180
    buffer_load_dwordx4 v[100:103], v59, s[24:27], s54 offen sc1
    s_waitcnt vmcnt(18) lgkmcnt(4)
    v_mfma_f32_32x32x16_bf16 v[144:159], v[192:195], v[120:123], v[144:159]
    ds_read_b64_tr_b16 v[204:205], v61 offset:13312
    ds_read_b64_tr_b16 v[206:207], v61 offset:14080
    buffer_load_dwordx4 v43, s[16:19], s55 offen offset:1024 lds
    s_waitcnt lgkmcnt(4)
    v_mfma_f32_32x32x16_bf16 v[160:175], v[196:199], v[120:123], v[160:175]
    ds_read_b64_tr_b16 v[208:209], v61 offset:13376
    ds_read_b64_tr_b16 v[210:211], v61 offset:14144
    s_waitcnt lgkmcnt(4)
    v_mfma_f32_32x32x16_bf16 v[176:191], v[200:203], v[120:123], v[176:191]
    ds_read_b64_tr_b16 v[212:213], v61 offset:13440
    ds_read_b64_tr_b16 v[214:215], v61 offset:14208
    s_mov_b32 s54, 0x8aea80
    buffer_load_dwordx4 v[104:107], v59, s[24:27], s54 offen sc1
    s_waitcnt vmcnt(19) lgkmcnt(4)
    v_mfma_f32_32x32x16_bf16 v[144:159], v[204:207], v[124:127], v[144:159]
    ds_read_b64_tr_b16 v[192:193], v61 offset:16384
    ds_read_b64_tr_b16 v[194:195], v61 offset:17152
    buffer_load_dwordx4 v44, s[16:19], s55 offen offset:2048 lds
    s_waitcnt lgkmcnt(4)
    v_mfma_f32_32x32x16_bf16 v[160:175], v[208:211], v[124:127], v[160:175]
    ds_read_b64_tr_b16 v[196:197], v61 offset:16448
    ds_read_b64_tr_b16 v[198:199], v61 offset:17216
    s_waitcnt lgkmcnt(4)
    v_mfma_f32_32x32x16_bf16 v[176:191], v[212:215], v[124:127], v[176:191]
    ds_read_b64_tr_b16 v[200:201], v61 offset:16512
    ds_read_b64_tr_b16 v[202:203], v61 offset:17280
    s_mov_b32 s54, 0x8bf380
    buffer_load_dwordx4 v[108:111], v59, s[24:27], s54 offen sc1
    s_waitcnt vmcnt(20) lgkmcnt(4)
    v_mfma_f32_32x32x16_bf16 v[144:159], v[192:195], v[64:67], v[144:159]
    ds_read_b64_tr_b16 v[204:205], v61 offset:19456
    ds_read_b64_tr_b16 v[206:207], v61 offset:20224
    s_add_u32 s48, s36, 38
    s_min_u32 s48, s48, 39
    s_mul_i32 s55, s48, 49152
    s_sub_u32 s48, s48, 26
    s_mul_i32 m0, s48, 3072
    s_nop 0
    buffer_load_dwordx4 v42, s[16:19], s55 offen offset:0 lds
    s_waitcnt lgkmcnt(4)
    v_mfma_f32_32x32x16_bf16 v[160:175], v[196:199], v[64:67], v[160:175]
    ds_read_b64_tr_b16 v[208:209], v61 offset:19520
    ds_read_b64_tr_b16 v[210:211], v61 offset:20288
    s_waitcnt lgkmcnt(4)
    v_mfma_f32_32x32x16_bf16 v[176:191], v[200:203], v[64:67], v[176:191]
    ds_read_b64_tr_b16 v[212:213], v61 offset:19584
    ds_read_b64_tr_b16 v[214:215], v61 offset:20352
    s_mov_b32 s54, 0x8cfc80
    buffer_load_dwordx4 v[112:115], v59, s[24:27], s54 offen sc1
    s_waitcnt vmcnt(21) lgkmcnt(4)
    v_mfma_f32_32x32x16_bf16 v[144:159], v[204:207], v[68:71], v[144:159]
    ds_read_b64_tr_b16 v[192:193], v61 offset:22528
    ds_read_b64_tr_b16 v[194:195], v61 offset:23296
    buffer_load_dwordx4 v43, s[16:19], s55 offen offset:1024 lds
    s_waitcnt lgkmcnt(4)
    v_mfma_f32_32x32x16_bf16 v[160:175], v[208:211], v[68:71], v[160:175]
    ds_read_b64_tr_b16 v[196:197], v61 offset:22592
    ds_read_b64_tr_b16 v[198:199], v61 offset:23360
    s_waitcnt lgkmcnt(4)
    v_mfma_f32_32x32x16_bf16 v[176:191], v[212:215], v[68:71], v[176:191]
    ds_read_b64_tr_b16 v[200:201], v61 offset:22656
    ds_read_b64_tr_b16 v[202:203], v61 offset:23424
    s_mov_b32 s54, 0x8e0580
    buffer_load_dwordx4 v[116:119], v59, s[24:27], s54 offen sc1
    s_waitcnt vmcnt(22) lgkmcnt(4)
    v_mfma_f32_32x32x16_bf16 v[144:159], v[192:195], v[72:75], v[144:159]
    ds_read_b64_tr_b16 v[204:205], v61 offset:25600
    ds_read_b64_tr_b16 v[206:207], v61 offset:26368
    buffer_load_dwordx4 v44, s[16:19], s55 offen offset:2048 lds
    s_waitcnt lgkmcnt(4)
    v_mfma_f32_32x32x16_bf16 v[160:175], v[196:199], v[72:75], v[160:175]
    ds_read_b64_tr_b16 v[208:209], v61 offset:25664
    ds_read_b64_tr_b16 v[210:211], v61 offset:26432
    s_waitcnt lgkmcnt(4)
    v_mfma_f32_32x32x16_bf16 v[176:191], v[200:203], v[72:75], v[176:191]
    ds_read_b64_tr_b16 v[212:213], v61 offset:25728
    ds_read_b64_tr_b16 v[214:215], v61 offset:26496
    s_mov_b32 s54, 0x8f0e80
    buffer_load_dwordx4 v[120:123], v59, s[24:27], s54 offen sc1
    s_waitcnt vmcnt(22) lgkmcnt(4)
    v_mfma_f32_32x32x16_bf16 v[144:159], v[204:207], v[76:79], v[144:159]
    ds_read_b64_tr_b16 v[192:193], v61 offset:28672
    ds_read_b64_tr_b16 v[194:195], v61 offset:29440
    buffer_load_dword v46, v47, s[24:27], 0 offen sc1
    s_waitcnt lgkmcnt(4)
    v_mfma_f32_32x32x16_bf16 v[160:175], v[208:211], v[76:79], v[160:175]
    ds_read_b64_tr_b16 v[196:197], v61 offset:28736
    ds_read_b64_tr_b16 v[198:199], v61 offset:29504
    s_waitcnt lgkmcnt(4)
    v_mfma_f32_32x32x16_bf16 v[176:191], v[212:215], v[76:79], v[176:191]
    ds_read_b64_tr_b16 v[200:201], v61 offset:28800
    ds_read_b64_tr_b16 v[202:203], v61 offset:29568
    s_mov_b32 s54, 0x901780
    buffer_load_dwordx4 v[124:127], v59, s[24:27], s54 offen sc1
    s_waitcnt vmcnt(22) lgkmcnt(4)
    v_mfma_f32_32x32x16_bf16 v[144:159], v[192:195], v[80:83], v[144:159]
    ds_read_b64_tr_b16 v[204:205], v61 offset:31744
    ds_read_b64_tr_b16 v[206:207], v61 offset:32512
    s_mov_b32 s51, 0x80000
    buffer_load_dwordx2 v[216:217], v62, s[24:27], s51 offen sc1
    s_waitcnt lgkmcnt(4)
    v_mfma_f32_32x32x16_bf16 v[160:175], v[196:199], v[80:83], v[160:175]
    ds_read_b64_tr_b16 v[208:209], v61 offset:31808
    ds_read_b64_tr_b16 v[210:211], v61 offset:32576
    s_waitcnt lgkmcnt(4)
    v_mfma_f32_32x32x16_bf16 v[176:191], v[200:203], v[80:83], v[176:191]
    ds_read_b64_tr_b16 v[212:213], v61 offset:31872
    ds_read_b64_tr_b16 v[214:215], v61 offset:32640
    s_mov_b32 s54, 0x912080
    buffer_load_dwordx4 v[64:67], v59, s[24:27], s54 offen sc1
    s_waitcnt vmcnt(22) lgkmcnt(4)
    v_mfma_f32_32x32x16_bf16 v[144:159], v[204:207], v[84:87], v[144:159]
    ds_read_b64_tr_b16 v[192:193], v61 offset:34816
    ds_read_b64_tr_b16 v[194:195], v61 offset:35584
    s_mov_b32 s51, 0x84200
    buffer_load_dwordx2 v[218:219], v62, s[24:27], s51 offen sc1
    s_waitcnt lgkmcnt(4)
    v_mfma_f32_32x32x16_bf16 v[160:175], v[208:211], v[84:87], v[160:175]
    ds_read_b64_tr_b16 v[196:197], v61 offset:34880
    ds_read_b64_tr_b16 v[198:199], v61 offset:35648
    s_waitcnt lgkmcnt(4)
    v_mfma_f32_32x32x16_bf16 v[176:191], v[212:215], v[84:87], v[176:191]
    ds_read_b64_tr_b16 v[200:201], v61 offset:34944
    ds_read_b64_tr_b16 v[202:203], v61 offset:35712
    s_mov_b32 s54, 0x922980
    buffer_load_dwordx4 v[68:71], v59, s[24:27], s54 offen sc1
    s_waitcnt vmcnt(22) lgkmcnt(4)
    v_mfma_f32_32x32x16_bf16 v[144:159], v[192:195], v[88:91], v[144:159]
    ds_read_b64_tr_b16 v[204:205], v61 offset:37888
    ds_read_b64_tr_b16 v[206:207], v61 offset:38656
    s_mov_b32 s51, 0x88400
    buffer_load_dwordx2 v[220:221], v62, s[24:27], s51 offen sc1
    s_waitcnt lgkmcnt(4)
    v_mfma_f32_32x32x16_bf16 v[160:175], v[196:199], v[88:91], v[160:175]
    ds_read_b64_tr_b16 v[208:209], v61 offset:37952
    ds_read_b64_tr_b16 v[210:211], v61 offset:38720
    s_waitcnt lgkmcnt(4)
    v_mfma_f32_32x32x16_bf16 v[176:191], v[200:203], v[88:91], v[176:191]
    ds_read_b64_tr_b16 v[212:213], v61 offset:38016
    ds_read_b64_tr_b16 v[214:215], v61 offset:38784
    s_mov_b32 s54, 0x933280
    buffer_load_dwordx4 v[72:75], v59, s[24:27], s54 offen sc1
    s_waitcnt vmcnt(22) lgkmcnt(4)
    v_mfma_f32_32x32x16_bf16 v[144:159], v[204:207], v[92:95], v[144:159]
    ds_read_b64_tr_b16 v[192:193], v61 offset:40960
    ds_read_b64_tr_b16 v[194:195], v61 offset:41728
    s_mov_b32 s51, 0x8c600
    buffer_load_dwordx2 v[222:223], v62, s[24:27], s51 offen sc1
    s_waitcnt lgkmcnt(4)
    v_mfma_f32_32x32x16_bf16 v[160:175], v[208:211], v[92:95], v[160:175]
    ds_read_b64_tr_b16 v[196:197], v61 offset:41024
    ds_read_b64_tr_b16 v[198:199], v61 offset:41792
    s_waitcnt lgkmcnt(4)
    v_mfma_f32_32x32x16_bf16 v[176:191], v[212:215], v[92:95], v[176:191]
    ds_read_b64_tr_b16 v[200:201], v61 offset:41088
    ds_read_b64_tr_b16 v[202:203], v61 offset:41856
    s_mov_b32 s54, 0x943b80
    buffer_load_dwordx4 v[76:79], v59, s[24:27], s54 offen sc1
    s_waitcnt vmcnt(22) lgkmcnt(4)
    v_mfma_f32_32x32x16_bf16 v[144:159], v[192:195], v[96:99], v[144:159]
    ds_read_b64_tr_b16 v[204:205], v61 offset:44032
    ds_read_b64_tr_b16 v[206:207], v61 offset:44800
    s_mov_b32 s51, 0x90800
    buffer_load_dwordx2 v[224:225], v62, s[24:27], s51 offen sc1
    s_waitcnt lgkmcnt(4)
    v_mfma_f32_32x32x16_bf16 v[160:175], v[196:199], v[96:99], v[160:175]
    ds_read_b64_tr_b16 v[208:209], v61 offset:44096
    ds_read_b64_tr_b16 v[210:211], v61 offset:44864
    s_waitcnt lgkmcnt(4)
    v_mfma_f32_32x32x16_bf16 v[176:191], v[200:203], v[96:99], v[176:191]
    ds_read_b64_tr_b16 v[212:213], v61 offset:44160
    ds_read_b64_tr_b16 v[214:215], v61 offset:44928
    s_mov_b32 s54, 0x954480
    buffer_load_dwordx4 v[80:83], v59, s[24:27], s54 offen sc1
    s_waitcnt vmcnt(22) lgkmcnt(4)
    s_waitcnt vmcnt(11)
    v_cmp_ne_u32 vcc, s45, v46
    s_cmp_lg_u32 s36, 0
    s_cbranch_scc1 L_ok_25
    s_nop 1
    s_cbranch_vccz L_ok_25
    s_mov_b64 s[58:59], exec
    s_mov_b32 exec_lo, -1
    s_mov_b32 exec_hi, -1
    s_mov_b32 s56, 0
L_poll_26:
    buffer_load_dword v46, v47, s[24:27], 0 offen sc1
    s_waitcnt vmcnt(0)
    v_cmp_ne_u32_e64 vcc, s45, v46
    s_add_u32 s56, s56, 1
    s_nop 2
    s_cbranch_vccz L_polled_27
    s_cmp_lt_u32 s56, 100000
    s_cbranch_scc1 L_poll_26
L_polled_27:
    s_mov_b64 exec, s[58:59]
L_ok_25:
    s_barrier
    v_mfma_f32_32x32x16_bf16 v[144:159], v[204:207], v[100:103], v[144:159]
    ds_read_b64_tr_b16 v[192:193], v60 offset:0
    ds_read_b64_tr_b16 v[194:195], v60 offset:768
    s_mov_b32 s51, 0x94a00
    buffer_load_dwordx2 v[226:227], v62, s[24:27], s51 offen sc1
    s_waitcnt lgkmcnt(4)
    v_mfma_f32_32x32x16_bf16 v[160:175], v[208:211], v[100:103], v[160:175]
    ds_read_b64_tr_b16 v[196:197], v60 offset:64
    ds_read_b64_tr_b16 v[198:199], v60 offset:832
    s_waitcnt lgkmcnt(4)
    v_mfma_f32_32x32x16_bf16 v[176:191], v[212:215], v[100:103], v[176:191]
    ds_read_b64_tr_b16 v[200:201], v60 offset:128
    ds_read_b64_tr_b16 v[202:203], v60 offset:896
    s_mov_b32 s54, 0x964d80
    buffer_load_dwordx4 v[84:87], v59, s[24:27], s54 offen sc1
    s_waitcnt lgkmcnt(4)
    v_mfma_f32_32x32x16_bf16 v[144:159], v[192:195], v[104:107], v[144:159]
    ds_read_b64_tr_b16 v[204:205], v60 offset:3072
    ds_read_b64_tr_b16 v[206:207], v60 offset:3840
    s_mov_b32 s51, 0x98c00
    buffer_load_dwordx2 v[228:229], v62, s[24:27], s51 offen sc1
    s_waitcnt lgkmcnt(4)
    v_mfma_f32_32x32x16_bf16 v[160:175], v[196:199], v[104:107], v[160:175]
    ds_read_b64_tr_b16 v[208:209], v60 offset:3136
    ds_read_b64_tr_b16 v[210:211], v60 offset:3904
    s_waitcnt lgkmcnt(4)
    v_mfma_f32_32x32x16_bf16 v[176:191], v[200:203], v[104:107], v[176:191]
    ds_read_b64_tr_b16 v[212:213], v60 offset:3200
    ds_read_b64_tr_b16 v[214:215], v60 offset:3968
    s_mov_b32 s54, 0x975680
    buffer_load_dwordx4 v[88:91], v59, s[24:27], s54 offen sc1
    s_waitcnt lgkmcnt(4)
    v_mfma_f32_32x32x16_bf16 v[144:159], v[204:207], v[108:111], v[144:159]
    ds_read_b64_tr_b16 v[192:193], v60 offset:6144
    ds_read_b64_tr_b16 v[194:195], v60 offset:6912
    s_mov_b32 s51, 0x9ce00
    buffer_load_dwordx2 v[230:231], v62, s[24:27], s51 offen sc1
    s_waitcnt lgkmcnt(4)
    v_mfma_f32_32x32x16_bf16 v[160:175], v[208:211], v[108:111], v[160:175]
    ds_read_b64_tr_b16 v[196:197], v60 offset:6208
    ds_read_b64_tr_b16 v[198:199], v60 offset:6976
    s_waitcnt lgkmcnt(4)
    v_mfma_f32_32x32x16_bf16 v[176:191], v[212:215], v[108:111], v[176:191]
    ds_read_b64_tr_b16 v[200:201], v60 offset:6272
    ds_read_b64_tr_b16 v[202:203], v60 offset:7040
    s_mov_b32 s54, 0x985f80
    buffer_load_dwordx4 v[92:95], v59, s[24:27], s54 offen sc1
    s_waitcnt lgkmcnt(4)
    v_mfma_f32_32x32x16_bf16 v[144:159], v[192:195], v[112:115], v[144:159]
    ds_read_b64_tr_b16 v[204:205], v60 offset:9216
    ds_read_b64_tr_b16 v[206:207], v60 offset:9984
    s_mov_b32 s51, 0xa1000
    buffer_load_dwordx2 v[232:233], v62, s[24:27], s51 offen sc1
    s_waitcnt lgkmcnt(4)
    v_mfma_f32_32x32x16_bf16 v[160:175], v[196:199], v[112:115], v[160:175]
    ds_read_b64_tr_b16 v[208:209], v60 offset:9280
    ds_read_b64_tr_b16 v[210:211], v60 offset:10048
    s_waitcnt lgkmcnt(4)
    v_mfma_f32_32x32x16_bf16 v[176:191], v[200:203], v[112:115], v[176:191]
    ds_read_b64_tr_b16 v[212:213], v60 offset:9344
    ds_read_b64_tr_b16 v[214:215], v60 offset:10112
    s_waitcnt lgkmcnt(4)
    v_mfma_f32_32x32x16_bf16 v[144:159], v[204:207], v[116:119], v[144:159]
    ds_read_b64_tr_b16 v[192:193], v60 offset:12288
    ds_read_b64_tr_b16 v[194:195], v60 offset:13056
    s_mov_b32 s51, 0xa5200
    buffer_load_dwordx2 v[234:235], v62, s[24:27], s51 offen sc1
    s_waitcnt lgkmcnt(4)
    v_mfma_f32_32x32x16_bf16 v[160:175], v[208:211], v[116:119], v[160:175]
    ds_read_b64_tr_b16 v[196:197], v60 offset:12352
    ds_read_b64_tr_b16 v[198:199], v60 offset:13120
    s_waitcnt lgkmcnt(4)
    v_mfma_f32_32x32x16_bf16 v[176:191], v[212:215], v[116:119], v[176:191]
    ds_read_b64_tr_b16 v[200:201], v60 offset:12416
    ds_read_b64_tr_b16 v[202:203], v60 offset:13184
    s_waitcnt lgkmcnt(4)
    v_mfma_f32_32x32x16_bf16 v[144:159], v[192:195], v[120:123], v[144:159]
    ds_read_b64_tr_b16 v[204:205], v60 offset:15360
    ds_read_b64_tr_b16 v[206:207], v60 offset:16128
    s_mul_i32 s48, s44, 384
    s_add_u32 s48, s48, 32768
    s_lshl_b32 s49, s36, 9
    s_add_u32 m0, s49, 79872
    s_mov_b64 exec, 0xffffff
    buffer_load_dwordx4 v45, s[24:27], s48 offen sc1 lds
    s_mov_b64 exec, -1
    s_waitcnt lgkmcnt(4)
    v_mfma_f32_32x32x16_bf16 v[160:175], v[196:199], v[120:123], v[160:175]
    ds_read_b64_tr_b16 v[208:209], v60 offset:15424
    ds_read_b64_tr_b16 v[210:211], v60 offset:16192
    s_waitcnt lgkmcnt(4)
    v_mfma_f32_32x32x16_bf16 v[176:191], v[200:203], v[120:123], v[176:191]
    ds_read_b64_tr_b16 v[212:213], v60 offset:15488
    ds_read_b64_tr_b16 v[214:215], v60 offset:16256
    s_waitcnt vmcnt(19) lgkmcnt(4)
    v_mfma_f32_32x32x16_bf16 v[144:159], v[204:207], v[124:127], v[144:159]
    ds_read_b64_tr_b16 v[192:193], v60 offset:18432
    ds_read_b64_tr_b16 v[194:195], v60 offset:19200
    s_waitcnt lgkmcnt(4)
    v_mfma_f32_32x32x16_bf16 v[160:175], v[208:211], v[124:127], v[160:175]
    ds_read_b64_tr_b16 v[196:197], v60 offset:18496
    ds_read_b64_tr_b16 v[198:199], v60 offset:19264
    s_waitcnt lgkmcnt(4)
    v_mfma_f32_32x32x16_bf16 v[176:191], v[212:215], v[124:127], v[176:191]
    ds_read_b64_tr_b16 v[200:201], v60 offset:18560
    ds_read_b64_tr_b16 v[202:203], v60 offset:19328
    s_waitcnt vmcnt(17) lgkmcnt(4)
    v_mfma_f32_32x32x16_bf16 v[144:159], v[192:195], v[64:67], v[144:159]
    ds_read_b64_tr_b16 v[204:205], v60 offset:21504
    ds_read_b64_tr_b16 v[206:207], v60 offset:22272
    s_waitcnt lgkmcnt(4)
    v_mfma_f32_32x32x16_bf16 v[160:175], v[196:199], v[64:67], v[160:175]
    ds_read_b64_tr_b16 v[208:209], v60 offset:21568
    ds_read_b64_tr_b16 v[210:211], v60 offset:22336
    s_waitcnt lgkmcnt(4)
    v_mfma_f32_32x32x16_bf16 v[176:191], v[200:203], v[64:67], v[176:191]
    ds_read_b64_tr_b16 v[212:213], v60 offset:21632
    ds_read_b64_tr_b16 v[214:215], v60 offset:22400
    s_waitcnt vmcnt(15) lgkmcnt(4)
    s_barrier
    v_mfma_f32_32x32x16_bf16 v[144:159], v[204:207], v[68:71], v[144:159]
    ds_read_b64_tr_b16 v[192:193], v60 offset:24576
    ds_read_b64_tr_b16 v[194:195], v60 offset:25344
    s_waitcnt lgkmcnt(4)
    v_mfma_f32_32x32x16_bf16 v[160:175], v[208:211], v[68:71], v[160:175]
    ds_read_b64_tr_b16 v[196:197], v60 offset:24640
    ds_read_b64_tr_b16 v[198:199], v60 offset:25408
    s_waitcnt lgkmcnt(4)
    v_mfma_f32_32x32x16_bf16 v[176:191], v[212:215], v[68:71], v[176:191]
    ds_read_b64_tr_b16 v[200:201], v60 offset:24704
    ds_read_b64_tr_b16 v[202:203], v60 offset:25472
    s_waitcnt vmcnt(13) lgkmcnt(4)
    s_waitcnt vmcnt(0)
    v_mfma_f32_32x32x16_bf16 v[144:159], v[192:195], v[72:75], v[144:159]
    ds_read_b64_tr_b16 v[204:205], v60 offset:27648
    ds_read_b64_tr_b16 v[206:207], v60 offset:28416
    v_add_f32 v216, v216, v218
    v_add_f32_e64 v217, v217, v219
    s_waitcnt lgkmcnt(4)
    v_mfma_f32_32x32x16_bf16 v[160:175], v[196:199], v[72:75], v[160:175]
    ds_read_b64_tr_b16 v[208:209], v60 offset:27712
    ds_read_b64_tr_b16 v[210:211], v60 offset:28480
    v_add_f32 v216, v216, v220
    v_add_f32 v217, v217, v221
    v_add_f32 v216, v216, v222
    s_waitcnt lgkmcnt(4)
    v_mfma_f32_32x32x16_bf16 v[176:191], v[200:203], v[72:75], v[176:191]
    ds_read_b64_tr_b16 v[212:213], v60 offset:27776
    ds_read_b64_tr_b16 v[214:215], v60 offset:28544
    v_add_f32 v217, v217, v223
    v_add_f32_e64 v216, v216, v224
    s_waitcnt lgkmcnt(4)
    v_mfma_f32_32x32x16_bf16 v[144:159], v[204:207], v[76:79], v[144:159]
    ds_read_b64_tr_b16 v[192:193], v60 offset:30720
    ds_read_b64_tr_b16 v[194:195], v60 offset:31488
    v_add_f32 v217, v217, v225
    v_add_f32_e64 v216, v216, v226
    s_waitcnt lgkmcnt(4)
    v_mfma_f32_32x32x16_bf16 v[160:175], v[208:211], v[76:79], v[160:175]
    ds_read_b64_tr_b16 v[196:197], v60 offset:30784
    ds_read_b64_tr_b16 v[198:199], v60 offset:31552
    v_add_f32 v217, v217, v227
    v_add_f32 v216, v216, v228
    v_add_f32 v217, v217, v229
    s_waitcnt lgkmcnt(4)
    v_mfma_f32_32x32x16_bf16 v[176:191], v[212:215], v[76:79], v[176:191]
    ds_read_b64_tr_b16 v[200:201], v60 offset:30848
    ds_read_b64_tr_b16 v[202:203], v60 offset:31616
    v_add_f32 v216, v216, v230
    v_add_f32_e64 v217, v217, v231
    s_waitcnt lgkmcnt(4)
    v_mfma_f32_32x32x16_bf16 v[144:159], v[192:195], v[80:83], v[144:159]
    ds_read_b64_tr_b16 v[204:205], v61 offset:1024
    ds_read_b64_tr_b16 v[206:207], v61 offset:1792
    v_add_f32 v216, v216, v232
    v_add_f32_e64 v217, v217, v233
    s_waitcnt lgkmcnt(4)
    v_mfma_f32_32x32x16_bf16 v[160:175], v[196:199], v[80:83], v[160:175]
    ds_read_b64_tr_b16 v[208:209], v61 offset:1088
    ds_read_b64_tr_b16 v[210:211], v61 offset:1856
    v_add_f32 v216, v216, v234
    v_add_f32 v217, v217, v235
    v_mov_b32 v218, v216
    s_waitcnt lgkmcnt(4)
    v_mfma_f32_32x32x16_bf16 v[176:191], v[200:203], v[80:83], v[176:191]
    ds_read_b64_tr_b16 v[212:213], v61 offset:1152
    ds_read_b64_tr_b16 v[214:215], v61 offset:1920
    v_mov_b32_e64 v219, v217
    v_permlane32_swap_b32 v216, v218
    s_waitcnt lgkmcnt(4)
    v_mfma_f32_32x32x16_bf16 v[144:159], v[204:207], v[84:87], v[144:159]
    ds_read_b64_tr_b16 v[192:193], v61 offset:4096
    ds_read_b64_tr_b16 v[194:195], v61 offset:4864
    v_permlane32_swap_b32 v217, v219
    v_add_f32_e64 v216, v216, v218
    s_waitcnt lgkmcnt(4)
    v_mfma_f32_32x32x16_bf16 v[160:175], v[208:211], v[84:87], v[160:175]
    ds_read_b64_tr_b16 v[196:197], v61 offset:4160
    ds_read_b64_tr_b16 v[198:199], v61 offset:4928
    v_add_f32 v217, v217, v219
    v_mul_f32 v216, s64, v216
    v_mul_f32 v217, s64, v217
    s_waitcnt lgkmcnt(4)
    v_mfma_f32_32x32x16_bf16 v[176:191], v[212:215], v[84:87], v[176:191]
    ds_read_b64_tr_b16 v[200:201], v61 offset:4224
    ds_read_b64_tr_b16 v[202:203], v61 offset:4992
    v_fma_f32 v217, -v216, v216, v217
    v_max_f32 v217, 0, v217
    s_waitcnt lgkmcnt(4)
    v_mfma_f32_32x32x16_bf16 v[144:159], v[192:195], v[88:91], v[144:159]
    ds_read_b64_tr_b16 v[204:205], v61 offset:7168
    ds_read_b64_tr_b16 v[206:207], v61 offset:7936
    v_add_f32 v217, s70, v217
    v_rsq_f32_e64 v218, v217
    s_waitcnt lgkmcnt(4)
    v_mfma_f32_32x32x16_bf16 v[160:175], v[196:199], v[88:91], v[160:175]
    ds_read_b64_tr_b16 v[208:209], v61 offset:7232
    ds_read_b64_tr_b16 v[210:211], v61 offset:8000
    v_mul_f32 v219, v216, v218
    s_waitcnt lgkmcnt(4)
    v_mfma_f32_32x32x16_bf16 v[176:191], v[200:203], v[88:91], v[176:191]
    ds_read_b64_tr_b16 v[212:213], v61 offset:7296
    ds_read_b64_tr_b16 v[214:215], v61 offset:8064
    s_waitcnt lgkmcnt(4)
    v_mfma_f32_32x32x16_bf16 v[144:159], v[204:207], v[92:95], v[144:159]
    ds_read_b128 v[96:99], v236 offset:0
    ds_read_b128 v[100:103], v236 offset:32
    ds_read_b128 v[104:107], v236 offset:64
    ds_read_b128 v[108:111], v236 offset:96
    s_waitcnt lgkmcnt(6)
    v_mfma_f32_32x32x16_bf16 v[160:175], v[208:211], v[92:95], v[160:175]
    ds_read_b128 v[112:115], v236 offset:128
    ds_read_b128 v[116:119], v236 offset:160
    ds_read_b128 v[120:123], v236 offset:192
    ds_read_b128 v[124:127], v236 offset:224
    s_waitcnt lgkmcnt(8)
    s_nop 0
    v_mfma_f32_32x32x16_bf16 v[176:191], v[212:215], v[92:95], v[176:191]
    ds_read_b128 v[128:131], v236 offset:256
    ds_read_b128 v[132:135], v236 offset:288
    ds_read_b128 v[136:139], v236 offset:320
    ds_read_b128 v[140:143], v236 offset:352
    s_mul_i32 s48, s37, 81920
    v_add_u32 v26, s48, v26
    v_add_u32_e64 v27, s48, v27
    s_lshl_b32 s48, s43, 11
    s_lshl_b32 s49, s44, 7
    s_add_u32 s48, s48, s49
    s_add_u32 s3, s48, 21233664
    s_lshr_b32 s48, s41, 7
    s_add_u32 s49, s41, 95
    s_lshr_b32 s49, s49, 7
    s_min_u32 s49, s49, 15
    s_sub_u32 s49, s49, s48
    s_lshl_b32 s49, s49, 11
    s_lshl_b32 s48, s48, 11
    s_add_u32 s48, s48, 21233664
    s_cmp_eq_u32 s36, 0
    s_cselect_b32 s48, s48, 0x7efffff0
    v_and_b32 v46, 1, v32
    v_mul_lo_u32 v46, v46, s49
    v_lshl_add_u32 v45, v1, 7, v46
    v_add_u32_e64 v64, s48, v45
    s_waitcnt lgkmcnt(0)
    s_barrier
    v_pk_mul_f32 v[144:145], v[144:145], v[218:219] op_sel_hi:[1,0]
    v_pk_mul_f32 v[146:147], v[146:147], v[218:219] op_sel_hi:[1,0]
    v_pk_mul_f32 v[148:149], v[148:149], v[218:219] op_sel_hi:[1,0]
    s_add_u32 m0, s52, 0
    s_mov_b32 s55, 0
    buffer_load_dwordx4 v26, s[20:23], s55 offen lds
    v_pk_mul_f32 v[150:151], v[150:151], v[218:219] op_sel_hi:[1,0]
    v_pk_mul_f32 v[152:153], v[152:153], v[218:219] op_sel_hi:[1,0]
    v_pk_mul_f32 v[154:155], v[154:155], v[218:219] op_sel_hi:[1,0]
    v_pk_mul_f32 v[156:157], v[156:157], v[218:219] op_sel_hi:[1,0]
    v_pk_mul_f32 v[158:159], v[158:159], v[218:219] op_sel_hi:[1,0]
    v_pk_fma_f32 v[144:145], v[96:97], v[218:219], v[144:145] op_sel:[0,1,0] op_sel_hi:[1,1,1] neg_lo:[0,1,0] neg_hi:[0,1,0]
    v_pk_fma_f32 v[146:147], v[98:99], v[218:219], v[146:147] op_sel:[0,1,0] op_sel_hi:[1,1,1] neg_lo:[0,1,0] neg_hi:[0,1,0]
    v_pk_fma_f32 v[148:149], v[100:101], v[218:219], v[148:149] op_sel:[0,1,0] op_sel_hi:[1,1,1] neg_lo:[0,1,0] neg_hi:[0,1,0]
    v_pk_fma_f32 v[150:151], v[102:103], v[218:219], v[150:151] op_sel:[0,1,0] op_sel_hi:[1,1,1] neg_lo:[0,1,0] neg_hi:[0,1,0]
    v_pk_fma_f32 v[152:153], v[104:105], v[218:219], v[152:153] op_sel:[0,1,0] op_sel_hi:[1,1,1] neg_lo:[0,1,0] neg_hi:[0,1,0]
    v_pk_fma_f32 v[154:155], v[106:107], v[218:219], v[154:155] op_sel:[0,1,0] op_sel_hi:[1,1,1] neg_lo:[0,1,0] neg_hi:[0,1,0]
    v_pk_fma_f32 v[156:157], v[108:109], v[218:219], v[156:157] op_sel:[0,1,0] op_sel_hi:[1,1,1] neg_lo:[0,1,0] neg_hi:[0,1,0]
    buffer_load_dwordx4 v27, s[20:23], s55 offen offset:1024 lds
    v_pk_fma_f32 v[158:159], v[110:111], v[218:219], v[158:159] op_sel:[0,1,0] op_sel_hi:[1,1,1] neg_lo:[0,1,0] neg_hi:[0,1,0]
    v_pk_mul_f32 v[66:67], v[144:145], v[144:145]
    v_pk_mul_f32 v[68:69], v[146:147], v[146:147]
    v_pk_mul_f32 v[70:71], v[148:149], v[148:149]
    v_pk_mul_f32 v[72:73], v[150:151], v[150:151]
    v_pk_mul_f32 v[74:75], v[152:153], v[152:153]
    v_pk_mul_f32 v[76:77], v[154:155], v[154:155]
    v_pk_mul_f32 v[78:79], v[156:157], v[156:157]
    v_pk_mul_f32 v[80:81], v[158:159], v[158:159]
    v_pk_fma_f32 v[66:67], v[66:67], s[66:67], v[28:29]
    v_pk_fma_f32 v[68:69], v[68:69], s[66:67], v[28:29]
    v_pk_fma_f32 v[70:71], v[70:71], s[66:67], v[28:29]
    s_add_u32 m0, s52, 8192
    s_mov_b32 s55, 245760
    buffer_load_dwordx4 v26, s[20:23], s55 offen lds
    v_pk_fma_f32 v[72:73], v[72:73], s[66:67], v[28:29]
    v_pk_fma_f32 v[74:75], v[74:75], s[66:67], v[28:29]
    v_pk_fma_f32 v[76:77], v[76:77], s[66:67], v[28:29]
    v_pk_fma_f32 v[78:79], v[78:79], s[66:67], v[28:29]
    v_pk_fma_f32 v[80:81], v[80:81], s[66:67], v[28:29]
    v_pk_mul_f32 v[66:67], v[66:67], v[144:145]
    v_pk_mul_f32 v[68:69], v[68:69], v[146:147]
    v_pk_mul_f32 v[70:71], v[70:71], v[148:149]
    v_pk_mul_f32 v[72:73], v[72:73], v[150:151]
    v_pk_mul_f32 v[74:75], v[74:75], v[152:153]
    v_pk_mul_f32 v[76:77], v[76:77], v[154:155]
    v_pk_mul_f32 v[78:79], v[78:79], v[156:157]
    buffer_load_dwordx4 v27, s[20:23], s55 offen offset:1024 lds
    v_pk_mul_f32 v[80:81], v[80:81], v[158:159]
    v_exp_f32 v66, v66
    v_exp_f32 v67, v67
    v_exp_f32 v68, v68
    v_exp_f32 v69, v69
    v_exp_f32 v70, v70
    v_exp_f32 v71, v71
    v_exp_f32 v72, v72
    v_exp_f32 v73, v73
    v_exp_f32 v74, v74
    v_exp_f32 v75, v75
    v_exp_f32_e64 v76, v76
    s_add_u32 m0, s52, 16384
    s_mov_b32 s55, 491520
    buffer_load_dwordx4 v26, s[20:23], s55 offen lds
    v_exp_f32 v77, v77
    v_exp_f32 v78, v78
    v_exp_f32 v79, v79
    v_exp_f32 v80, v80
    v_exp_f32_e64 v81, v81
    v_pk_add_f32 v[66:67], v[66:67], 1.0 op_sel_hi:[1,0]
    v_pk_add_f32 v[68:69], v[68:69], 1.0 op_sel_hi:[1,0]
    v_pk_add_f32 v[70:71], v[70:71], 1.0 op_sel_hi:[1,0]
    v_pk_add_f32 v[72:73], v[72:73], 1.0 op_sel_hi:[1,0]
    v_pk_add_f32 v[74:75], v[74:75], 1.0 op_sel_hi:[1,0]
    v_pk_add_f32 v[76:77], v[76:77], 1.0 op_sel_hi:[1,0]
    v_pk_add_f32 v[78:79], v[78:79], 1.0 op_sel_hi:[1,0]
    buffer_load_dwordx4 v27, s[20:23], s55 offen offset:1024 lds
    v_pk_add_f32 v[80:81], v[80:81], 1.0 op_sel_hi:[1,0]
    v_rcp_f32 v66, v66
    v_rcp_f32 v67, v67
    v_rcp_f32 v68, v68
    v_rcp_f32 v69, v69
    v_rcp_f32 v70, v70
    v_rcp_f32 v71, v71
    v_rcp_f32 v72, v72
    v_rcp_f32 v73, v73
    v_rcp_f32 v74, v74
    v_rcp_f32 v75, v75
    v_rcp_f32_e64 v76, v76
    s_add_u32 m0, s52, 24576
    s_mov_b32 s55, 737280
    buffer_load_dwordx4 v26, s[20:23], s55 offen lds
    v_rcp_f32 v77, v77
    v_rcp_f32 v78, v78
    v_rcp_f32 v79, v79
    v_rcp_f32 v80, v80
    v_rcp_f32_e64 v81, v81
    v_pk_mul_f32 v[66:67], v[66:67], v[144:145]
    v_pk_mul_f32 v[68:69], v[68:69], v[146:147]
    v_pk_mul_f32 v[70:71], v[70:71], v[148:149]
    v_pk_mul_f32 v[72:73], v[72:73], v[150:151]
    v_pk_mul_f32 v[74:75], v[74:75], v[152:153]
    v_pk_mul_f32 v[76:77], v[76:77], v[154:155]
    v_pk_mul_f32 v[78:79], v[78:79], v[156:157]
    v_pk_mul_f32 v[80:81], v[80:81], v[158:159]
    v_cvt_pk_bf16_f32 v192, v66, v67
    v_cvt_pk_bf16_f32 v193, v68, v69
    v_cvt_pk_bf16_f32 v194, v70, v71
    v_cvt_pk_bf16_f32 v195, v72, v73
    v_cvt_pk_bf16_f32 v196, v74, v75
    v_cvt_pk_bf16_f32 v197, v76, v77
    v_cvt_pk_bf16_f32 v198, v78, v79
    v_cvt_pk_bf16_f32 v199, v80, v81
    v_permlane32_swap_b32 v192, v194
    v_permlane32_swap_b32 v193, v195
    v_permlane32_swap_b32 v196, v198
    v_permlane32_swap_b32 v197, v199
    s_mov_b32 s54, 0xd00000
    buffer_store_dwordx4 v[192:195], v63, s[24:27], s54 offen sc1
    s_mov_b32 s54, 0xd10000
    buffer_store_dwordx4 v[196:199], v63, s[24:27], s54 offen sc1
    v_pk_mul_f32 v[160:161], v[160:161], v[218:219] op_sel_hi:[1,0]
    v_pk_mul_f32 v[162:163], v[162:163], v[218:219] op_sel_hi:[1,0]
    v_pk_mul_f32 v[164:165], v[164:165], v[218:219] op_sel_hi:[1,0]
    buffer_load_dwordx4 v27, s[20:23], s55 offen offset:1024 lds
    v_pk_mul_f32 v[166:167], v[166:167], v[218:219] op_sel_hi:[1,0]
    v_pk_mul_f32 v[168:169], v[168:169], v[218:219] op_sel_hi:[1,0]
    v_pk_mul_f32 v[170:171], v[170:171], v[218:219] op_sel_hi:[1,0]
    v_pk_mul_f32 v[172:173], v[172:173], v[218:219] op_sel_hi:[1,0]
    v_pk_mul_f32 v[174:175], v[174:175], v[218:219] op_sel_hi:[1,0]
    v_pk_fma_f32 v[160:161], v[112:113], v[218:219], v[160:161] op_sel:[0,1,0] op_sel_hi:[1,1,1] neg_lo:[0,1,0] neg_hi:[0,1,0]
    v_pk_fma_f32 v[162:163], v[114:115], v[218:219], v[162:163] op_sel:[0,1,0] op_sel_hi:[1,1,1] neg_lo:[0,1,0] neg_hi:[0,1,0]
    v_pk_fma_f32 v[164:165], v[116:117], v[218:219], v[164:165] op_sel:[0,1,0] op_sel_hi:[1,1,1] neg_lo:[0,1,0] neg_hi:[0,1,0]
    v_pk_fma_f32 v[166:167], v[118:119], v[218:219], v[166:167] op_sel:[0,1,0] op_sel_hi:[1,1,1] neg_lo:[0,1,0] neg_hi:[0,1,0]
    v_pk_fma_f32 v[168:169], v[120:121], v[218:219], v[168:169] op_sel:[0,1,0] op_sel_hi:[1,1,1] neg_lo:[0,1,0] neg_hi:[0,1,0]
    v_pk_fma_f32 v[170:171], v[122:123], v[218:219], v[170:171] op_sel:[0,1,0] op_sel_hi:[1,1,1] neg_lo:[0,1,0] neg_hi:[0,1,0]
    v_pk_fma_f32 v[172:173], v[124:125], v[218:219], v[172:173] op_sel:[0,1,0] op_sel_hi:[1,1,1] neg_lo:[0,1,0] neg_hi:[0,1,0]
    s_add_u32 m0, s52, 32768
    s_mov_b32 s55, 983040
    buffer_load_dwordx4 v26, s[20:23], s55 offen lds
    v_pk_fma_f32 v[174:175], v[126:127], v[218:219], v[174:175] op_sel:[0,1,0] op_sel_hi:[1,1,1] neg_lo:[0,1,0] neg_hi:[0,1,0]
    v_pk_mul_f32 v[66:67], v[160:161], v[160:161]
    v_pk_mul_f32 v[68:69], v[162:163], v[162:163]
    v_pk_mul_f32 v[70:71], v[164:165], v[164:165]
    v_pk_mul_f32 v[72:73], v[166:167], v[166:167]
    v_pk_mul_f32 v[74:75], v[168:169], v[168:169]
    v_pk_mul_f32 v[76:77], v[170:171], v[170:171]
    v_pk_mul_f32 v[78:79], v[172:173], v[172:173]
    v_pk_mul_f32 v[80:81], v[174:175], v[174:175]
    v_pk_fma_f32 v[66:67], v[66:67], s[66:67], v[28:29]
    v_pk_fma_f32 v[68:69], v[68:69], s[66:67], v[28:29]
    v_pk_fma_f32 v[70:71], v[70:71], s[66:67], v[28:29]
    buffer_load_dwordx4 v27, s[20:23], s55 offen offset:1024 lds
    v_pk_fma_f32 v[72:73], v[72:73], s[66:67], v[28:29]
    v_pk_fma_f32 v[74:75], v[74:75], s[66:67], v[28:29]
    v_pk_fma_f32 v[76:77], v[76:77], s[66:67], v[28:29]
    v_pk_fma_f32 v[78:79], v[78:79], s[66:67], v[28:29]
    v_pk_fma_f32 v[80:81], v[80:81], s[66:67], v[28:29]
    v_pk_mul_f32 v[66:67], v[66:67], v[160:161]
    v_pk_mul_f32 v[68:69], v[68:69], v[162:163]
    v_pk_mul_f32 v[70:71], v[70:71], v[164:165]
    v_pk_mul_f32 v[72:73], v[72:73], v[166:167]
    v_pk_mul_f32 v[74:75], v[74:75], v[168:169]
    v_pk_mul_f32 v[76:77], v[76:77], v[170:171]
    v_pk_mul_f32 v[78:79], v[78:79], v[172:173]
    s_add_u32 m0, s52, 40960
    s_mov_b32 s55, 1228800
    buffer_load_dwordx4 v26, s[20:23], s55 offen lds
    v_pk_mul_f32 v[80:81], v[80:81], v[174:175]
    v_exp_f32 v66, v66
    v_exp_f32 v67, v67
    v_exp_f32 v68, v68
    v_exp_f32 v69, v69
    v_exp_f32 v70, v70
    v_exp_f32 v71, v71
    v_exp_f32 v72, v72
    v_exp_f32 v73, v73
    v_exp_f32 v74, v74
    v_exp_f32 v75, v75
    v_exp_f32_e64 v76, v76
    buffer_load_dwordx4 v27, s[20:23], s55 offen offset:1024 lds
    v_exp_f32 v77, v77
    v_exp_f32 v78, v78
    v_exp_f32 v79, v79
    v_exp_f32 v80, v80
    v_exp_f32_e64 v81, v81
    v_pk_add_f32 v[66:67], v[66:67], 1.0 op_sel_hi:[1,0]
    v_pk_add_f32 v[68:69], v[68:69], 1.0 op_sel_hi:[1,0]
    v_pk_add_f32 v[70:71], v[70:71], 1.0 op_sel_hi:[1,0]
    v_pk_add_f32 v[72:73], v[72:73], 1.0 op_sel_hi:[1,0]
    v_pk_add_f32 v[74:75], v[74:75], 1.0 op_sel_hi:[1,0]
    v_pk_add_f32 v[76:77], v[76:77], 1.0 op_sel_hi:[1,0]
    v_pk_add_f32 v[78:79], v[78:79], 1.0 op_sel_hi:[1,0]
    s_add_u32 m0, s52, 49152
    s_mov_b32 s55, 1474560
    buffer_load_dwordx4 v26, s[20:23], s55 offen lds
    v_pk_add_f32 v[80:81], v[80:81], 1.0 op_sel_hi:[1,0]
    v_rcp_f32 v66, v66
    v_rcp_f32 v67, v67
    v_rcp_f32 v68, v68
    v_rcp_f32 v69, v69
    v_rcp_f32 v70, v70
    v_rcp_f32 v71, v71
    v_rcp_f32 v72, v72
    v_rcp_f32 v73, v73
    v_rcp_f32 v74, v74
    v_rcp_f32 v75, v75
    v_rcp_f32_e64 v76, v76
    buffer_load_dwordx4 v27, s[20:23], s55 offen offset:1024 lds
    v_rcp_f32 v77, v77
    v_rcp_f32 v78, v78
    v_rcp_f32 v79, v79
    v_rcp_f32 v80, v80
    v_rcp_f32_e64 v81, v81
    v_pk_mul_f32 v[66:67], v[66:67], v[160:161]
    v_pk_mul_f32 v[68:69], v[68:69], v[162:163]
    v_pk_mul_f32 v[70:71], v[70:71], v[164:165]
    v_pk_mul_f32 v[72:73], v[72:73], v[166:167]
    v_pk_mul_f32 v[74:75], v[74:75], v[168:169]
    v_pk_mul_f32 v[76:77], v[76:77], v[170:171]
    v_pk_mul_f32 v[78:79], v[78:79], v[172:173]
    v_pk_mul_f32 v[80:81], v[80:81], v[174:175]
    v_cvt_pk_bf16_f32 v200, v66, v67
    v_cvt_pk_bf16_f32 v201, v68, v69
    v_cvt_pk_bf16_f32 v202, v70, v71
    v_cvt_pk_bf16_f32 v203, v72, v73
    v_cvt_pk_bf16_f32 v204, v74, v75
    v_cvt_pk_bf16_f32 v205, v76, v77
    v_cvt_pk_bf16_f32 v206, v78, v79
    v_cvt_pk_bf16_f32 v207, v80, v81
    v_permlane32_swap_b32 v200, v202
    v_permlane32_swap_b32 v201, v203
    v_permlane32_swap_b32 v204, v206
    v_permlane32_swap_b32 v205, v207
    s_mov_b32 s54, 0xd20000
    buffer_store_dwordx4 v[200:203], v63, s[24:27], s54 offen sc1
    s_mov_b32 s54, 0xd30000
    buffer_store_dwordx4 v[204:207], v63, s[24:27], s54 offen sc1
    s_waitcnt vmcnt(9)
    s_barrier
    s_cmp_lg_u32 s36, 0
    s_cbranch_scc1 L_sig_28
    v_mov_b32_e64 v45, s45
    s_mov_b64 s[58:59], exec
    s_mov_b64 exec, 1
    buffer_store_dword v45, off, s[24:27], s3 sc1
    s_mov_b64 exec, s[58:59]
L_sig_28:
    s_nop 0
    s_add_u32 s3, s3, 32768
    v_pk_mul_f32 v[176:177], v[176:177], v[218:219] op_sel_hi:[1,0]
    v_pk_mul_f32 v[178:179], v[178:179], v[218:219] op_sel_hi:[1,0]
    v_pk_mul_f32 v[180:181], v[180:181], v[218:219] op_sel_hi:[1,0]
    s_add_u32 m0, s52, 57344
    s_mov_b32 s55, 1720320
    buffer_load_dwordx4 v26, s[20:23], s55 offen lds
    v_pk_mul_f32 v[182:183], v[182:183], v[218:219] op_sel_hi:[1,0]
    v_pk_mul_f32 v[184:185], v[184:185], v[218:219] op_sel_hi:[1,0]
    v_pk_mul_f32 v[186:187], v[186:187], v[218:219] op_sel_hi:[1,0]
    v_pk_mul_f32 v[188:189], v[188:189], v[218:219] op_sel_hi:[1,0]
    v_pk_mul_f32 v[190:191], v[190:191], v[218:219] op_sel_hi:[1,0]
    v_pk_fma_f32 v[176:177], v[128:129], v[218:219], v[176:177] op_sel:[0,1,0] op_sel_hi:[1,1,1] neg_lo:[0,1,0] neg_hi:[0,1,0]
    v_pk_fma_f32 v[178:179], v[130:131], v[218:219], v[178:179] op_sel:[0,1,0] op_sel_hi:[1,1,1] neg_lo:[0,1,0] neg_hi:[0,1,0]
    v_pk_fma_f32 v[180:181], v[132:133], v[218:219], v[180:181] op_sel:[0,1,0] op_sel_hi:[1,1,1] neg_lo:[0,1,0] neg_hi:[0,1,0]
    v_pk_fma_f32 v[182:183], v[134:135], v[218:219], v[182:183] op_sel:[0,1,0] op_sel_hi:[1,1,1] neg_lo:[0,1,0] neg_hi:[0,1,0]
    v_pk_fma_f32 v[184:185], v[136:137], v[218:219], v[184:185] op_sel:[0,1,0] op_sel_hi:[1,1,1] neg_lo:[0,1,0] neg_hi:[0,1,0]
    v_pk_fma_f32 v[186:187], v[138:139], v[218:219], v[186:187] op_sel:[0,1,0] op_sel_hi:[1,1,1] neg_lo:[0,1,0] neg_hi:[0,1,0]
    v_pk_fma_f32 v[188:189], v[140:141], v[218:219], v[188:189] op_sel:[0,1,0] op_sel_hi:[1,1,1] neg_lo:[0,1,0] neg_hi:[0,1,0]
    buffer_load_dwordx4 v27, s[20:23], s55 offen offset:1024 lds
    v_pk_fma_f32 v[190:191], v[142:143], v[218:219], v[190:191] op_sel:[0,1,0] op_sel_hi:[1,1,1] neg_lo:[0,1,0] neg_hi:[0,1,0]
    v_pk_mul_f32 v[66:67], v[176:177], v[176:177]
    v_pk_mul_f32 v[68:69], v[178:179], v[178:179]
    v_pk_mul_f32 v[70:71], v[180:181], v[180:181]
    v_pk_mul_f32 v[72:73], v[182:183], v[182:183]
    v_pk_mul_f32 v[74:75], v[184:185], v[184:185]
    v_pk_mul_f32 v[76:77], v[186:187], v[186:187]
    v_pk_mul_f32 v[78:79], v[188:189], v[188:189]
    v_pk_mul_f32 v[80:81], v[190:191], v[190:191]
    v_pk_fma_f32 v[66:67], v[66:67], s[66:67], v[28:29]
    v_pk_fma_f32 v[68:69], v[68:69], s[66:67], v[28:29]
    v_pk_fma_f32 v[70:71], v[70:71], s[66:67], v[28:29]
    s_add_u32 m0, s52, 65536
    s_mov_b32 s55, 40960
    buffer_load_dwordx4 v26, s[20:23], s55 offen lds
    v_pk_fma_f32 v[72:73], v[72:73], s[66:67], v[28:29]
    v_pk_fma_f32 v[74:75], v[74:75], s[66:67], v[28:29]
    v_pk_fma_f32 v[76:77], v[76:77], s[66:67], v[28:29]
    v_pk_fma_f32 v[78:79], v[78:79], s[66:67], v[28:29]
    v_pk_fma_f32 v[80:81], v[80:81], s[66:67], v[28:29]
    v_pk_mul_f32 v[66:67], v[66:67], v[176:177]
    v_pk_mul_f32 v[68:69], v[68:69], v[178:179]
    v_pk_mul_f32 v[70:71], v[70:71], v[180:181]
    v_pk_mul_f32 v[72:73], v[72:73], v[182:183]
    v_pk_mul_f32 v[74:75], v[74:75], v[184:185]
    v_pk_mul_f32 v[76:77], v[76:77], v[186:187]
    v_pk_mul_f32 v[78:79], v[78:79], v[188:189]
    buffer_load_dwordx4 v27, s[20:23], s55 offen offset:1024 lds
    v_pk_mul_f32 v[80:81], v[80:81], v[190:191]
    v_exp_f32 v66, v66
    v_exp_f32 v67, v67
    v_exp_f32 v68, v68
    v_exp_f32 v69, v69
    v_exp_f32 v70, v70
    v_exp_f32 v71, v71
    v_exp_f32 v72, v72
    v_exp_f32 v73, v73
    v_exp_f32 v74, v74
    v_exp_f32 v75, v75
    v_exp_f32_e64 v76, v76
    s_add_u32 m0, s52, 73728
    s_mov_b32 s55, 286720
    buffer_load_dwordx4 v26, s[20:23], s55 offen lds
    v_exp_f32 v77, v77
    v_exp_f32 v78, v78
    v_exp_f32 v79, v79
    v_exp_f32 v80, v80
    v_exp_f32_e64 v81, v81
    v_pk_add_f32 v[66:67], v[66:67], 1.0 op_sel_hi:[1,0]
    v_pk_add_f32 v[68:69], v[68:69], 1.0 op_sel_hi:[1,0]
    v_pk_add_f32 v[70:71], v[70:71], 1.0 op_sel_hi:[1,0]
    v_pk_add_f32 v[72:73], v[72:73], 1.0 op_sel_hi:[1,0]
    v_pk_add_f32 v[74:75], v[74:75], 1.0 op_sel_hi:[1,0]
    v_pk_add_f32 v[76:77], v[76:77], 1.0 op_sel_hi:[1,0]
    v_pk_add_f32 v[78:79], v[78:79], 1.0 op_sel_hi:[1,0]
    buffer_load_dwordx4 v27, s[20:23], s55 offen offset:1024 lds
    v_pk_add_f32 v[80:81], v[80:81], 1.0 op_sel_hi:[1,0]
    v_rcp_f32 v66, v66
    v_rcp_f32 v67, v67
    v_rcp_f32 v68, v68
    v_rcp_f32 v69, v69
    v_rcp_f32 v70, v70
    v_rcp_f32 v71, v71
    v_rcp_f32 v72, v72
    v_rcp_f32 v73, v73
    v_rcp_f32 v74, v74
    v_rcp_f32 v75, v75
    v_rcp_f32 v76, v76
    v_rcp_f32 v77, v77
    v_rcp_f32 v78, v78
    v_rcp_f32 v79, v79
    v_rcp_f32 v80, v80
    v_rcp_f32 v81, v81
    v_pk_mul_f32 v[66:67], v[66:67], v[176:177]
    v_pk_mul_f32 v[68:69], v[68:69], v[178:179]
    v_pk_mul_f32 v[70:71], v[70:71], v[180:181]
    v_pk_mul_f32 v[72:73], v[72:73], v[182:183]
    v_pk_mul_f32 v[74:75], v[74:75], v[184:185]
    v_pk_mul_f32 v[76:77], v[76:77], v[186:187]
    v_pk_mul_f32 v[78:79], v[78:79], v[188:189]
    v_pk_mul_f32 v[80:81], v[80:81], v[190:191]
    v_cvt_pk_bf16_f32 v208, v66, v67
    v_cvt_pk_bf16_f32 v209, v68, v69
    v_cvt_pk_bf16_f32 v210, v70, v71
    v_cvt_pk_bf16_f32 v211, v72, v73
    v_cvt_pk_bf16_f32 v212, v74, v75
    buffer_load_dword v65, v64, s[24:27], 0 offen sc1
    v_cvt_pk_bf16_f32 v213, v76, v77
    v_cvt_pk_bf16_f32 v214, v78, v79
    v_cvt_pk_bf16_f32 v215, v80, v81
    v_permlane32_swap_b32 v208, v210
    v_permlane32_swap_b32 v209, v211
    v_permlane32_swap_b32 v212, v214
    v_permlane32_swap_b32 v213, v215
    s_mov_b32 s54, 0xd40000
    buffer_store_dwordx4 v[208:211], v63, s[24:27], s54 offen sc1
    s_mov_b32 s54, 0xd50000
    buffer_store_dwordx4 v[212:215], v63, s[24:27], s54 offen sc1
    s_waitcnt vmcnt(9)
    s_barrier
    s_cmp_lg_u32 s36, 0
    s_cbranch_scc1 L_sig_29
    v_mov_b32_e64 v45, s45
    s_mov_b64 s[58:59], exec
    s_mov_b64 exec, 1
    buffer_store_dword v45, off, s[24:27], s3 sc1
    s_mov_b64 exec, s[58:59]
L_sig_29:
    s_add_u32 s3, s3, 32768
    s_cmp_lt_u32 s39, 22
    s_cbranch_scc1 L_p4_30
    s_waitcnt vmcnt(0)
    s_barrier
    s_cmp_lg_u32 s36, 0
    s_cbranch_scc1 L_sig_31
    v_mov_b32 v30, s45
    s_mov_b64 s[58:59], exec
    s_mov_b64 exec, 1
    buffer_store_dword v30, off, s[24:27], s3 sc1
    s_mov_b64 exec, s[58:59]
L_sig_31:
    s_mov_b32 s56, s68
    s_lshr_b32 s49, s46, 1
    s_mul_i32 s49, s49, 0
    s_and_b32 s50, s46, 1
    s_mul_i32 s50, s50, 640
L_pf_32:
    s_cmp_ge_u32 s56, 70
    s_cbranch_scc1 L_pfe_33
    s_add_u32 s48, s56, s49
    s_sub_u32 s51, s48, 70
    s_cselect_b32 s48, s48, s51
    s_add_u32 s48, s48, 50
    s_lshl_b32 s48, s48, 6
    v_add_u32_e64 v42, s48, v0
    v_mul_u32_u24 v43, 52429, v42
    v_lshrrev_b32 v43, 18, v43
    v_mul_u32_u24 v44, 5, v43
    v_sub_u32_e64 v42, v42, v44
    v_bfe_u32 v44, v43, 5, 4
    v_mul_u32_u24 v44, 96, v44
    v_lshrrev_b32_e64 v45, 9, v43
    v_lshl_add_u32 v44, v45, 5, v44
    v_and_b32 v43, 31, v43
    v_add_u32 v43, v43, v44
    v_mul_u32_u24 v43, 1280, v43
    v_lshl_add_u32 v42, v42, 7, v43
    buffer_load_dword v44, v42, s[20:23], s50 offen
    s_add_u32 s56, s56, s69
    s_waitcnt vmcnt(1)
    s_branch L_pf_32
L_pfe_33:
    s_waitcnt vmcnt(0)
    s_endpgm
L_p4_30:
    v_lshlrev_b32 v126, 16, v14
    v_and_b32 v127, 0xffff0000, v14
    v_lshlrev_b32_e64 v128, 16, v15
    v_and_b32 v129, 0xffff0000, v15
    v_lshlrev_b32_e64 v130, 16, v16
    v_and_b32 v131, 0xffff0000, v16
    v_lshlrev_b32_e64 v132, 16, v17
    v_and_b32 v133, 0xffff0000, v17
    v_lshlrev_b32_e64 v142, 16, v18
    v_and_b32 v143, 0xffff0000, v18
    v_lshlrev_b32_e64 v144, 16, v19
    v_and_b32 v145, 0xffff0000, v19
    v_lshlrev_b32_e64 v146, 16, v20
    v_and_b32 v147, 0xffff0000, v20
    v_lshlrev_b32_e64 v148, 16, v21
    v_and_b32 v149, 0xffff0000, v21
    v_lshlrev_b32_e64 v158, 16, v22
    v_and_b32 v159, 0xffff0000, v22
    v_lshlrev_b32_e64 v160, 16, v23
    v_and_b32 v161, 0xffff0000, v23
    v_lshlrev_b32_e64 v162, 16, v24
    v_and_b32 v163, 0xffff0000, v24
    v_lshlrev_b32_e64 v164, 16, v25
    v_and_b32 v165, 0xffff0000, v25
    s_mov_b32 s64, 0xbfb8aa3b
    s_mov_b32 s65, 0xbfb8aa3b
    s_waitcnt vmcnt(3)
    s_waitcnt lgkmcnt(0)
    s_waitcnt vmcnt(2)
    v_cmp_ne_u32 vcc, s45, v65
    s_cmp_lg_u32 s36, 0
    s_cbranch_scc1 L_ok_34
    s_nop 1
    s_cbranch_vccz L_ok_34
    s_mov_b64 s[58:59], exec
    s_mov_b32 exec_lo, -1
    s_mov_b32 exec_hi, -1
    s_mov_b32 s56, 0
L_poll_35:
    buffer_load_dword v65, v64, s[24:27], 0 offen sc1
    s_waitcnt vmcnt(0)
    v_cmp_ne_u32_e64 vcc, s45, v65
    s_add_u32 s56, s56, 1
    s_nop 2
    s_cbranch_vccz L_polled_36
    s_cmp_lt_u32 s56, 100000
    s_cbranch_scc1 L_poll_35
L_polled_36:
    s_mov_b64 exec, s[58:59]
L_ok_34:
    s_barrier
    s_nop 0
    v_add_u32 v64, 32768, v64
    buffer_load_dword v65, v64, s[24:27], 0 offen sc1
    s_mov_b32 s54, 0xd00000
    buffer_load_dwordx4 v[66:69], v41, s[24:27], s54 offen offset:0 sc1
    buffer_load_dwordx4 v[70:73], v41, s[24:27], s54 offen offset:512 sc1
    buffer_load_dwordx4 v[74:77], v41, s[24:27], s54 offen offset:1024 sc1
    s_mov_b32 s54, 0xdc0000
    buffer_load_dwordx4 v[78:81], v41, s[24:27], s54 offen offset:0 sc1
    buffer_load_dwordx4 v[82:85], v41, s[24:27], s54 offen offset:512 sc1
    buffer_load_dwordx4 v[86:89], v41, s[24:27], s54 offen offset:1024 sc1
    s_mov_b32 s54, 0xe80000
    buffer_load_dwordx4 v[90:93], v41, s[24:27], s54 offen offset:0 sc1
    buffer_load_dwordx4 v[94:97], v41, s[24:27], s54 offen offset:512 sc1
    buffer_load_dwordx4 v[98:101], v41, s[24:27], s54 offen offset:1024 sc1
    s_mov_b32 s54, 0xf40000
    buffer_load_dwordx4 v[102:105], v41, s[24:27], s54 offen offset:0 sc1
    buffer_load_dwordx4 v[106:109], v41, s[24:27], s54 offen offset:512 sc1
    buffer_load_dwordx4 v[110:113], v41, s[24:27], s54 offen offset:1024 sc1
    ds_read_b64_tr_b16 v[174:175], v33 offset:0
    ds_read_b64_tr_b16 v[176:177], v33 offset:512
    ds_read_b64_tr_b16 v[178:179], v34 offset:0
    ds_read_b64_tr_b16 v[180:181], v34 offset:512
    ds_read_b64_tr_b16 v[182:183], v35 offset:0
    ds_read_b64_tr_b16 v[184:185], v35 offset:512
    ds_read_b64_tr_b16 v[186:187], v36 offset:0
    ds_read_b64_tr_b16 v[188:189], v36 offset:512
    s_waitcnt vmcnt(9) lgkmcnt(0)
    s_nop 0
    v_mfma_f32_16x16x32_bf16 v[126:129], v[174:177], v[66:69], v[126:129]
    ds_read_b64_tr_b16 v[190:191], v33 offset:8192
    v_mfma_f32_16x16x32_bf16 v[142:145], v[174:177], v[70:73], v[142:145]
    ds_read_b64_tr_b16 v[192:193], v33 offset:8704
    s_mov_b32 s54, 0x1000000
    buffer_load_dwordx4 v[114:117], v41, s[24:27], s54 offen offset:0 sc1
    v_mfma_f32_16x16x32_bf16 v[158:161], v[174:177], v[74:77], v[158:161]
    ds_read_b64_tr_b16 v[194:195], v34 offset:8192
    v_mfma_f32_16x16x32_bf16 v[130:133], v[178:181], v[66:69], v[130:133]
    ds_read_b64_tr_b16 v[196:197], v34 offset:8704
    v_mfma_f32_16x16x32_bf16 v[146:149], v[178:181], v[70:73], v[146:149]
    ds_read_b64_tr_b16 v[198:199], v35 offset:8192
    v_mfma_f32_16x16x32_bf16 v[162:165], v[178:181], v[74:77], v[162:165]
    ds_read_b64_tr_b16 v[200:201], v35 offset:8704
    buffer_load_dwordx4 v[118:121], v41, s[24:27], s54 offen offset:512 sc1
    v_mfma_f32_16x16x32_bf16 v[134:137], v[182:185], v[66:69], 0
    ds_read_b64_tr_b16 v[202:203], v36 offset:8192
    v_mfma_f32_16x16x32_bf16 v[150:153], v[182:185], v[70:73], 0
    ds_read_b64_tr_b16 v[204:205], v36 offset:8704
    v_mfma_f32_16x16x32_bf16 v[166:169], v[182:185], v[74:77], 0
    v_mfma_f32_16x16x32_bf16 v[138:141], v[186:189], v[66:69], 0
    buffer_load_dwordx4 v[122:125], v41, s[24:27], s54 offen offset:1024 sc1
    v_mfma_f32_16x16x32_bf16 v[154:157], v[186:189], v[70:73], 0
    v_mfma_f32_16x16x32_bf16 v[170:173], v[186:189], v[74:77], 0
    s_waitcnt vmcnt(9) lgkmcnt(0)
    s_barrier
    s_cmp_lg_u32 s36, 0
    s_cbranch_scc1 L_sig_37
    v_mov_b32_e64 v42, s45
    s_mov_b64 s[58:59], exec
    s_mov_b64 exec, 1
    buffer_store_dword v42, off, s[24:27], s3 sc1
    s_mov_b64 exec, s[58:59]
L_sig_37:
    s_nop 0
    v_mfma_f32_16x16x32_bf16 v[126:129], v[190:193], v[78:81], v[126:129]
    ds_read_b64_tr_b16 v[174:175], v33 offset:16384
    v_mfma_f32_16x16x32_bf16 v[142:145], v[190:193], v[82:85], v[142:145]
    ds_read_b64_tr_b16 v[176:177], v33 offset:16896
    s_mov_b32 s54, 0x10c0000
    buffer_load_dwordx4 v[66:69], v41, s[24:27], s54 offen offset:0 sc1
    v_mfma_f32_16x16x32_bf16 v[158:161], v[190:193], v[86:89], v[158:161]
    ds_read_b64_tr_b16 v[178:179], v34 offset:16384
    v_mfma_f32_16x16x32_bf16 v[130:133], v[194:197], v[78:81], v[130:133]
    ds_read_b64_tr_b16 v[180:181], v34 offset:16896
    s_add_u32 m0, s52, 0
    s_nop 0
    s_mov_b32 s55, 532480
    buffer_load_dwordx4 v26, s[20:23], s55 offen lds
    v_mfma_f32_16x16x32_bf16 v[146:149], v[194:197], v[82:85], v[146:149]
    ds_read_b64_tr_b16 v[182:183], v35 offset:16384
    v_mfma_f32_16x16x32_bf16 v[162:165], v[194:197], v[86:89], v[162:165]
    ds_read_b64_tr_b16 v[184:185], v35 offset:16896
    buffer_load_dwordx4 v[70:73], v41, s[24:27], s54 offen offset:512 sc1
    v_mfma_f32_16x16x32_bf16 v[134:137], v[198:201], v[78:81], v[134:137]
    ds_read_b64_tr_b16 v[186:187], v36 offset:16384
    v_mfma_f32_16x16x32_bf16 v[150:153], v[198:201], v[82:85], v[150:153]
    ds_read_b64_tr_b16 v[188:189], v36 offset:16896
    buffer_load_dwordx4 v27, s[20:23], s55 offen offset:1024 lds
    v_mfma_f32_16x16x32_bf16 v[166:169], v[198:201], v[86:89], v[166:169]
    v_mfma_f32_16x16x32_bf16 v[138:141], v[202:205], v[78:81], v[138:141]
    buffer_load_dwordx4 v[74:77], v41, s[24:27], s54 offen offset:1024 sc1
    v_mfma_f32_16x16x32_bf16 v[154:157], v[202:205], v[82:85], v[154:157]
    v_mfma_f32_16x16x32_bf16 v[170:173], v[202:205], v[86:89], v[170:173]
    s_waitcnt vmcnt(11) lgkmcnt(0)
    s_nop 0
    v_mfma_f32_16x16x32_bf16 v[126:129], v[174:177], v[90:93], v[126:129]
    ds_read_b64_tr_b16 v[190:191], v33 offset:24576
    v_mfma_f32_16x16x32_bf16 v[142:145], v[174:177], v[94:97], v[142:145]
    ds_read_b64_tr_b16 v[192:193], v33 offset:25088
    s_mov_b32 s54, 0x1180000
    buffer_load_dwordx4 v[78:81], v41, s[24:27], s54 offen offset:0 sc1
    v_mfma_f32_16x16x32_bf16 v[158:161], v[174:177], v[98:101], v[158:161]
    ds_read_b64_tr_b16 v[194:195], v34 offset:24576
    v_mfma_f32_16x16x32_bf16 v[130:133], v[178:181], v[90:93], v[130:133]
    ds_read_b64_tr_b16 v[196:197], v34 offset:25088
    s_add_u32 m0, s52, 8192
    s_mov_b32 s55, 778240
    buffer_load_dwordx4 v26, s[20:23], s55 offen lds
    v_mfma_f32_16x16x32_bf16 v[146:149], v[178:181], v[94:97], v[146:149]
    ds_read_b64_tr_b16 v[198:199], v35 offset:24576
    v_mfma_f32_16x16x32_bf16 v[162:165], v[178:181], v[98:101], v[162:165]
    ds_read_b64_tr_b16 v[200:201], v35 offset:25088
    buffer_load_dwordx4 v[82:85], v41, s[24:27], s54 offen offset:512 sc1
    v_mfma_f32_16x16x32_bf16 v[134:137], v[182:185], v[90:93], v[134:137]
    ds_read_b64_tr_b16 v[202:203], v36 offset:24576
    v_mfma_f32_16x16x32_bf16 v[150:153], v[182:185], v[94:97], v[150:153]
    ds_read_b64_tr_b16 v[204:205], v36 offset:25088
    buffer_load_dwordx4 v27, s[20:23], s55 offen offset:1024 lds
    v_mfma_f32_16x16x32_bf16 v[166:169], v[182:185], v[98:101], v[166:169]
    v_mfma_f32_16x16x32_bf16 v[138:141], v[186:189], v[90:93], v[138:141]
    buffer_load_dwordx4 v[86:89], v41, s[24:27], s54 offen offset:1024 sc1
    v_mfma_f32_16x16x32_bf16 v[154:157], v[186:189], v[94:97], v[154:157]
    v_mfma_f32_16x16x32_bf16 v[170:173], v[186:189], v[98:101], v[170:173]
    s_waitcnt vmcnt(13) lgkmcnt(0)
    v_cmp_ne_u32 vcc, s45, v65
    s_cmp_lg_u32 s36, 0
    s_cbranch_scc1 L_ok_38
    s_nop 1
    s_cbranch_vccz L_ok_38
    s_mov_b64 s[58:59], exec
    s_mov_b32 exec_lo, -1
    s_mov_b32 exec_hi, -1
    s_mov_b32 s56, 0
L_poll_39:
    buffer_load_dword v65, v64, s[24:27], 0 offen sc1
    s_waitcnt vmcnt(0)
    v_cmp_ne_u32_e64 vcc, s45, v65
    s_add_u32 s56, s56, 1
    s_nop 2
    s_cbranch_vccz L_polled_40
    s_cmp_lt_u32 s56, 100000
    s_cbranch_scc1 L_poll_39
L_polled_40:
    s_mov_b64 exec, s[58:59]
L_ok_38:
    s_barrier
    s_nop 0
    v_mfma_f32_16x16x32_bf16 v[126:129], v[190:193], v[102:105], v[126:129]
    ds_read_b64_tr_b16 v[174:175], v37 offset:0
    v_mfma_f32_16x16x32_bf16 v[142:145], v[190:193], v[106:109], v[142:145]
    ds_read_b64_tr_b16 v[176:177], v37 offset:512
    s_mov_b32 s54, 0x1240000
    buffer_load_dwordx4 v[90:93], v41, s[24:27], s54 offen offset:0 sc1
    v_mfma_f32_16x16x32_bf16 v[158:161], v[190:193], v[110:113], v[158:161]
    ds_read_b64_tr_b16 v[178:179], v38 offset:0
    v_mfma_f32_16x16x32_bf16 v[130:133], v[194:197], v[102:105], v[130:133]
    ds_read_b64_tr_b16 v[180:181], v38 offset:512
    s_add_u32 m0, s52, 16384
    s_mov_b32 s55, 1024000
    buffer_load_dwordx4 v26, s[20:23], s55 offen lds
    v_mfma_f32_16x16x32_bf16 v[146:149], v[194:197], v[106:109], v[146:149]
    ds_read_b64_tr_b16 v[182:183], v39 offset:0
    v_mfma_f32_16x16x32_bf16 v[162:165], v[194:197], v[110:113], v[162:165]
    ds_read_b64_tr_b16 v[184:185], v39 offset:512
    buffer_load_dwordx4 v[94:97], v41, s[24:27], s54 offen offset:512 sc1
    v_mfma_f32_16x16x32_bf16 v[134:137], v[198:201], v[102:105], v[134:137]
    ds_read_b64_tr_b16 v[186:187], v40 offset:0
    v_mfma_f32_16x16x32_bf16 v[150:153], v[198:201], v[106:109], v[150:153]
    ds_read_b64_tr_b16 v[188:189], v40 offset:512
    buffer_load_dwordx4 v27, s[20:23], s55 offen offset:1024 lds
    v_mfma_f32_16x16x32_bf16 v[166:169], v[198:201], v[110:113], v[166:169]
    v_mfma_f32_16x16x32_bf16 v[138:141], v[202:205], v[102:105], v[138:141]
    buffer_load_dwordx4 v[98:101], v41, s[24:27], s54 offen offset:1024 sc1
    v_mfma_f32_16x16x32_bf16 v[154:157], v[202:205], v[106:109], v[154:157]
    v_mfma_f32_16x16x32_bf16 v[170:173], v[202:205], v[110:113], v[170:173]
    s_waitcnt vmcnt(15) lgkmcnt(0)
    s_nop 0
    v_mfma_f32_16x16x32_bf16 v[126:129], v[174:177], v[114:117], v[126:129]
    ds_read_b64_tr_b16 v[190:191], v37 offset:8192
    v_mfma_f32_16x16x32_bf16 v[142:145], v[174:177], v[118:121], v[142:145]
    ds_read_b64_tr_b16 v[192:193], v37 offset:8704
    s_mov_b32 s54, 0xd20000
    buffer_load_dwordx4 v[102:105], v41, s[24:27], s54 offen offset:0 sc1
    v_mfma_f32_16x16x32_bf16 v[158:161], v[174:177], v[122:125], v[158:161]
    ds_read_b64_tr_b16 v[194:195], v38 offset:8192
    v_mfma_f32_16x16x32_bf16 v[130:133], v[178:181], v[114:117], v[130:133]
    ds_read_b64_tr_b16 v[196:197], v38 offset:8704
    s_add_u32 m0, s52, 24576
    s_mov_b32 s55, 1269760
    buffer_load_dwordx4 v26, s[20:23], s55 offen lds
    v_mfma_f32_16x16x32_bf16 v[146:149], v[178:181], v[118:121], v[146:149]
    ds_read_b64_tr_b16 v[198:199], v39 offset:8192
    v_mfma_f32_16x16x32_bf16 v[162:165], v[178:181], v[122:125], v[162:165]
    ds_read_b64_tr_b16 v[200:201], v39 offset:8704
    buffer_load_dwordx4 v[106:109], v41, s[24:27], s54 offen offset:512 sc1
    v_mfma_f32_16x16x32_bf16 v[134:137], v[182:185], v[114:117], v[134:137]
    ds_read_b64_tr_b16 v[202:203], v40 offset:8192
    v_mfma_f32_16x16x32_bf16 v[150:153], v[182:185], v[118:121], v[150:153]
    ds_read_b64_tr_b16 v[204:205], v40 offset:8704
    buffer_load_dwordx4 v27, s[20:23], s55 offen offset:1024 lds
    v_mfma_f32_16x16x32_bf16 v[166:169], v[182:185], v[122:125], v[166:169]
    v_mfma_f32_16x16x32_bf16 v[138:141], v[186:189], v[114:117], v[138:141]
    buffer_load_dwordx4 v[110:113], v41, s[24:27], s54 offen offset:1024 sc1
    v_mfma_f32_16x16x32_bf16 v[154:157], v[186:189], v[118:121], v[154:157]
    v_mfma_f32_16x16x32_bf16 v[170:173], v[186:189], v[122:125], v[170:173]
    s_waitcnt vmcnt(15) lgkmcnt(0)
    s_barrier
    v_mfma_f32_16x16x32_bf16 v[126:129], v[190:193], v[66:69], v[126:129]
    ds_read_b64_tr_b16 v[174:175], v37 offset:16384
    v_mfma_f32_16x16x32_bf16 v[142:145], v[190:193], v[70:73], v[142:145]
    ds_read_b64_tr_b16 v[176:177], v37 offset:16896
    s_mov_b32 s54, 0xde0000
    buffer_load_dwordx4 v[114:117], v41, s[24:27], s54 offen offset:0 sc1
    v_mfma_f32_16x16x32_bf16 v[158:161], v[190:193], v[74:77], v[158:161]
    ds_read_b64_tr_b16 v[178:179], v38 offset:16384
    v_mfma_f32_16x16x32_bf16 v[130:133], v[194:197], v[66:69], v[130:133]
    ds_read_b64_tr_b16 v[180:181], v38 offset:16896
    s_add_u32 m0, s52, 32768
    s_mov_b32 s55, 1515520
    buffer_load_dwordx4 v26, s[20:23], s55 offen lds
    v_mfma_f32_16x16x32_bf16 v[146:149], v[194:197], v[70:73], v[146:149]
    ds_read_b64_tr_b16 v[182:183], v39 offset:16384
    v_mfma_f32_16x16x32_bf16 v[162:165], v[194:197], v[74:77], v[162:165]
    ds_read_b64_tr_b16 v[184:185], v39 offset:16896
    buffer_load_dwordx4 v[118:121], v41, s[24:27], s54 offen offset:512 sc1
    v_mfma_f32_16x16x32_bf16 v[134:137], v[198:201], v[66:69], v[134:137]
    ds_read_b64_tr_b16 v[186:187], v40 offset:16384
    v_mfma_f32_16x16x32_bf16 v[150:153], v[198:201], v[70:73], v[150:153]
    ds_read_b64_tr_b16 v[188:189], v40 offset:16896
    buffer_load_dwordx4 v27, s[20:23], s55 offen offset:1024 lds
    v_mfma_f32_16x16x32_bf16 v[166:169], v[198:201], v[74:77], v[166:169]
    v_mfma_f32_16x16x32_bf16 v[138:141], v[202:205], v[66:69], v[138:141]
    buffer_load_dwordx4 v[122:125], v41, s[24:27], s54 offen offset:1024 sc1
    v_mfma_f32_16x16x32_bf16 v[154:157], v[202:205], v[70:73], v[154:157]
    v_mfma_f32_16x16x32_bf16 v[170:173], v[202:205], v[74:77], v[170:173]
    s_waitcnt vmcnt(15) lgkmcnt(0)
    s_nop 0
    v_mfma_f32_16x16x32_bf16 v[126:129], v[174:177], v[78:81], v[126:129]
    ds_read_b64_tr_b16 v[190:191], v37 offset:24576
    v_mfma_f32_16x16x32_bf16 v[142:145], v[174:177], v[82:85], v[142:145]
    ds_read_b64_tr_b16 v[192:193], v37 offset:25088
    s_mov_b32 s54, 0xea0000
    buffer_load_dwordx4 v[66:69], v41, s[24:27], s54 offen offset:0 sc1
    v_mfma_f32_16x16x32_bf16 v[158:161], v[174:177], v[86:89], v[158:161]
    ds_read_b64_tr_b16 v[194:195], v38 offset:24576
    v_mfma_f32_16x16x32_bf16 v[130:133], v[178:181], v[78:81], v[130:133]
    ds_read_b64_tr_b16 v[196:197], v38 offset:25088
    s_add_u32 m0, s52, 40960
    s_mov_b32 s55, 1761280
    buffer_load_dwordx4 v26, s[20:23], s55 offen lds
    v_mfma_f32_16x16x32_bf16 v[146:149], v[178:181], v[82:85], v[146:149]
    ds_read_b64_tr_b16 v[198:199], v39 offset:24576
    v_mfma_f32_16x16x32_bf16 v[162:165], v[178:181], v[86:89], v[162:165]
    ds_read_b64_tr_b16 v[200:201], v39 offset:25088
    buffer_load_dwordx4 v[70:73], v41, s[24:27], s54 offen offset:512 sc1
    v_mfma_f32_16x16x32_bf16 v[134:137], v[182:185], v[78:81], v[134:137]
    ds_read_b64_tr_b16 v[202:203], v40 offset:24576
    v_mfma_f32_16x16x32_bf16 v[150:153], v[182:185], v[82:85], v[150:153]
    ds_read_b64_tr_b16 v[204:205], v40 offset:25088
    buffer_load_dwordx4 v27, s[20:23], s55 offen offset:1024 lds
    v_mfma_f32_16x16x32_bf16 v[166:169], v[182:185], v[86:89], v[166:169]
    v_add_u32 v64, 32768, v64
    buffer_load_dword v65, v64, s[24:27], 0 offen sc1
    v_mfma_f32_16x16x32_bf16 v[138:141], v[186:189], v[78:81], v[138:141]
    buffer_load_dwordx4 v[74:77], v41, s[24:27], s54 offen offset:1024 sc1
    v_mfma_f32_16x16x32_bf16 v[154:157], v[186:189], v[82:85], v[154:157]
    v_mfma_f32_16x16x32_bf16 v[170:173], v[186:189], v[86:89], v[170:173]
    s_waitcnt vmcnt(16) lgkmcnt(0)
    s_barrier
    v_mfma_f32_16x16x32_bf16 v[126:129], v[190:193], v[90:93], v[126:129]
    ds_read_b64_tr_b16 v[174:175], v37 offset:32768
    v_mfma_f32_16x16x32_bf16 v[142:145], v[190:193], v[94:97], v[142:145]
    ds_read_b64_tr_b16 v[176:177], v37 offset:33280
    s_mov_b32 s54, 0xf60000
    buffer_load_dwordx4 v[78:81], v41, s[24:27], s54 offen offset:0 sc1
    v_mfma_f32_16x16x32_bf16 v[158:161], v[190:193], v[98:101], v[158:161]
    ds_read_b64_tr_b16 v[178:179], v38 offset:32768
    v_mfma_f32_16x16x32_bf16 v[130:133], v[194:197], v[90:93], v[130:133]
    ds_read_b64_tr_b16 v[180:181], v38 offset:33280
    s_add_u32 m0, s52, 49152
    s_mov_b32 s55, 81920
    buffer_load_dwordx4 v26, s[20:23], s55 offen lds
    v_mfma_f32_16x16x32_bf16 v[146:149], v[194:197], v[94:97], v[146:149]
    ds_read_b64_tr_b16 v[182:183], v39 offset:32768
    v_mfma_f32_16x16x32_bf16 v[162:165], v[194:197], v[98:101], v[162:165]
    ds_read_b64_tr_b16 v[184:185], v39 offset:33280
    buffer_load_dwordx4 v[82:85], v41, s[24:27], s54 offen offset:512 sc1
    v_mfma_f32_16x16x32_bf16 v[134:137], v[198:201], v[90:93], v[134:137]
    ds_read_b64_tr_b16 v[186:187], v40 offset:32768
    v_mfma_f32_16x16x32_bf16 v[150:153], v[198:201], v[94:97], v[150:153]
    ds_read_b64_tr_b16 v[188:189], v40 offset:33280
    buffer_load_dwordx4 v27, s[20:23], s55 offen offset:1024 lds
    v_mfma_f32_16x16x32_bf16 v[166:169], v[198:201], v[98:101], v[166:169]
    v_mfma_f32_16x16x32_bf16 v[138:141], v[202:205], v[90:93], v[138:141]
    buffer_load_dwordx4 v[86:89], v41, s[24:27], s54 offen offset:1024 sc1
    v_mfma_f32_16x16x32_bf16 v[154:157], v[202:205], v[94:97], v[154:157]
    v_mfma_f32_16x16x32_bf16 v[170:173], v[202:205], v[98:101], v[170:173]
    s_waitcnt vmcnt(16) lgkmcnt(0)
    s_nop 0
    v_mfma_f32_16x16x32_bf16 v[126:129], v[174:177], v[102:105], v[126:129]
    ds_read_b64_tr_b16 v[190:191], v37 offset:40960
    v_mfma_f32_16x16x32_bf16 v[142:145], v[174:177], v[106:109], v[142:145]
    ds_read_b64_tr_b16 v[192:193], v37 offset:41472
    s_mov_b32 s54, 0x1020000
    buffer_load_dwordx4 v[90:93], v41, s[24:27], s54 offen offset:0 sc1
    v_mfma_f32_16x16x32_bf16 v[158:161], v[174:177], v[110:113], v[158:161]
    ds_read_b64_tr_b16 v[194:195], v38 offset:40960
    v_mfma_f32_16x16x32_bf16 v[130:133], v[178:181], v[102:105], v[130:133]
    ds_read_b64_tr_b16 v[196:197], v38 offset:41472
    s_add_u32 m0, s52, 57344
    s_mov_b32 s55, 327680
    buffer_load_dwordx4 v26, s[20:23], s55 offen lds
    v_mfma_f32_16x16x32_bf16 v[146:149], v[178:181], v[106:109], v[146:149]
    ds_read_b64_tr_b16 v[198:199], v39 offset:40960
    v_mfma_f32_16x16x32_bf16 v[162:165], v[178:181], v[110:113], v[162:165]
    ds_read_b64_tr_b16 v[200:201], v39 offset:41472
    buffer_load_dwordx4 v[94:97], v41, s[24:27], s54 offen offset:512 sc1
    v_mfma_f32_16x16x32_bf16 v[134:137], v[182:185], v[102:105], v[134:137]
    ds_read_b64_tr_b16 v[202:203], v40 offset:40960
    v_mfma_f32_16x16x32_bf16 v[150:153], v[182:185], v[106:109], v[150:153]
    ds_read_b64_tr_b16 v[204:205], v40 offset:41472
    buffer_load_dwordx4 v27, s[20:23], s55 offen offset:1024 lds
    v_mfma_f32_16x16x32_bf16 v[166:169], v[182:185], v[110:113], v[166:169]
    v_mfma_f32_16x16x32_bf16 v[138:141], v[186:189], v[102:105], v[138:141]
    buffer_load_dwordx4 v[98:101], v41, s[24:27], s54 offen offset:1024 sc1
    v_mfma_f32_16x16x32_bf16 v[154:157], v[186:189], v[106:109], v[154:157]
    v_mfma_f32_16x16x32_bf16 v[170:173], v[186:189], v[110:113], v[170:173]
    s_waitcnt vmcnt(16) lgkmcnt(0)
    s_barrier
    v_mfma_f32_16x16x32_bf16 v[126:129], v[190:193], v[114:117], v[126:129]
    ds_read_b64_tr_b16 v[174:175], v33 offset:0
    v_mfma_f32_16x16x32_bf16 v[142:145], v[190:193], v[118:121], v[142:145]
    ds_read_b64_tr_b16 v[176:177], v33 offset:512
    s_mov_b32 s54, 0x10e0000
    buffer_load_dwordx4 v[102:105], v41, s[24:27], s54 offen offset:0 sc1
    v_mfma_f32_16x16x32_bf16 v[158:161], v[190:193], v[122:125], v[158:161]
    ds_read_b64_tr_b16 v[178:179], v34 offset:0
    v_mfma_f32_16x16x32_bf16 v[130:133], v[194:197], v[114:117], v[130:133]
    ds_read_b64_tr_b16 v[180:181], v34 offset:512
    s_add_u32 m0, s52, 65536
    s_mov_b32 s55, 573440
    buffer_load_dwordx4 v26, s[20:23], s55 offen lds
    v_mfma_f32_16x16x32_bf16 v[146:149], v[194:197], v[118:121], v[146:149]
    ds_read_b64_tr_b16 v[182:183], v35 offset:0
    v_mfma_f32_16x16x32_bf16 v[162:165], v[194:197], v[122:125], v[162:165]
    ds_read_b64_tr_b16 v[184:185], v35 offset:512
    buffer_load_dwordx4 v[106:109], v41, s[24:27], s54 offen offset:512 sc1
    v_mfma_f32_16x16x32_bf16 v[134:137], v[198:201], v[114:117], v[134:137]
    ds_read_b64_tr_b16 v[186:187], v36 offset:0
    v_mfma_f32_16x16x32_bf16 v[150:153], v[198:201], v[118:121], v[150:153]
    ds_read_b64_tr_b16 v[188:189], v36 offset:512
    buffer_load_dwordx4 v27, s[20:23], s55 offen offset:1024 lds
    v_mfma_f32_16x16x32_bf16 v[166:169], v[198:201], v[122:125], v[166:169]
    v_mfma_f32_16x16x32_bf16 v[138:141], v[202:205], v[114:117], v[138:141]
    buffer_load_dwordx4 v[110:113], v41, s[24:27], s54 offen offset:1024 sc1
    v_mfma_f32_16x16x32_bf16 v[154:157], v[202:205], v[118:121], v[154:157]
    v_mfma_f32_16x16x32_bf16 v[170:173], v[202:205], v[122:125], v[170:173]
    s_waitcnt vmcnt(15) lgkmcnt(0)
    s_nop 0
    v_mfma_f32_16x16x32_bf16 v[126:129], v[174:177], v[66:69], v[126:129]
    ds_read_b64_tr_b16 v[190:191], v33 offset:8192
    v_mfma_f32_16x16x32_bf16 v[142:145], v[174:177], v[70:73], v[142:145]
    ds_read_b64_tr_b16 v[192:193], v33 offset:8704
    s_mov_b32 s54, 0x11a0000
    buffer_load_dwordx4 v[114:117], v41, s[24:27], s54 offen offset:0 sc1
    v_mfma_f32_16x16x32_bf16 v[158:161], v[174:177], v[74:77], v[158:161]
    ds_read_b64_tr_b16 v[194:195], v34 offset:8192
    v_mfma_f32_16x16x32_bf16 v[130:133], v[178:181], v[66:69], v[130:133]
    ds_read_b64_tr_b16 v[196:197], v34 offset:8704
    s_add_u32 m0, s52, 73728
    s_mov_b32 s55, 819200
    buffer_load_dwordx4 v26, s[20:23], s55 offen lds
    v_mfma_f32_16x16x32_bf16 v[146:149], v[178:181], v[70:73], v[146:149]
    ds_read_b64_tr_b16 v[198:199], v35 offset:8192
    v_mfma_f32_16x16x32_bf16 v[162:165], v[178:181], v[74:77], v[162:165]
    ds_read_b64_tr_b16 v[200:201], v35 offset:8704
    buffer_load_dwordx4 v[118:121], v41, s[24:27], s54 offen offset:512 sc1
    v_mfma_f32_16x16x32_bf16 v[134:137], v[182:185], v[66:69], v[134:137]
    ds_read_b64_tr_b16 v[202:203], v36 offset:8192
    v_mfma_f32_16x16x32_bf16 v[150:153], v[182:185], v[70:73], v[150:153]
    ds_read_b64_tr_b16 v[204:205], v36 offset:8704
    buffer_load_dwordx4 v27, s[20:23], s55 offen offset:1024 lds
    v_mfma_f32_16x16x32_bf16 v[166:169], v[182:185], v[74:77], v[166:169]
    buffer_load_dword v45, v52, s[24:27], 0 offen sc1
    v_mfma_f32_16x16x32_bf16 v[138:141], v[186:189], v[66:69], v[138:141]
    buffer_load_dwordx4 v[122:125], v41, s[24:27], s54 offen offset:1024 sc1
    v_mfma_f32_16x16x32_bf16 v[154:157], v[186:189], v[70:73], v[154:157]
    v_mfma_f32_16x16x32_bf16 v[170:173], v[186:189], v[74:77], v[170:173]
    s_waitcnt vmcnt(16) lgkmcnt(0)
    v_cmp_ne_u32 vcc, s45, v65
    s_cmp_lg_u32 s36, 0
    s_cbranch_scc1 L_ok_41
    s_nop 1
    s_cbranch_vccz L_ok_41
    s_mov_b64 s[58:59], exec
    s_mov_b32 exec_lo, -1
    s_mov_b32 exec_hi, -1
    s_mov_b32 s56, 0
L_poll_42:
    buffer_load_dword v65, v64, s[24:27], 0 offen sc1
    s_waitcnt vmcnt(0)
    v_cmp_ne_u32_e64 vcc, s45, v65
    s_add_u32 s56, s56, 1
    s_nop 2
    s_cbranch_vccz L_polled_43
    s_cmp_lt_u32 s56, 100000
    s_cbranch_scc1 L_poll_42
L_polled_43:
    s_mov_b64 exec, s[58:59]
L_ok_41:
    s_barrier
    s_nop 0
    v_mfma_f32_16x16x32_bf16 v[126:129], v[190:193], v[78:81], v[126:129]
    ds_read_b64_tr_b16 v[174:175], v33 offset:16384
    v_mfma_f32_16x16x32_bf16 v[142:145], v[190:193], v[82:85], v[142:145]
    ds_read_b64_tr_b16 v[176:177], v33 offset:16896
    s_mov_b32 s54, 0x1260000
    buffer_load_dwordx4 v[66:69], v41, s[24:27], s54 offen offset:0 sc1
    v_mfma_f32_16x16x32_bf16 v[158:161], v[190:193], v[86:89], v[158:161]
    ds_read_b64_tr_b16 v[178:179], v34 offset:16384
    v_mfma_f32_16x16x32_bf16 v[130:133], v[194:197], v[78:81], v[130:133]
    ds_read_b64_tr_b16 v[180:181], v34 offset:16896
    s_add_u32 m0, s52, 0
    s_nop 0
    s_mov_b32 s55, 1064960
    buffer_load_dwordx4 v26, s[20:23], s55 offen lds
    v_mfma_f32_16x16x32_bf16 v[146:149], v[194:197], v[82:85], v[146:149]
    ds_read_b64_tr_b16 v[182:183], v35 offset:16384
    v_mfma_f32_16x16x32_bf16 v[162:165], v[194:197], v[86:89], v[162:165]
    ds_read_b64_tr_b16 v[184:185], v35 offset:16896
    buffer_load_dwordx4 v[70:73], v41, s[24:27], s54 offen offset:512 sc1
    v_mfma_f32_16x16x32_bf16 v[134:137], v[198:201], v[78:81], v[134:137]
    ds_read_b64_tr_b16 v[186:187], v36 offset:16384
    v_mfma_f32_16x16x32_bf16 v[150:153], v[198:201], v[82:85], v[150:153]
    ds_read_b64_tr_b16 v[188:189], v36 offset:16896
    buffer_load_dwordx4 v27, s[20:23], s55 offen offset:1024 lds
    v_mfma_f32_16x16x32_bf16 v[166:169], v[198:201], v[86:89], v[166:169]
    v_mfma_f32_16x16x32_bf16 v[138:141], v[202:205], v[78:81], v[138:141]
    buffer_load_dwordx4 v[74:77], v41, s[24:27], s54 offen offset:1024 sc1
    v_mfma_f32_16x16x32_bf16 v[154:157], v[202:205], v[82:85], v[154:157]
    v_mfma_f32_16x16x32_bf16 v[170:173], v[202:205], v[86:89], v[170:173]
    s_waitcnt vmcnt(16) lgkmcnt(0)
    s_nop 0
    v_mfma_f32_16x16x32_bf16 v[126:129], v[174:177], v[90:93], v[126:129]
    ds_read_b64_tr_b16 v[190:191], v33 offset:24576
    v_mfma_f32_16x16x32_bf16 v[142:145], v[174:177], v[94:97], v[142:145]
    ds_read_b64_tr_b16 v[192:193], v33 offset:25088
    s_mov_b32 s54, 0xd40000
    buffer_load_dwordx4 v[78:81], v41, s[24:27], s54 offen offset:0 sc1
    v_mfma_f32_16x16x32_bf16 v[158:161], v[174:177], v[98:101], v[158:161]
    ds_read_b64_tr_b16 v[194:195], v34 offset:24576
    v_mfma_f32_16x16x32_bf16 v[130:133], v[178:181], v[90:93], v[130:133]
    ds_read_b64_tr_b16 v[196:197], v34 offset:25088
    s_add_u32 m0, s52, 8192
    s_mov_b32 s55, 1310720
    buffer_load_dwordx4 v26, s[20:23], s55 offen lds
    v_mfma_f32_16x16x32_bf16 v[146:149], v[178:181], v[94:97], v[146:149]
    ds_read_b64_tr_b16 v[198:199], v35 offset:24576
    v_mfma_f32_16x16x32_bf16 v[162:165], v[178:181], v[98:101], v[162:165]
    ds_read_b64_tr_b16 v[200:201], v35 offset:25088
    buffer_load_dwordx4 v[82:85], v41, s[24:27], s54 offen offset:512 sc1
    v_mfma_f32_16x16x32_bf16 v[134:137], v[182:185], v[90:93], v[134:137]
    ds_read_b64_tr_b16 v[202:203], v36 offset:24576
    v_mfma_f32_16x16x32_bf16 v[150:153], v[182:185], v[94:97], v[150:153]
    ds_read_b64_tr_b16 v[204:205], v36 offset:25088
    buffer_load_dwordx4 v27, s[20:23], s55 offen offset:1024 lds
    v_mfma_f32_16x16x32_bf16 v[166:169], v[182:185], v[98:101], v[166:169]
    v_mfma_f32_16x16x32_bf16 v[138:141], v[186:189], v[90:93], v[138:141]
    buffer_load_dwordx4 v[86:89], v41, s[24:27], s54 offen offset:1024 sc1
    v_mfma_f32_16x16x32_bf16 v[154:157], v[186:189], v[94:97], v[154:157]
    v_mfma_f32_16x16x32_bf16 v[170:173], v[186:189], v[98:101], v[170:173]
    s_waitcnt vmcnt(16) lgkmcnt(0)
    s_barrier
    v_mfma_f32_16x16x32_bf16 v[126:129], v[190:193], v[102:105], v[126:129]
    ds_read_b64_tr_b16 v[174:175], v37 offset:0
    v_mfma_f32_16x16x32_bf16 v[142:145], v[190:193], v[106:109], v[142:145]
    ds_read_b64_tr_b16 v[176:177], v37 offset:512
    s_mov_b32 s54, 0xe00000
    buffer_load_dwordx4 v[90:93], v41, s[24:27], s54 offen offset:0 sc1
    v_mfma_f32_16x16x32_bf16 v[158:161], v[190:193], v[110:113], v[158:161]
    ds_read_b64_tr_b16 v[178:179], v38 offset:0
    v_mfma_f32_16x16x32_bf16 v[130:133], v[194:197], v[102:105], v[130:133]
    ds_read_b64_tr_b16 v[180:181], v38 offset:512
    s_add_u32 m0, s52, 16384
    s_mov_b32 s55, 1556480
    buffer_load_dwordx4 v26, s[20:23], s55 offen lds
    v_mfma_f32_16x16x32_bf16 v[146:149], v[194:197], v[106:109], v[146:149]
    ds_read_b64_tr_b16 v[182:183], v39 offset:0
    v_mfma_f32_16x16x32_bf16 v[162:165], v[194:197], v[110:113], v[162:165]
    ds_read_b64_tr_b16 v[184:185], v39 offset:512
    buffer_load_dwordx4 v[94:97], v41, s[24:27], s54 offen offset:512 sc1
    v_mfma_f32_16x16x32_bf16 v[134:137], v[198:201], v[102:105], v[134:137]
    ds_read_b64_tr_b16 v[186:187], v40 offset:0
    v_mfma_f32_16x16x32_bf16 v[150:153], v[198:201], v[106:109], v[150:153]
    ds_read_b64_tr_b16 v[188:189], v40 offset:512
    buffer_load_dwordx4 v27, s[20:23], s55 offen offset:1024 lds
    v_mfma_f32_16x16x32_bf16 v[166:169], v[198:201], v[110:113], v[166:169]
    v_mfma_f32_16x16x32_bf16 v[138:141], v[202:205], v[102:105], v[138:141]
    buffer_load_dwordx4 v[98:101], v41, s[24:27], s54 offen offset:1024 sc1
    v_mfma_f32_16x16x32_bf16 v[154:157], v[202:205], v[106:109], v[154:157]
    v_mfma_f32_16x16x32_bf16 v[170:173], v[202:205], v[110:113], v[170:173]
    s_waitcnt vmcnt(15) lgkmcnt(0)
    s_nop 0
    v_mfma_f32_16x16x32_bf16 v[126:129], v[174:177], v[114:117], v[126:129]
    ds_read_b64_tr_b16 v[190:191], v37 offset:8192
    v_mfma_f32_16x16x32_bf16 v[142:145], v[174:177], v[118:121], v[142:145]
    ds_read_b64_tr_b16 v[192:193], v37 offset:8704
    s_mov_b32 s54, 0xec0000
    buffer_load_dwordx4 v[102:105], v41, s[24:27], s54 offen offset:0 sc1
    v_mfma_f32_16x16x32_bf16 v[158:161], v[174:177], v[122:125], v[158:161]
    ds_read_b64_tr_b16 v[194:195], v38 offset:8192
    v_mfma_f32_16x16x32_bf16 v[130:133], v[178:181], v[114:117], v[130:133]
    ds_read_b64_tr_b16 v[196:197], v38 offset:8704
    s_add_u32 m0, s52, 24576
    s_mov_b32 s55, 1802240
    buffer_load_dwordx4 v26, s[20:23], s55 offen lds
    v_mfma_f32_16x16x32_bf16 v[146:149], v[178:181], v[118:121], v[146:149]
    ds_read_b64_tr_b16 v[198:199], v39 offset:8192
    v_mfma_f32_16x16x32_bf16 v[162:165], v[178:181], v[122:125], v[162:165]
    ds_read_b64_tr_b16 v[200:201], v39 offset:8704
    buffer_load_dwordx4 v[106:109], v41, s[24:27], s54 offen offset:512 sc1
    v_mfma_f32_16x16x32_bf16 v[134:137], v[182:185], v[114:117], v[134:137]
    ds_read_b64_tr_b16 v[202:203], v40 offset:8192
    v_mfma_f32_16x16x32_bf16 v[150:153], v[182:185], v[118:121], v[150:153]
    ds_read_b64_tr_b16 v[204:205], v40 offset:8704
    buffer_load_dwordx4 v27, s[20:23], s55 offen offset:1024 lds
    v_mfma_f32_16x16x32_bf16 v[166:169], v[182:185], v[122:125], v[166:169]
    v_mfma_f32_16x16x32_bf16 v[138:141], v[186:189], v[114:117], v[138:141]
    buffer_load_dwordx4 v[110:113], v41, s[24:27], s54 offen offset:1024 sc1
    v_mfma_f32_16x16x32_bf16 v[154:157], v[186:189], v[118:121], v[154:157]
    v_mfma_f32_16x16x32_bf16 v[170:173], v[186:189], v[122:125], v[170:173]
    s_waitcnt vmcnt(15) lgkmcnt(0)
    v_cmp_ne_u32 vcc, s45, v45
    s_cmp_lg_u32 s36, 0
    s_cbranch_scc1 L_ok_44
    s_nop 1
    s_cbranch_vccz L_ok_44
    s_mov_b64 s[58:59], exec
    s_mov_b32 exec_lo, -1
    s_mov_b32 exec_hi, -1
    s_mov_b32 s56, 0
L_poll_45:
    buffer_load_dword v45, v52, s[24:27], 0 offen sc1
    s_waitcnt vmcnt(0)
    v_cmp_ne_u32_e64 vcc, s45, v45
    s_add_u32 s56, s56, 1
    s_nop 2
    s_cbranch_vccz L_polled_46
    s_cmp_lt_u32 s56, 100000
    s_cbranch_scc1 L_poll_45
L_polled_46:
    s_mov_b64 exec, s[58:59]
L_ok_44:
    s_barrier
    s_nop 0
    s_add_u32 m0, s53, 32768
    v_mfma_f32_16x16x32_bf16 v[126:129], v[190:193], v[66:69], v[126:129]
    ds_read_b64_tr_b16 v[174:175], v37 offset:16384
    v_mfma_f32_16x16x32_bf16 v[142:145], v[190:193], v[70:73], v[142:145]
    ds_read_b64_tr_b16 v[176:177], v37 offset:16896
    s_mov_b32 s54, 0xf80000
    buffer_load_dwordx4 v[114:117], v41, s[24:27], s54 offen offset:0 sc1
    v_mfma_f32_16x16x32_bf16 v[158:161], v[190:193], v[74:77], v[158:161]
    ds_read_b64_tr_b16 v[178:179], v38 offset:16384
    v_mfma_f32_16x16x32_bf16 v[130:133], v[194:197], v[66:69], v[130:133]
    ds_read_b64_tr_b16 v[180:181], v38 offset:16896
    buffer_load_dwordx4 v48, s[24:27], 0 offen offset:0 sc1 lds
    v_mfma_f32_16x16x32_bf16 v[146:149], v[194:197], v[70:73], v[146:149]
    ds_read_b64_tr_b16 v[182:183], v39 offset:16384
    v_mfma_f32_16x16x32_bf16 v[162:165], v[194:197], v[74:77], v[162:165]
    ds_read_b64_tr_b16 v[184:185], v39 offset:16896
    buffer_load_dwordx4 v[118:121], v41, s[24:27], s54 offen offset:512 sc1
    v_mfma_f32_16x16x32_bf16 v[134:137], v[198:201], v[66:69], v[134:137]
    ds_read_b64_tr_b16 v[186:187], v40 offset:16384
    v_mfma_f32_16x16x32_bf16 v[150:153], v[198:201], v[70:73], v[150:153]
    ds_read_b64_tr_b16 v[188:189], v40 offset:16896
    buffer_load_dwordx4 v49, s[24:27], 0 offen offset:1024 sc1 lds
    v_mfma_f32_16x16x32_bf16 v[166:169], v[198:201], v[74:77], v[166:169]
    v_mfma_f32_16x16x32_bf16 v[138:141], v[202:205], v[66:69], v[138:141]
    buffer_load_dwordx4 v[122:125], v41, s[24:27], s54 offen offset:1024 sc1
    v_mfma_f32_16x16x32_bf16 v[154:157], v[202:205], v[70:73], v[154:157]
    v_mfma_f32_16x16x32_bf16 v[170:173], v[202:205], v[74:77], v[170:173]
    buffer_load_dwordx4 v50, s[24:27], 0 offen offset:2048 sc1 lds
    s_waitcnt vmcnt(16) lgkmcnt(0)
    s_nop 0
    v_mfma_f32_16x16x32_bf16 v[126:129], v[174:177], v[78:81], v[126:129]
    ds_read_b64_tr_b16 v[190:191], v37 offset:24576
    v_mfma_f32_16x16x32_bf16 v[142:145], v[174:177], v[82:85], v[142:145]
    ds_read_b64_tr_b16 v[192:193], v37 offset:25088
    s_mov_b32 s54, 0x1040000
    buffer_load_dwordx4 v[66:69], v41, s[24:27], s54 offen offset:0 sc1
    v_mfma_f32_16x16x32_bf16 v[158:161], v[174:177], v[86:89], v[158:161]
    ds_read_b64_tr_b16 v[194:195], v38 offset:24576
    v_mfma_f32_16x16x32_bf16 v[130:133], v[178:181], v[78:81], v[130:133]
    ds_read_b64_tr_b16 v[196:197], v38 offset:25088
    v_mfma_f32_16x16x32_bf16 v[146:149], v[178:181], v[82:85], v[146:149]
    ds_read_b64_tr_b16 v[198:199], v39 offset:24576
    v_mfma_f32_16x16x32_bf16 v[162:165], v[178:181], v[86:89], v[162:165]
    ds_read_b64_tr_b16 v[200:201], v39 offset:25088
    buffer_load_dwordx4 v[70:73], v41, s[24:27], s54 offen offset:512 sc1
    v_mfma_f32_16x16x32_bf16 v[134:137], v[182:185], v[78:81], v[134:137]
    ds_read_b64_tr_b16 v[202:203], v40 offset:24576
    v_mfma_f32_16x16x32_bf16 v[150:153], v[182:185], v[82:85], v[150:153]
    ds_read_b64_tr_b16 v[204:205], v40 offset:25088
    v_mfma_f32_16x16x32_bf16 v[166:169], v[182:185], v[86:89], v[166:169]
    v_mfma_f32_16x16x32_bf16 v[138:141], v[186:189], v[78:81], v[138:141]
    buffer_load_dwordx4 v[74:77], v41, s[24:27], s54 offen offset:1024 sc1
    v_mfma_f32_16x16x32_bf16 v[154:157], v[186:189], v[82:85], v[154:157]
    v_mfma_f32_16x16x32_bf16 v[170:173], v[186:189], v[86:89], v[170:173]
    s_waitcnt vmcnt(14) lgkmcnt(0)
    s_barrier
    v_mfma_f32_16x16x32_bf16 v[126:129], v[190:193], v[90:93], v[126:129]
    ds_read_b64_tr_b16 v[174:175], v37 offset:32768
    v_mfma_f32_16x16x32_bf16 v[142:145], v[190:193], v[94:97], v[142:145]
    ds_read_b64_tr_b16 v[176:177], v37 offset:33280
    s_mov_b32 s54, 0x1100000
    buffer_load_dwordx4 v[78:81], v41, s[24:27], s54 offen offset:0 sc1
    v_mfma_f32_16x16x32_bf16 v[158:161], v[190:193], v[98:101], v[158:161]
    ds_read_b64_tr_b16 v[178:179], v38 offset:32768
    v_mfma_f32_16x16x32_bf16 v[130:133], v[194:197], v[90:93], v[130:133]
    ds_read_b64_tr_b16 v[180:181], v38 offset:33280
    v_mfma_f32_16x16x32_bf16 v[146:149], v[194:197], v[94:97], v[146:149]
    ds_read_b64_tr_b16 v[182:183], v39 offset:32768
    v_mfma_f32_16x16x32_bf16 v[162:165], v[194:197], v[98:101], v[162:165]
    ds_read_b64_tr_b16 v[184:185], v39 offset:33280
    buffer_load_dwordx4 v[82:85], v41, s[24:27], s54 offen offset:512 sc1
    v_mfma_f32_16x16x32_bf16 v[134:137], v[198:201], v[90:93], v[134:137]
    ds_read_b64_tr_b16 v[186:187], v40 offset:32768
    v_mfma_f32_16x16x32_bf16 v[150:153], v[198:201], v[94:97], v[150:153]
    ds_read_b64_tr_b16 v[188:189], v40 offset:33280
    v_mfma_f32_16x16x32_bf16 v[166:169], v[198:201], v[98:101], v[166:169]
    v_mfma_f32_16x16x32_bf16 v[138:141], v[202:205], v[90:93], v[138:141]
    buffer_load_dwordx4 v[86:89], v41, s[24:27], s54 offen offset:1024 sc1
    v_mfma_f32_16x16x32_bf16 v[154:157], v[202:205], v[94:97], v[154:157]
    v_mfma_f32_16x16x32_bf16 v[170:173], v[202:205], v[98:101], v[170:173]
    s_waitcnt vmcnt(12) lgkmcnt(0)
    v_mfma_f32_16x16x32_bf16 v[126:129], v[174:177], v[102:105], v[126:129]
    ds_read_b64_tr_b16 v[190:191], v37 offset:40960
    v_lshlrev_b32 v206, 16, v2
    v_mfma_f32_16x16x32_bf16 v[142:145], v[174:177], v[106:109], v[142:145]
    ds_read_b64_tr_b16 v[192:193], v37 offset:41472
    s_mov_b32 s54, 0x11c0000
    buffer_load_dwordx4 v[90:93], v41, s[24:27], s54 offen offset:0 sc1
    v_and_b32 v207, 0xffff0000, v2
    v_mfma_f32_16x16x32_bf16 v[158:161], v[174:177], v[110:113], v[158:161]
    ds_read_b64_tr_b16 v[194:195], v38 offset:40960
    v_lshlrev_b32_e64 v208, 16, v3
    v_mfma_f32_16x16x32_bf16 v[130:133], v[178:181], v[102:105], v[130:133]
    ds_read_b64_tr_b16 v[196:197], v38 offset:41472
    v_and_b32 v209, 0xffff0000, v3
    v_mfma_f32_16x16x32_bf16 v[146:149], v[178:181], v[106:109], v[146:149]
    ds_read_b64_tr_b16 v[198:199], v39 offset:40960
    v_lshlrev_b32_e64 v210, 16, v4
    v_mfma_f32_16x16x32_bf16 v[162:165], v[178:181], v[110:113], v[162:165]
    ds_read_b64_tr_b16 v[200:201], v39 offset:41472
    buffer_load_dwordx4 v[94:97], v41, s[24:27], s54 offen offset:512 sc1
    v_and_b32 v211, 0xffff0000, v4
    v_mfma_f32_16x16x32_bf16 v[134:137], v[182:185], v[102:105], v[134:137]
    ds_read_b64_tr_b16 v[202:203], v40 offset:40960
    v_lshlrev_b32_e64 v212, 16, v5
    v_mfma_f32_16x16x32_bf16 v[150:153], v[182:185], v[106:109], v[150:153]
    ds_read_b64_tr_b16 v[204:205], v40 offset:41472
    v_and_b32 v213, 0xffff0000, v5
    v_mfma_f32_16x16x32_bf16 v[166:169], v[182:185], v[110:113], v[166:169]
    v_lshlrev_b32_e64 v214, 16, v6
    v_mfma_f32_16x16x32_bf16 v[138:141], v[186:189], v[102:105], v[138:141]
    buffer_load_dwordx4 v[98:101], v41, s[24:27], s54 offen offset:1024 sc1
    v_and_b32 v215, 0xffff0000, v6
    v_mfma_f32_16x16x32_bf16 v[154:157], v[186:189], v[106:109], v[154:157]
    v_lshlrev_b32_e64 v216, 16, v7
    v_mfma_f32_16x16x32_bf16 v[170:173], v[186:189], v[110:113], v[170:173]
    v_and_b32 v217, 0xffff0000, v7
    s_waitcnt vmcnt(10) lgkmcnt(0)
    s_barrier
    v_mfma_f32_16x16x32_bf16 v[126:129], v[190:193], v[114:117], v[126:129]
    ds_read_b64_tr_b16 v[174:175], v33 offset:0
    v_lshlrev_b32_e64 v218, 16, v8
    v_mfma_f32_16x16x32_bf16 v[142:145], v[190:193], v[118:121], v[142:145]
    ds_read_b64_tr_b16 v[176:177], v33 offset:512
    s_mov_b32 s54, 0x1280000
    buffer_load_dwordx4 v[102:105], v41, s[24:27], s54 offen offset:0 sc1
    v_and_b32 v219, 0xffff0000, v8
    v_mfma_f32_16x16x32_bf16 v[158:161], v[190:193], v[122:125], v[158:161]
    ds_read_b64_tr_b16 v[178:179], v34 offset:0
    v_lshlrev_b32_e64 v220, 16, v9
    v_mfma_f32_16x16x32_bf16 v[130:133], v[194:197], v[114:117], v[130:133]
    ds_read_b64_tr_b16 v[180:181], v34 offset:512
    v_and_b32 v221, 0xffff0000, v9
    v_mfma_f32_16x16x32_bf16 v[146:149], v[194:197], v[118:121], v[146:149]
    ds_read_b64_tr_b16 v[182:183], v35 offset:0
    v_lshlrev_b32_e64 v222, 16, v10
    v_mfma_f32_16x16x32_bf16 v[162:165], v[194:197], v[122:125], v[162:165]
    ds_read_b64_tr_b16 v[184:185], v35 offset:512
    buffer_load_dwordx4 v[106:109], v41, s[24:27], s54 offen offset:512 sc1
    v_and_b32 v223, 0xffff0000, v10
    v_mfma_f32_16x16x32_bf16 v[134:137], v[198:201], v[114:117], v[134:137]
    ds_read_b64_tr_b16 v[186:187], v36 offset:0
    v_lshlrev_b32_e64 v224, 16, v11
    v_mfma_f32_16x16x32_bf16 v[150:153], v[198:201], v[118:121], v[150:153]
    ds_read_b64_tr_b16 v[188:189], v36 offset:512
    v_and_b32 v225, 0xffff0000, v11
    v_mfma_f32_16x16x32_bf16 v[166:169], v[198:201], v[122:125], v[166:169]
    v_lshlrev_b32_e64 v226, 16, v12
    v_mfma_f32_16x16x32_bf16 v[138:141], v[202:205], v[114:117], v[138:141]
    buffer_load_dwordx4 v[110:113], v41, s[24:27], s54 offen offset:1024 sc1
    v_and_b32 v227, 0xffff0000, v12
    v_mfma_f32_16x16x32_bf16 v[154:157], v[202:205], v[118:121], v[154:157]
    v_lshlrev_b32_e64 v228, 16, v13
    v_mfma_f32_16x16x32_bf16 v[170:173], v[202:205], v[122:125], v[170:173]
    v_and_b32 v229, 0xffff0000, v13
    s_waitcnt vmcnt(9) lgkmcnt(0)
    s_nop 0
    v_mfma_f32_16x16x32_bf16 v[126:129], v[174:177], v[66:69], v[126:129]
    ds_read_b64_tr_b16 v[190:191], v33 offset:8192
    v_mfma_f32_16x16x32_bf16 v[142:145], v[174:177], v[70:73], v[142:145]
    ds_read_b64_tr_b16 v[192:193], v33 offset:8704
    v_mfma_f32_16x16x32_bf16 v[158:161], v[174:177], v[74:77], v[158:161]
    ds_read_b64_tr_b16 v[194:195], v34 offset:8192
    v_mfma_f32_16x16x32_bf16 v[130:133], v[178:181], v[66:69], v[130:133]
    ds_read_b64_tr_b16 v[196:197], v34 offset:8704
    v_mfma_f32_16x16x32_bf16 v[146:149], v[178:181], v[70:73], v[146:149]
    ds_read_b64_tr_b16 v[198:199], v35 offset:8192
    v_mfma_f32_16x16x32_bf16 v[162:165], v[178:181], v[74:77], v[162:165]
    ds_read_b64_tr_b16 v[200:201], v35 offset:8704
    v_mfma_f32_16x16x32_bf16 v[134:137], v[182:185], v[66:69], v[134:137]
    ds_read_b64_tr_b16 v[202:203], v36 offset:8192
    v_mfma_f32_16x16x32_bf16 v[150:153], v[182:185], v[70:73], v[150:153]
    ds_read_b64_tr_b16 v[204:205], v36 offset:8704
    v_mfma_f32_16x16x32_bf16 v[166:169], v[182:185], v[74:77], v[166:169]
    v_mfma_f32_16x16x32_bf16 v[138:141], v[186:189], v[66:69], v[138:141]
    v_mfma_f32_16x16x32_bf16 v[154:157], v[186:189], v[70:73], v[154:157]
    v_mfma_f32_16x16x32_bf16 v[170:173], v[186:189], v[74:77], v[170:173]
    s_waitcnt vmcnt(6) lgkmcnt(0)
    s_barrier
    v_mfma_f32_16x16x32_bf16 v[126:129], v[190:193], v[78:81], v[126:129]
    ds_read_b64_tr_b16 v[174:175], v33 offset:16384
    v_mfma_f32_16x16x32_bf16 v[142:145], v[190:193], v[82:85], v[142:145]
    ds_read_b64_tr_b16 v[176:177], v33 offset:16896
    v_mfma_f32_16x16x32_bf16 v[158:161], v[190:193], v[86:89], v[158:161]
    ds_read_b64_tr_b16 v[178:179], v34 offset:16384
    v_mfma_f32_16x16x32_bf16 v[130:133], v[194:197], v[78:81], v[130:133]
    ds_read_b64_tr_b16 v[180:181], v34 offset:16896
    v_mfma_f32_16x16x32_bf16 v[146:149], v[194:197], v[82:85], v[146:149]
    ds_read_b64_tr_b16 v[182:183], v35 offset:16384
    v_mfma_f32_16x16x32_bf16 v[162:165], v[194:197], v[86:89], v[162:165]
    ds_read_b64_tr_b16 v[184:185], v35 offset:16896
    v_mfma_f32_16x16x32_bf16 v[134:137], v[198:201], v[78:81], v[134:137]
    ds_read_b64_tr_b16 v[186:187], v36 offset:16384
    v_mfma_f32_16x16x32_bf16 v[150:153], v[198:201], v[82:85], v[150:153]
    ds_read_b64_tr_b16 v[188:189], v36 offset:16896
    v_mfma_f32_16x16x32_bf16 v[166:169], v[198:201], v[86:89], v[166:169]
    ds_read_b64_tr_b16 v[14:15], v51 offset:0
    v_mfma_f32_16x16x32_bf16 v[138:141], v[202:205], v[78:81], v[138:141]
    ds_read_b64_tr_b16 v[16:17], v51 offset:3072
    v_mfma_f32_16x16x32_bf16 v[154:157], v[202:205], v[82:85], v[154:157]
    ds_read_b64_tr_b16 v[18:19], v51 offset:32
    v_mfma_f32_16x16x32_bf16 v[170:173], v[202:205], v[86:89], v[170:173]
    ds_read_b64_tr_b16 v[20:21], v51 offset:3104
    ds_read_b64_tr_b16 v[22:23], v51 offset:64
    ds_read_b64_tr_b16 v[24:25], v51 offset:3136
    s_waitcnt vmcnt(3) lgkmcnt(0)
    v_mfma_f32_16x16x32_bf16 v[126:129], v[174:177], v[90:93], v[126:129]
    ds_read_b64_tr_b16 v[190:191], v33 offset:24576
    v_lshlrev_b32 v230, 16, v14
    v_mfma_f32_16x16x32_bf16 v[142:145], v[174:177], v[94:97], v[142:145]
    ds_read_b64_tr_b16 v[192:193], v33 offset:25088
    v_and_b32 v231, 0xffff0000, v14
    v_mfma_f32_16x16x32_bf16 v[158:161], v[174:177], v[98:101], v[158:161]
    ds_read_b64_tr_b16 v[194:195], v34 offset:24576
    v_lshlrev_b32_e64 v232, 16, v15
    v_mfma_f32_16x16x32_bf16 v[130:133], v[178:181], v[90:93], v[130:133]
    ds_read_b64_tr_b16 v[196:197], v34 offset:25088
    v_and_b32 v233, 0xffff0000, v15
    v_mfma_f32_16x16x32_bf16 v[146:149], v[178:181], v[94:97], v[146:149]
    ds_read_b64_tr_b16 v[198:199], v35 offset:24576
    v_lshlrev_b32_e64 v234, 16, v16
    v_mfma_f32_16x16x32_bf16 v[162:165], v[178:181], v[98:101], v[162:165]
    ds_read_b64_tr_b16 v[200:201], v35 offset:25088
    v_and_b32 v235, 0xffff0000, v16
    v_mfma_f32_16x16x32_bf16 v[134:137], v[182:185], v[90:93], v[134:137]
    ds_read_b64_tr_b16 v[202:203], v36 offset:24576
    v_lshlrev_b32_e64 v236, 16, v17
    v_mfma_f32_16x16x32_bf16 v[150:153], v[182:185], v[94:97], v[150:153]
    ds_read_b64_tr_b16 v[204:205], v36 offset:25088
    v_and_b32 v237, 0xffff0000, v17
    v_mfma_f32_16x16x32_bf16 v[166:169], v[182:185], v[98:101], v[166:169]
    v_lshlrev_b32_e64 v238, 16, v18
    v_mfma_f32_16x16x32_bf16 v[138:141], v[186:189], v[90:93], v[138:141]
    v_and_b32 v239, 0xffff0000, v18
    v_mfma_f32_16x16x32_bf16 v[154:157], v[186:189], v[94:97], v[154:157]
    v_lshlrev_b32_e64 v240, 16, v19
    v_mfma_f32_16x16x32_bf16 v[170:173], v[186:189], v[98:101], v[170:173]
    v_and_b32 v241, 0xffff0000, v19
    s_waitcnt vmcnt(0) lgkmcnt(0)
    v_mfma_f32_16x16x32_bf16 v[134:137], v[198:201], v[102:105], v[134:137]
    v_lshlrev_b32 v242, 16, v20
    v_mfma_f32_16x16x32_bf16 v[150:153], v[198:201], v[106:109], v[150:153]
    v_and_b32 v243, 0xffff0000, v20
    v_mfma_f32_16x16x32_bf16 v[166:169], v[198:201], v[110:113], v[166:169]
    v_lshlrev_b32_e64 v244, 16, v21
    v_mfma_f32_16x16x32_bf16 v[138:141], v[202:205], v[102:105], v[138:141]
    v_and_b32 v245, 0xffff0000, v21
    v_mfma_f32_16x16x32_bf16 v[154:157], v[202:205], v[106:109], v[154:157]
    v_lshlrev_b32_e64 v246, 16, v22
    v_mfma_f32_16x16x32_bf16 v[170:173], v[202:205], v[110:113], v[170:173]
    v_and_b32 v247, 0xffff0000, v22
    v_mfma_f32_16x16x32_bf16 v[126:129], v[190:193], v[102:105], v[126:129]
    v_lshlrev_b32_e64 v248, 16, v23
    v_mfma_f32_16x16x32_bf16 v[142:145], v[190:193], v[106:109], v[142:145]
    v_and_b32 v249, 0xffff0000, v23
    v_mfma_f32_16x16x32_bf16 v[158:161], v[190:193], v[110:113], v[158:161]
    v_lshlrev_b32_e64 v250, 16, v24
    ds_write_b128 v53, v[134:137] offset:0
    v_mfma_f32_16x16x32_bf16 v[130:133], v[194:197], v[102:105], v[130:133]
    v_and_b32 v251, 0xffff0000, v24
    ds_write_b128 v53, v[150:153] offset:2048
    v_mfma_f32_16x16x32_bf16 v[146:149], v[194:197], v[106:109], v[146:149]
    v_lshlrev_b32_e64 v252, 16, v25
    ds_write_b128 v53, v[166:169] offset:4096
    v_mfma_f32_16x16x32_bf16 v[162:165], v[194:197], v[110:113], v[162:165]
    v_and_b32 v253, 0xffff0000, v25
    ds_write_b128 v53, v[138:141] offset:1024
    ds_write_b128 v53, v[154:157] offset:3072
    ds_write_b128 v53, v[170:173] offset:5120
    s_waitcnt lgkmcnt(0)
    s_barrier
    ds_read_b128 v[66:69], v54 offset:0
    ds_read_b128 v[70:73], v54 offset:1024
    ds_read_b128 v[74:77], v54 offset:2048
    ds_read_b128 v[78:81], v54 offset:3072
    ds_read_b128 v[82:85], v54 offset:4096
    ds_read_b128 v[86:89], v54 offset:5120
    s_waitcnt lgkmcnt(4)
    s_nop 0
    v_pk_add_f32 v[126:127], v[126:127], v[66:67]
    v_pk_add_f32 v[128:129], v[128:129], v[68:69]
    v_pk_add_f32 v[130:131], v[130:131], v[70:71]
    v_pk_add_f32 v[132:133], v[132:133], v[72:73]
    v_pk_mul_f32 v[174:175], v[126:127], s[64:65]
    v_pk_mul_f32 v[176:177], v[128:129], s[64:65]
    v_pk_mul_f32 v[178:179], v[130:131], s[64:65]
    v_pk_mul_f32 v[180:181], v[132:133], s[64:65]
    v_exp_f32 v174, v174
    v_exp_f32 v175, v175
    v_exp_f32 v176, v176
    v_exp_f32 v177, v177
    v_exp_f32 v178, v178
    v_exp_f32 v179, v179
    v_exp_f32 v180, v180
    v_exp_f32 v181, v181
    v_pk_mul_f32 v[126:127], v[126:127], v[230:231]
    v_pk_mul_f32 v[128:129], v[128:129], v[232:233]
    v_pk_mul_f32 v[130:131], v[130:131], v[234:235]
    v_pk_mul_f32 v[132:133], v[132:133], v[236:237]
    v_pk_add_f32 v[174:175], v[174:175], 1.0 op_sel_hi:[1,0]
    v_pk_add_f32 v[176:177], v[176:177], 1.0 op_sel_hi:[1,0]
    v_pk_add_f32 v[178:179], v[178:179], 1.0 op_sel_hi:[1,0]
    v_pk_add_f32 v[180:181], v[180:181], 1.0 op_sel_hi:[1,0]
    v_rcp_f32 v174, v174
    v_rcp_f32 v175, v175
    v_rcp_f32 v176, v176
    v_rcp_f32 v177, v177
    v_rcp_f32 v178, v178
    v_rcp_f32 v179, v179
    v_rcp_f32 v180, v180
    v_rcp_f32 v181, v181
    v_pk_fma_f32 v[174:175], v[174:175], v[126:127], v[206:207]
    v_pk_fma_f32 v[176:177], v[176:177], v[128:129], v[208:209]
    v_pk_fma_f32 v[178:179], v[178:179], v[130:131], v[210:211]
    v_pk_fma_f32 v[180:181], v[180:181], v[132:133], v[212:213]
    v_cvt_pk_bf16_f32 v182, v174, v175
    v_cvt_pk_bf16_f32 v183, v176, v177
    v_cvt_pk_bf16_f32 v184, v178, v179
    v_cvt_pk_bf16_f32 v185, v180, v181
    ds_write_b64 v55, v[182:183] offset:0
    ds_write_b64 v56, v[184:185] offset:0
    s_waitcnt lgkmcnt(4)
    s_nop 0
    v_pk_add_f32 v[142:143], v[142:143], v[74:75]
    v_pk_add_f32 v[144:145], v[144:145], v[76:77]
    v_pk_add_f32 v[146:147], v[146:147], v[78:79]
    v_pk_add_f32 v[148:149], v[148:149], v[80:81]
    v_pk_mul_f32 v[174:175], v[142:143], s[64:65]
    v_pk_mul_f32 v[176:177], v[144:145], s[64:65]
    v_pk_mul_f32 v[178:179], v[146:147], s[64:65]
    v_pk_mul_f32 v[180:181], v[148:149], s[64:65]
    v_exp_f32 v174, v174
    v_exp_f32 v175, v175
    v_exp_f32 v176, v176
    v_exp_f32 v177, v177
    v_exp_f32 v178, v178
    v_exp_f32 v179, v179
    v_exp_f32 v180, v180
    v_exp_f32_e64 v181, v181
    s_waitcnt lgkmcnt(0)
    ds_read_b128 v[182:185], v57 offset:0
    v_pk_mul_f32 v[142:143], v[142:143], v[238:239]
    v_pk_mul_f32 v[144:145], v[144:145], v[240:241]
    v_pk_mul_f32 v[146:147], v[146:147], v[242:243]
    v_pk_mul_f32 v[148:149], v[148:149], v[244:245]
    v_pk_add_f32 v[174:175], v[174:175], 1.0 op_sel_hi:[1,0]
    v_pk_add_f32 v[176:177], v[176:177], 1.0 op_sel_hi:[1,0]
    v_pk_add_f32 v[178:179], v[178:179], 1.0 op_sel_hi:[1,0]
    v_pk_add_f32 v[180:181], v[180:181], 1.0 op_sel_hi:[1,0]
    v_rcp_f32 v174, v174
    v_rcp_f32 v175, v175
    v_rcp_f32 v176, v176
    v_rcp_f32 v177, v177
    v_rcp_f32 v178, v178
    v_rcp_f32 v179, v179
    v_rcp_f32 v180, v180
    v_rcp_f32 v181, v181
    s_waitcnt lgkmcnt(0)
    s_mov_b32 s54, 0
    buffer_store_dwordx4 v[182:185], v58, s[28:31], s54 offen sc1
    v_pk_fma_f32 v[174:175], v[174:175], v[142:143], v[214:215]
    v_pk_fma_f32 v[176:177], v[176:177], v[144:145], v[216:217]
    v_pk_fma_f32 v[178:179], v[178:179], v[146:147], v[218:219]
    v_pk_fma_f32 v[180:181], v[180:181], v[148:149], v[220:221]
    v_cvt_pk_bf16_f32 v186, v174, v175
    v_cvt_pk_bf16_f32 v187, v176, v177
    v_cvt_pk_bf16_f32 v188, v178, v179
    v_cvt_pk_bf16_f32 v189, v180, v181
    ds_write_b64 v55, v[186:187] offset:1024
    ds_write_b64 v56, v[188:189] offset:1024
    v_pk_add_f32 v[158:159], v[158:159], v[82:83]
    v_pk_add_f32 v[160:161], v[160:161], v[84:85]
    v_pk_add_f32 v[162:163], v[162:163], v[86:87]
    v_pk_add_f32 v[164:165], v[164:165], v[88:89]
    v_pk_mul_f32 v[174:175], v[158:159], s[64:65]
    v_pk_mul_f32 v[176:177], v[160:161], s[64:65]
    v_pk_mul_f32 v[178:179], v[162:163], s[64:65]
    v_pk_mul_f32 v[180:181], v[164:165], s[64:65]
    v_exp_f32 v174, v174
    v_exp_f32 v175, v175
    v_exp_f32 v176, v176
    v_exp_f32 v177, v177
    v_exp_f32 v178, v178
    v_exp_f32 v179, v179
    v_exp_f32 v180, v180
    v_exp_f32_e64 v181, v181
    s_waitcnt lgkmcnt(0)
    ds_read_b128 v[186:189], v57 offset:1024
    v_pk_mul_f32 v[158:159], v[158:159], v[246:247]
    v_pk_mul_f32 v[160:161], v[160:161], v[248:249]
    v_pk_mul_f32 v[162:163], v[162:163], v[250:251]
    v_pk_mul_f32 v[164:165], v[164:165], v[252:253]
    v_pk_add_f32 v[174:175], v[174:175], 1.0 op_sel_hi:[1,0]
    v_pk_add_f32 v[176:177], v[176:177], 1.0 op_sel_hi:[1,0]
    v_pk_add_f32 v[178:179], v[178:179], 1.0 op_sel_hi:[1,0]
    v_pk_add_f32 v[180:181], v[180:181], 1.0 op_sel_hi:[1,0]
    v_rcp_f32 v174, v174
    v_rcp_f32 v175, v175
    v_rcp_f32 v176, v176
    v_rcp_f32 v177, v177
    v_rcp_f32 v178, v178
    v_rcp_f32 v179, v179
    v_rcp_f32 v180, v180
    v_rcp_f32_e64 v181, v181
    s_waitcnt lgkmcnt(0)
    s_mov_b32 s54, 20480
    buffer_store_dwordx4 v[186:189], v58, s[28:31], s54 offen sc1
    v_pk_fma_f32 v[174:175], v[174:175], v[158:159], v[222:223]
    v_pk_fma_f32 v[176:177], v[176:177], v[160:161], v[224:225]
    v_pk_fma_f32 v[178:179], v[178:179], v[162:163], v[226:227]
    v_pk_fma_f32 v[180:181], v[180:181], v[164:165], v[228:229]
    v_cvt_pk_bf16_f32 v190, v174, v175
    v_cvt_pk_bf16_f32 v191, v176, v177
    v_cvt_pk_bf16_f32 v192, v178, v179
    v_cvt_pk_bf16_f32 v193, v180, v181
    ds_write_b64 v55, v[190:191] offset:2048
    ds_write_b64 v56, v[192:193] offset:2048
    s_waitcnt lgkmcnt(0)
    ds_read_b128 v[190:193], v57 offset:2048
    s_mov_b32 s54, 40960
    s_waitcnt lgkmcnt(0)
    buffer_store_dwordx4 v[190:193], v58, s[28:31], s54 offen sc1
    s_endpgm
L_ssm:
    s_nop 0
    s_load_dwordx2 s[24:25], s[0:1], 128
    s_load_dwordx2 s[32:33], s[0:1], 120
    s_load_dwordx16 s[76:91], s[0:1], 8
    s_load_dwordx2 s[16:17], s[0:1], 96
    s_load_dwordx2 s[12:13], s[0:1], 88
    s_load_dwordx2 s[20:21], s[0:1], 104
    v_lshrrev_b32 v1, 6, v0
    v_and_b32 v0, 63, v0
    s_and_b32 s46, s2, 7
    v_readfirstlane_b32 s36, v1
    s_bfe_u32 s47, s2, 0x50003
    s_mov_b32 s26, 0x10000000
    s_mov_b32 s27, 0x20000
    s_mov_b32 s34, 0x100
    s_mov_b32 s35, 0x20000
    s_mov_b32 s18, 0x1e0000
    s_mov_b32 s19, 0x20000
    s_cmp_ge_u32 s47, 20
    s_cbranch_scc1 L_helper
    s_mul_i32 s48, s46, 20
    s_add_u32 s48, s48, s47
    s_lshl_b32 s48, s48, 2
    s_add_u32 s92, s48, s36
    s_lshl_b32 s93, s36, 14
    s_mul_i32 s48, s92, 384
    v_lshl_add_u32 v1, v0, 2, s48
    s_add_u32 s48, s48, 256
    v_lshl_add_u32 v4, v0, 1, s48
    s_waitcnt lgkmcnt(0)
    s_sub_u32 s48, s2, 256
    s_or_b32 s48, s48, s36
    s_cmp_lg_u32 s48, 0
    s_cbranch_scc1 L_nonv_47
    s_mov_b64 exec, 1
    buffer_load_dword v5, off, s[24:27], 0 offset:0 sc1
    buffer_load_dword v6, off, s[32:35], 0 offset:128 sc1
    s_mov_b32 s48, 0x9e3779b1
    s_waitcnt vmcnt(1)
    v_add_u32 v5, 1, v5
    v_mul_lo_u32 v2, v5, s48
    v_mov_b32_e64 v3, 1
    buffer_store_dwordx2 v[2:3], off, s[32:35], 0 sc1
    buffer_store_dword v5, off, s[24:27], 0 offset:0 sc1
    s_mov_b64 exec, -1
L_nonv_47:
    s_nop 0
    global_load_dword v8, v1, s[76:77]
    global_load_ushort v14, v4, s[76:77]
    global_load_dword v9, v1, s[78:79]
    global_load_ushort v15, v4, s[78:79]
    global_load_dword v10, v1, s[80:81]
    global_load_ushort v16, v4, s[80:81]
    global_load_dword v11, v1, s[82:83]
    global_load_ushort v17, v4, s[82:83]
    global_load_dword v12, v1, s[84:85]
    global_load_ushort v18, v4, s[84:85]
    global_load_dword v13, v1, s[86:87]
    global_load_ushort v19, v4, s[86:87]
    s_lshr_b32 s48, s92, 1
    s_lshl_b32 s48, s48, 2
    s_load_dword s94, s[88:89], s48
    s_load_dword s95, s[90:91], s48
    s_mov_b32 m0, s93
    v_and_b32 v1, 31, v0
    v_lshrrev_b32_e64 v4, 5, v0
    v_mul_u32_u24 v21, 272, v1
    v_lshl_add_u32 v21, v4, 4, v21
    v_add_u32 v21, s93, v21
    v_lshrrev_b32 v5, 2, v1
    v_mov_b32 v20, 0x3020100
    v_cmp_eq_u32_e64 vcc, 1, v5
    v_mov_b32 v6, 0xf0e0d0d
    s_nop 0
    v_cndmask_b32 v20, v20, v6, vcc
    v_cmp_eq_u32_e64 vcc, 2, v5
    v_mov_b32 v6, 0x13121110
    s_nop 0
    v_cndmask_b32 v20, v20, v6, vcc
    v_cmp_eq_u32_e64 vcc, 3, v5
    v_mov_b32 v6, 0x5040f0f
    s_nop 0
    v_cndmask_b32 v20, v20, v6, vcc
    v_cmp_eq_u32_e64 vcc, 4, v5
    v_mov_b32 v6, 0x17161514
    s_nop 0
    v_cndmask_b32 v20, v20, v6, vcc
    v_cmp_eq_u32_e64 vcc, 5, v5
    v_mov_b32 v6, 0x9080706
    s_nop 0
    v_cndmask_b32 v20, v20, v6, vcc
    v_cmp_eq_u32_e64 vcc, 6, v5
    v_mov_b32 v6, 0xc0c0b0a
    s_nop 0
    v_cndmask_b32 v20, v20, v6, vcc
    v_cmp_eq_u32_e64 vcc, 7, v5
    v_mov_b32 v6, 0x1a1a1918
    s_nop 0
    v_cndmask_b32 v20, v20, v6, vcc
    v_and_b32 v5, 3, v0
    v_lshlrev_b32 v5, 3, v5
    v_bfe_u32 v20, v20, v5, 8
    v_add_u32_e64 v20, 32, v20
    v_mul_u32_u24 v20, 272, v20
    v_lshl_add_u32 v20, v4, 4, v20
    v_add_u32 v20, s93, v20
    s_lshl_b32 s64, s36, 12
    v_and_b32 v1, 31, v0
    v_lshrrev_b32 v4, 5, v0
    v_lshlrev_b32_e64 v1, 4, v1
    s_add_u32 s48, s64, 68592
    v_sub_u32 v5, s48, v1
    v_lshlrev_b32 v6, 9, v4
    v_sub_u32 v22, v5, v6
    v_sub_u32 v23, v22, v6
    v_subrev_u32 v23, 1536, v23
    s_add_u32 s48, s64, 65536
    v_lshl_add_u32 v28, v0, 4, s48
    v_bfe_u32 v1, v0, 1, 2
    v_lshl_add_u32 v4, v0, 6, s93
    v_xor_b32_e64 v5, 0, v1
    v_lshl_add_u32 v24, v5, 4, v4
    v_xor_b32_e64 v5, 1, v1
    v_lshl_add_u32 v25, v5, 4, v4
    v_xor_b32_e64 v5, 2, v1
    v_lshl_add_u32 v26, v5, 4, v4
    v_xor_b32_e64 v5, 3, v1
    v_lshl_add_u32 v27, v5, 4, v4
    v_and_b32 v41, 15, v0
    v_lshrrev_b32 v42, 4, v0
    v_sub_u32 v1, 3, v41
    v_and_b32 v1, 3, v1
    v_sub_u32 v4, 2031, v41
    v_sub_u32 v4, v4, v1
    v_lshrrev_b32 v4, 2, v4
    v_lshl_add_u32 v4, v42, 1, v4
    v_subrev_u32 v5, 496, v4
    v_bfe_u32 v6, v5, 2, 2
    v_xor_b32 v6, v6, v1
    v_lshlrev_b32 v6, 4, v6
    v_and_b32_e64 v43, 1, v5
    v_lshl_add_u32 v6, v43, 3, v6
    v_lshrrev_b32_e64 v5, 1, v5
    v_lshl_add_u32 v6, v5, 6, v6
    v_add_u32_e64 v29, s93, v6
    v_subrev_u32 v5, 495, v4
    v_bfe_u32 v6, v5, 2, 2
    v_xor_b32 v6, v6, v1
    v_lshlrev_b32 v6, 4, v6
    v_and_b32_e64 v43, 1, v5
    v_lshl_add_u32 v6, v43, 3, v6
    v_lshrrev_b32_e64 v5, 1, v5
    v_lshl_add_u32 v6, v5, 6, v6
    v_add_u32_e64 v30, s93, v6
    v_subrev_u32 v5, 504, v4
    v_bfe_u32 v6, v5, 2, 2
    v_xor_b32 v6, v6, v1
    v_lshlrev_b32 v6, 4, v6
    v_and_b32_e64 v43, 1, v5
    v_lshl_add_u32 v6, v43, 3, v6
    v_lshrrev_b32_e64 v5, 1, v5
    v_lshl_add_u32 v6, v5, 6, v6
    v_add_u32_e64 v31, s93, v6
    v_subrev_u32 v5, 503, v4
    v_bfe_u32 v6, v5, 2, 2
    v_xor_b32 v6, v6, v1
    v_lshlrev_b32 v6, 4, v6
    v_and_b32_e64 v43, 1, v5
    v_lshl_add_u32 v6, v43, 3, v6
    v_lshrrev_b32_e64 v5, 1, v5
    v_lshl_add_u32 v6, v5, 6, v6
    v_add_u32 v32, s93, v6
    v_lshrrev_b32 v1, 1, v42
    v_add3_u32 v35, v41, v1, 15
    v_and_b32 v1, 1, v42
    s_lshl_b32 s48, s36, 1
    v_add_u32 v40, s48, v1
    v_lshlrev_b32 v1, 3, v42
    v_sub_u32_e64 v1, v41, v1
    v_mov_b32 v5, 0xffff
    v_mov_b32 v6, -1
    v_add_u32 v4, 16, v1
    v_cmp_le_i32_e64 vcc, 0, v4
    v_cmp_le_i32 s[72:73], 1, v4
    s_nop 0
    v_cndmask_b32 v36, 0, v5, vcc
    v_cndmask_b32 v36, v36, v6, s[72:73]
    v_add_u32 v4, 14, v1
    v_cmp_le_i32 vcc, 0, v4
    v_cmp_le_i32 s[72:73], 1, v4
    s_nop 0
    v_cndmask_b32 v37, 0, v5, vcc
    v_cndmask_b32 v37, v37, v6, s[72:73]
    v_add_u32 v4, 12, v1
    v_cmp_le_i32 vcc, 0, v4
    v_cmp_le_i32 s[72:73], 1, v4
    s_nop 0
    v_cndmask_b32 v38, 0, v5, vcc
    v_cndmask_b32 v38, v38, v6, s[72:73]
    v_add_u32 v4, 10, v1
    v_cmp_le_i32 vcc, 0, v4
    v_cmp_le_i32 s[72:73], 1, v4
    s_nop 0
    v_cndmask_b32 v39, 0, v5, vcc
    v_cndmask_b32 v39, v39, v6, s[72:73]
    v_lshrrev_b32 v1, 3, v0
    v_lshrrev_b32 v4, 4, v0
    v_and_b32_e64 v5, 7, v0
    v_mul_u32_u24 v1, 20480, v1
    v_xor_b32_e64 v6, v4, v5
    v_lshl_add_u32 v44, v6, 4, v1
    v_xor_b32_e64 v45, 64, v44
    s_andn2_b32 s48, s92, 3
    s_lshl_b32 s48, s48, 5
    s_mul_i32 s49, s36, 655360
    s_add_u32 s48, s48, s49
    s_add_u32 s65, s48, 4194304
    s_lshr_b32 s48, s92, 6
    s_lshl_b32 s48, s48, 12
    s_add_u32 s48, s48, 21102592
    v_lshl_add_u32 v46, v0, 7, s48
    s_waitcnt lgkmcnt(0)
    s_bitcmp1_b32 s92, 0
    s_cselect_b32 s48, 0, 16
    s_lshl_b32 s94, s94, s48
    s_and_b32 s94, s94, 0xffff0000
    s_lshl_b32 s95, s95, s48
    s_and_b32 s95, s95, 0xffff0000
    v_mov_b32 v1, 0x3fb8aa3b
    v_mul_f32 v1, s94, v1
    v_exp_f32_e64 v1, v1
    s_nop 0
    v_cvt_pk_bf16_f32 v1, v1, v1
    v_and_b32 v47, 0xffff0000, v1
    s_waitcnt vmcnt(0)
    v_mov_b32 v184, 0x3f80
    v_lshlrev_b32 v64, 16, v8
    v_lshlrev_b32 v65, 16, v9
    v_lshlrev_b32 v66, 16, v10
    v_lshlrev_b32 v67, 16, v11
    v_lshlrev_b32 v68, 16, v12
    v_lshlrev_b32 v69, 16, v13
    v_mul_f32 v64, v47, v64
    v_mul_f32 v65, v47, v65
    v_mul_f32 v66, v47, v66
    v_mul_f32_e64 v67, v47, v67
    v_mul_f32 v64, 0x3fb8aa3b, v64
    v_mul_f32 v65, 0x3e22f983, v65
    v_exp_f32 v96, v64
    v_mul_f32 v98, 0x41000000, v64
    v_mul_f32 v100, 0x43800000, v64
    v_mul_f32 v104, v69, v67
    v_fract_f32 v97, v65
    v_mul_f32 v99, 0x41000000, v65
    v_mul_f32 v101, 0x43800000, v65
    v_mul_f32 v105, v69, v66
    v_cos_f32 v70, v97
    v_exp_f32 v98, v98
    v_exp_f32 v100, v100
    v_fma_f32 v83, v68, v67, v105
    v_sin_f32 v71, v97
    v_fract_f32 v99, v99
    v_fract_f32_e64 v101, v101
    v_fma_f32 v82, v68, v66, -v104
    v_mul_f32 v70, v96, v70
    v_cos_f32 v76, v99
    v_cos_f32 v78, v101
    v_mul_f32 v71, v96, v71
    v_sin_f32 v77, v99
    v_sin_f32 v79, v101
    v_mul_f32 v76, v98, v76
    v_mul_f32 v78, v100, v78
    v_mul_f32 v77, v98, v77
    v_mul_f32 v79, v100, v79
    v_mul_f32 v104, v71, v71
    v_mul_f32 v106, v77, v77
    ds_write_addtid_b32 v184 offset:0
    v_mul_f32 v105, v71, v70
    v_mul_f32 v107, v77, v76
    v_cvt_pk_bf16_f32 v117, v76, v77
    v_fma_f32 v73, v70, v71, v105
    v_fma_f32 v81, v76, v77, v107
    ds_write_addtid_b32 v117 offset:272
    v_fma_f32 v72, v70, v70, -v104
    v_fma_f32 v80, v76, v76, -v106
    v_mul_f32 v104, v73, v73
    v_mul_f32 v105, v73, v72
    v_fma_f32 v75, v72, v73, v105
    v_fma_f32 v74, v72, v72, -v104
    v_cvt_pk_bf16_f32 v113, v80, v81
    v_mul_f32 v106, v77, v81
    v_mul_f32 v108, v83, v79
    ds_write_addtid_b32 v113 offset:544
    v_mul_f32 v107, v77, v80
    v_mul_f32 v109, v83, v78
    v_mul_f32_e64 v104, v81, v81
    v_fma_f32 v99, v76, v81, v107
    v_fma_f32 v85, v82, v79, v109
    v_mul_f32_e64 v105, v81, v80
    v_fma_f32 v98, v76, v80, -v106
    v_fma_f32 v84, v82, v78, -v108
    v_fma_f32 v97, v80, v81, v105
    v_cvt_pk_bf16_f32 v115, v98, v99
    v_cvt_pk_bf16_f32 v116, v82, -v83
    v_mul_f32_e64 v110, v85, v79
    v_fma_f32 v96, v80, v80, -v104
    ds_write_addtid_b32 v115 offset:816
    ds_write_addtid_b32 v116 offset:8704
    v_mul_f32_e64 v111, v85, v78
    v_cvt_pk_bf16_f32 v112, v96, v97
    v_mul_f32 v106, v99, v81
    v_mul_f32 v108, v83, v71
    v_fma_f32 v87, v84, v79, v111
    ds_write_addtid_b32 v112 offset:1088
    v_mul_f32 v107, v99, v80
    v_mul_f32 v109, v83, v70
    v_fma_f32 v86, v84, v78, -v110
    v_mul_f32_e64 v104, v97, v81
    v_fma_f32 v103, v98, v81, v107
    v_fma_f32 v89, v82, v71, v109
    v_cvt_pk_bf16_f32 v119, v86, -v87
    v_mul_f32_e64 v105, v97, v80
    v_fma_f32 v102, v98, v80, -v106
    v_fma_f32 v88, v82, v70, -v108
    ds_write_addtid_b32 v119 offset:14144
    v_fma_f32 v101, v96, v81, v105
    v_cvt_pk_bf16_f32 v114, v102, v103
    v_cvt_pk_bf16_f32 v117, v88, -v89
    v_mul_f32_e64 v110, v87, v75
    v_fma_f32 v100, v96, v80, -v104
    ds_write_addtid_b32 v114 offset:1360
    ds_write_addtid_b32 v117 offset:8976
    v_mul_f32_e64 v111, v87, v74
    v_cvt_pk_bf16_f32 v113, v100, v101
    v_mul_f32 v106, v103, v81
    v_mul_f32 v108, v89, v71
    v_fma_f32 v93, v86, v75, v111
    ds_write_addtid_b32 v113 offset:1632
    v_mul_f32 v107, v103, v80
    v_mul_f32 v109, v89, v70
    v_fma_f32 v92, v86, v74, -v110
    v_mul_f32_e64 v104, v101, v81
    v_fma_f32 v99, v102, v81, v107
    v_fma_f32 v91, v88, v71, v109
    v_cvt_pk_bf16_f32 v118, v92, -v93
    v_mul_f32_e64 v105, v101, v80
    v_fma_f32 v98, v102, v80, -v106
    v_fma_f32 v90, v88, v70, -v108
    ds_write_addtid_b32 v118 offset:14416
    v_fma_f32 v97, v100, v81, v105
    v_cvt_pk_bf16_f32 v115, v98, v99
    v_cvt_pk_bf16_f32 v116, v90, -v91
    v_mul_f32_e64 v110, v93, v75
    v_fma_f32 v96, v100, v80, -v104
    ds_write_addtid_b32 v115 offset:1904
    ds_write_addtid_b32 v116 offset:9248
    v_mul_f32_e64 v111, v93, v74
    v_cvt_pk_bf16_f32 v112, v96, v97
    v_mul_f32 v106, v99, v81
    v_mul_f32 v108, v91, v71
    v_fma_f32 v95, v92, v75, v111
    ds_write_addtid_b32 v112 offset:2176
    v_mul_f32 v107, v99, v80
    v_mul_f32 v109, v91, v70
    v_fma_f32 v94, v92, v74, -v110
    v_mul_f32_e64 v104, v97, v81
    v_fma_f32 v103, v98, v81, v107
    v_fma_f32 v89, v90, v71, v109
    v_cvt_pk_bf16_f32 v119, v94, -v95
    v_mul_f32_e64 v105, v97, v80
    v_fma_f32 v102, v98, v80, -v106
    v_fma_f32 v88, v90, v70, -v108
    ds_write_addtid_b32 v119 offset:14688
    v_fma_f32 v101, v96, v81, v105
    v_cvt_pk_bf16_f32 v114, v102, v103
    v_cvt_pk_bf16_f32 v117, v88, -v89
    v_mul_f32_e64 v110, v87, v79
    v_fma_f32 v100, v96, v80, -v104
    ds_write_addtid_b32 v114 offset:2448
    ds_write_addtid_b32 v117 offset:9520
    v_mul_f32_e64 v111, v87, v78
    v_cvt_pk_bf16_f32 v113, v100, v101
    v_mul_f32 v106, v103, v81
    v_mul_f32 v108, v89, v71
    v_fma_f32 v87, v86, v79, v111
    ds_write_addtid_b32 v113 offset:2720
    v_mul_f32 v107, v103, v80
    v_mul_f32 v109, v89, v70
    v_fma_f32 v86, v86, v78, -v110
    v_mul_f32_e64 v104, v101, v81
    v_fma_f32 v99, v102, v81, v107
    v_fma_f32 v91, v88, v71, v109
    v_cvt_pk_bf16_f32 v118, v86, -v87
    v_mul_f32_e64 v105, v101, v80
    v_fma_f32 v98, v102, v80, -v106
    v_fma_f32 v90, v88, v70, -v108
    ds_write_addtid_b32 v118 offset:10336
    v_fma_f32 v97, v100, v81, v105
    v_cvt_pk_bf16_f32 v115, v98, v99
    v_cvt_pk_bf16_f32 v116, v90, -v91
    v_mul_f32_e64 v110, v87, v75
    v_fma_f32 v96, v100, v80, -v104
    ds_write_addtid_b32 v115 offset:2992
    ds_write_addtid_b32 v116 offset:13056
    v_mul_f32_e64 v111, v87, v74
    v_cvt_pk_bf16_f32 v112, v96, v97
    v_mul_f32 v106, v99, v81
    v_mul_f32 v108, v91, v71
    v_fma_f32 v93, v86, v75, v111
    ds_write_addtid_b32 v112 offset:3264
    v_mul_f32 v107, v99, v80
    v_mul_f32 v109, v91, v70
    v_fma_f32 v92, v86, v74, -v110
    v_mul_f32_e64 v104, v97, v81
    v_fma_f32 v103, v98, v81, v107
    v_fma_f32 v89, v90, v71, v109
    v_cvt_pk_bf16_f32 v119, v92, -v93
    v_mul_f32_e64 v105, v97, v80
    v_fma_f32 v102, v98, v80, -v106
    v_fma_f32 v88, v90, v70, -v108
    ds_write_addtid_b32 v119 offset:10608
    v_fma_f32 v101, v96, v81, v105
    v_cvt_pk_bf16_f32 v114, v102, v103
    v_cvt_pk_bf16_f32 v117, v88, -v89
    v_mul_f32_e64 v110, v93, v75
    v_fma_f32 v100, v96, v80, -v104
    ds_write_addtid_b32 v114 offset:3536
    ds_write_addtid_b32 v117 offset:13328
    v_mul_f32_e64 v111, v93, v74
    v_cvt_pk_bf16_f32 v113, v100, v101
    v_mul_f32 v106, v103, v81
    v_mul_f32 v108, v89, v71
    v_fma_f32 v95, v92, v75, v111
    ds_write_addtid_b32 v113 offset:3808
    v_mul_f32 v107, v103, v80
    v_mul_f32 v109, v89, v70
    v_fma_f32 v94, v92, v74, -v110
    v_mul_f32_e64 v104, v101, v81
    v_fma_f32 v99, v102, v81, v107
    v_fma_f32 v91, v88, v71, v109
    v_cvt_pk_bf16_f32 v118, v94, -v95
    v_mul_f32_e64 v105, v101, v80
    v_fma_f32 v98, v102, v80, -v106
    v_fma_f32 v90, v88, v70, -v108
    ds_write_addtid_b32 v118 offset:10880
    v_fma_f32 v97, v100, v81, v105
    v_cvt_pk_bf16_f32 v115, v98, v99
    v_cvt_pk_bf16_f32 v116, v90, -v91
    v_mul_f32_e64 v110, v87, v79
    v_fma_f32 v96, v100, v80, -v104
    ds_write_addtid_b32 v115 offset:4080
    ds_write_addtid_b32 v116 offset:13600
    v_mul_f32_e64 v111, v87, v78
    v_cvt_pk_bf16_f32 v112, v96, v97
    v_mul_f32 v106, v99, v81
    v_mul_f32 v108, v91, v71
    v_fma_f32 v87, v86, v79, v111
    ds_write_addtid_b32 v112 offset:4352
    v_mul_f32 v107, v99, v80
    v_mul_f32 v109, v91, v70
    v_fma_f32 v86, v86, v78, -v110
    v_mul_f32_e64 v104, v97, v81
    v_fma_f32 v103, v98, v81, v107
    v_fma_f32 v89, v90, v71, v109
    v_cvt_pk_bf16_f32 v119, v86, -v87
    v_mul_f32_e64 v105, v97, v80
    v_fma_f32 v102, v98, v80, -v106
    v_fma_f32 v88, v90, v70, -v108
    ds_write_addtid_b32 v119 offset:14960
    v_fma_f32 v101, v96, v81, v105
    v_cvt_pk_bf16_f32 v114, v102, v103
    v_cvt_pk_bf16_f32 v117, v88, -v89
    v_mul_f32_e64 v110, v87, v77
    v_fma_f32 v100, v96, v80, -v104
    ds_write_addtid_b32 v114 offset:4624
    ds_write_addtid_b32 v117 offset:13872
    v_mul_f32_e64 v111, v87, v76
    v_cvt_pk_bf16_f32 v113, v100, v101
    v_mul_f32_e64 v106, v103, v81
    v_cvt_pk_bf16_f32 v116, v84, -v85
    v_fma_f32 v93, v86, v77, v111
    ds_write_addtid_b32 v113 offset:4896
    v_mul_f32_e64 v107, v103, v80
    ds_write_addtid_b32 v116 offset:12240
    v_fma_f32 v92, v86, v76, -v110
    v_mul_f32_e64 v104, v101, v81
    v_fma_f32 v99, v102, v81, v107
    v_mul_f32_e64 v108, v85, v73
    v_cvt_pk_bf16_f32 v118, v92, -v93
    v_mul_f32_e64 v105, v101, v80
    v_fma_f32 v98, v102, v80, -v106
    v_mul_f32_e64 v109, v85, v72
    ds_write_addtid_b32 v118 offset:11424
    v_fma_f32 v97, v100, v81, v105
    v_cvt_pk_bf16_f32 v115, v98, v99
    v_fma_f32 v89, v84, v73, v109
    v_mul_f32_e64 v110, v87, v79
    v_fma_f32 v96, v100, v80, -v104
    ds_write_addtid_b32 v115 offset:5168
    v_fma_f32 v88, v84, v72, -v108
    v_mul_f32_e64 v111, v87, v78
    v_cvt_pk_bf16_f32 v112, v96, v97
    v_mul_f32_e64 v106, v99, v81
    v_cvt_pk_bf16_f32 v117, v88, -v89
    v_fma_f32 v87, v86, v79, v111
    ds_write_addtid_b32 v112 offset:5440
    v_mul_f32_e64 v107, v99, v80
    ds_write_addtid_b32 v117 offset:12512
    v_fma_f32 v86, v86, v78, -v110
    v_mul_f32_e64 v104, v97, v81
    v_fma_f32 v103, v98, v81, v107
    v_mul_f32_e64 v108, v89, v73
    v_cvt_pk_bf16_f32 v119, v86, -v87
    v_mul_f32_e64 v105, v97, v80
    v_fma_f32 v102, v98, v80, -v106
    v_mul_f32_e64 v109, v89, v72
    ds_write_addtid_b32 v119 offset:11696
    v_fma_f32 v101, v96, v81, v105
    v_cvt_pk_bf16_f32 v114, v102, v103
    v_fma_f32 v91, v88, v73, v109
    v_mul_f32_e64 v110, v87, v77
    v_fma_f32 v100, v96, v80, -v104
    ds_write_addtid_b32 v114 offset:5712
    v_fma_f32 v90, v88, v72, -v108
    v_mul_f32_e64 v111, v87, v76
    v_cvt_pk_bf16_f32 v113, v100, v101
    v_mul_f32_e64 v106, v103, v81
    v_cvt_pk_bf16_f32 v116, v90, -v91
    v_fma_f32 v93, v86, v77, v111
    ds_write_addtid_b32 v113 offset:5984
    v_mul_f32_e64 v107, v103, v80
    ds_write_addtid_b32 v116 offset:12784
    v_fma_f32 v92, v86, v76, -v110
    v_mul_f32_e64 v104, v101, v81
    v_fma_f32 v99, v102, v81, v107
    v_mul_f32_e64 v108, v91, v73
    v_cvt_pk_bf16_f32 v118, v92, -v93
    v_mul_f32_e64 v105, v101, v80
    v_fma_f32 v98, v102, v80, -v106
    v_mul_f32_e64 v109, v91, v72
    ds_write_addtid_b32 v118 offset:11968
    v_fma_f32 v97, v100, v81, v105
    v_cvt_pk_bf16_f32 v115, v98, v99
    v_fma_f32 v89, v90, v73, v109
    v_mul_f32_e64 v110, v87, v79
    v_fma_f32 v96, v100, v80, -v104
    ds_write_addtid_b32 v115 offset:6256
    v_fma_f32 v88, v90, v72, -v108
    v_mul_f32_e64 v111, v87, v78
    v_cvt_pk_bf16_f32 v112, v96, v97
    v_mul_f32_e64 v106, v99, v81
    v_cvt_pk_bf16_f32 v117, v88, -v89
    v_fma_f32 v87, v86, v79, v111
    ds_write_addtid_b32 v112 offset:6528
    v_mul_f32_e64 v107, v99, v80
    ds_write_addtid_b32 v117 offset:9792
    v_fma_f32 v86, v86, v78, -v110
    v_mul_f32_e64 v104, v97, v81
    v_fma_f32 v103, v98, v81, v107
    v_mul_f32_e64 v108, v89, v73
    v_cvt_pk_bf16_f32 v119, v86, -v87
    v_mul_f32_e64 v105, v97, v80
    v_fma_f32 v102, v98, v80, -v106
    v_mul_f32_e64 v109, v89, v72
    ds_write_addtid_b32 v119 offset:11152
    v_fma_f32 v101, v96, v81, v105
    v_cvt_pk_bf16_f32 v114, v102, v103
    v_fma_f32 v91, v88, v73, v109
    v_mul_f32_e64 v110, v87, v77
    v_fma_f32 v100, v96, v80, -v104
    ds_write_addtid_b32 v114 offset:6800
    v_fma_f32 v90, v88, v72, -v108
    v_mul_f32_e64 v111, v87, v76
    v_cvt_pk_bf16_f32 v113, v100, v101
    v_mul_f32_e64 v106, v103, v81
    v_cvt_pk_bf16_f32 v116, v90, -v91
    v_fma_f32 v93, v86, v77, v111
    ds_write_addtid_b32 v113 offset:7072
    v_mul_f32_e64 v107, v103, v80
    ds_write_addtid_b32 v116 offset:10064
    v_fma_f32 v92, v86, v76, -v110
    v_mul_f32_e64 v104, v101, v81
    v_fma_f32 v99, v102, v81, v107
    v_cvt_pk_bf16_f32 v118, v92, -v93
    v_mul_f32_e64 v105, v101, v80
    v_fma_f32 v98, v102, v80, -v106
    ds_write_addtid_b32 v118 offset:15232
    v_fma_f32 v97, v100, v81, v105
    v_cvt_pk_bf16_f32 v115, v98, v99
    v_mul_f32_e64 v110, v87, v79
    v_fma_f32 v96, v100, v80, -v104
    ds_write_addtid_b32 v115 offset:7344
    v_mul_f32_e64 v111, v87, v78
    v_cvt_pk_bf16_f32 v112, v96, v97
    v_mul_f32_e64 v106, v99, v81
    v_fma_f32 v87, v86, v79, v111
    ds_write_addtid_b32 v112 offset:7616
    v_mul_f32_e64 v107, v99, v80
    v_fma_f32 v86, v86, v78, -v110
    v_mul_f32_e64 v104, v97, v81
    v_fma_f32 v103, v98, v81, v107
    v_cvt_pk_bf16_f32 v119, v86, -v87
    v_mul_f32_e64 v105, v97, v80
    v_fma_f32 v102, v98, v80, -v106
    ds_write_addtid_b32 v119 offset:15504
    v_fma_f32 v101, v96, v81, v105
    v_cvt_pk_bf16_f32 v114, v102, v103
    v_mul_f32_e64 v110, v87, v77
    v_fma_f32 v100, v96, v80, -v104
    ds_write_addtid_b32 v114 offset:7888
    v_mul_f32_e64 v111, v87, v76
    v_cvt_pk_bf16_f32 v113, v100, v101
    v_mul_f32_e64 v106, v103, v81
    v_fma_f32 v93, v86, v77, v111
    ds_write_addtid_b32 v113 offset:8160
    v_mul_f32_e64 v107, v103, v80
    v_fma_f32 v92, v86, v76, -v110
    v_fma_f32 v99, v102, v81, v107
    v_cvt_pk_bf16_f32 v118, v92, -v93
    v_fma_f32 v98, v102, v80, -v106
    ds_write_addtid_b32 v118 offset:15776
    v_cvt_pk_bf16_f32 v115, v98, v99
    ds_write_addtid_b32 v115 offset:8432
    s_waitcnt lgkmcnt(0)
    s_nop 0
    ds_read_b128 v[120:123], v20 offset:0
    ds_read_b128 v[124:127], v21 offset:0
    ds_read_b128 v[128:131], v20 offset:32
    ds_read_b128 v[132:135], v21 offset:32
    ds_read_b128 v[136:139], v20 offset:64
    ds_read_b128 v[140:143], v21 offset:64
    ds_read_b128 v[144:147], v20 offset:96
    ds_read_b128 v[148:151], v21 offset:96
    ds_read_b128 v[152:155], v20 offset:128
    ds_read_b128 v[156:159], v21 offset:128
    ds_read_b128 v[160:163], v20 offset:160
    ds_read_b128 v[164:167], v21 offset:160
    ds_read_b128 v[168:171], v20 offset:192
    ds_read_b128 v[172:175], v21 offset:192
    ds_read_b128 v[176:179], v20 offset:224
    ds_read_b128 v[180:183], v21 offset:224
    v_and_b32 v64, 0xffff0000, v8
    v_and_b32 v65, 0xffff0000, v9
    v_and_b32 v66, 0xffff0000, v10
    v_and_b32 v67, 0xffff0000, v11
    v_and_b32 v68, 0xffff0000, v12
    v_and_b32 v69, 0xffff0000, v13
    v_mul_f32 v64, v47, v64
    v_mul_f32 v65, v47, v65
    v_mul_f32 v66, v47, v66
    v_mul_f32 v67, v47, v67
    v_mul_f32 v64, 0x3fb8aa3b, v64
    v_mul_f32 v65, 0x3e22f983, v65
    v_exp_f32 v96, v64
    v_mul_f32 v98, 0x41000000, v64
    v_mul_f32 v100, 0x43800000, v64
    v_mul_f32 v104, v69, v67
    v_fract_f32 v97, v65
    v_mul_f32 v99, 0x41000000, v65
    v_mul_f32 v101, 0x43800000, v65
    v_mul_f32 v105, v69, v66
    v_cos_f32 v70, v97
    v_exp_f32 v98, v98
    v_exp_f32 v100, v100
    v_fma_f32 v83, v68, v67, v105
    v_sin_f32 v71, v97
    v_fract_f32 v99, v99
    v_fract_f32_e64 v101, v101
    v_fma_f32 v82, v68, v66, -v104
    v_mul_f32 v70, v96, v70
    v_cos_f32 v76, v99
    v_cos_f32 v78, v101
    v_mul_f32 v71, v96, v71
    v_sin_f32 v77, v99
    v_sin_f32 v79, v101
    v_mul_f32 v76, v98, v76
    v_mul_f32 v78, v100, v78
    v_mul_f32 v77, v98, v77
    v_mul_f32 v79, v100, v79
    s_waitcnt lgkmcnt(0)
    v_mul_f32 v104, v71, v71
    v_mul_f32_e64 v106, v77, v77
    ds_write_addtid_b32 v184 offset:0
    v_mul_f32 v105, v71, v70
    v_mul_f32 v107, v77, v76
    v_cvt_pk_bf16_f32 v117, v76, v77
    v_fma_f32 v73, v70, v71, v105
    v_fma_f32 v81, v76, v77, v107
    ds_write_addtid_b32 v117 offset:272
    v_fma_f32 v72, v70, v70, -v104
    v_fma_f32 v80, v76, v76, -v106
    v_mul_f32 v104, v73, v73
    v_mul_f32 v105, v73, v72
    v_fma_f32 v75, v72, v73, v105
    v_fma_f32 v74, v72, v72, -v104
    v_cvt_pk_bf16_f32 v112, v80, v81
    v_mul_f32 v106, v77, v81
    v_mul_f32 v108, v83, v79
    v_mfma_f32_32x32x16_bf16 v[48:63], v[120:123], v[124:127], 0
    ds_write_addtid_b32 v112 offset:544
    v_mul_f32 v107, v77, v80
    v_mul_f32 v109, v83, v78
    v_mul_f32_e64 v104, v81, v81
    v_fma_f32 v99, v76, v81, v107
    v_fma_f32 v85, v82, v79, v109
    v_mul_f32_e64 v105, v81, v80
    v_fma_f32 v98, v76, v80, -v106
    v_fma_f32 v84, v82, v78, -v108
    v_mfma_f32_32x32x16_bf16 v[48:63], v[128:131], v[132:135], v[48:63]
    v_fma_f32 v97, v80, v81, v105
    v_cvt_pk_bf16_f32 v114, v98, v99
    v_cvt_pk_bf16_f32 v116, v82, -v83
    v_mul_f32_e64 v110, v85, v79
    v_fma_f32 v96, v80, v80, -v104
    ds_write_addtid_b32 v114 offset:816
    ds_write_addtid_b32 v116 offset:8704
    v_mul_f32_e64 v111, v85, v78
    v_cvt_pk_bf16_f32 v113, v96, v97
    v_mul_f32 v106, v99, v81
    v_mul_f32 v108, v83, v71
    v_fma_f32 v87, v84, v79, v111
    v_mfma_f32_32x32x16_bf16 v[48:63], v[136:139], v[140:143], v[48:63]
    ds_write_addtid_b32 v113 offset:1088
    v_mul_f32 v107, v99, v80
    v_mul_f32 v109, v83, v70
    v_fma_f32 v86, v84, v78, -v110
    v_mul_f32_e64 v104, v97, v81
    v_fma_f32 v103, v98, v81, v107
    v_fma_f32 v89, v82, v71, v109
    v_cvt_pk_bf16_f32 v119, v86, -v87
    v_mul_f32_e64 v105, v97, v80
    v_fma_f32 v102, v98, v80, -v106
    v_fma_f32 v88, v82, v70, -v108
    ds_write_addtid_b32 v119 offset:14144
    v_mfma_f32_32x32x16_bf16 v[48:63], v[144:147], v[148:151], v[48:63]
    v_fma_f32 v101, v96, v81, v105
    v_cvt_pk_bf16_f32 v115, v102, v103
    v_cvt_pk_bf16_f32 v117, v88, -v89
    v_mul_f32_e64 v110, v87, v75
    v_fma_f32 v100, v96, v80, -v104
    ds_write_addtid_b32 v115 offset:1360
    ds_write_addtid_b32 v117 offset:8976
    v_mul_f32_e64 v111, v87, v74
    v_cvt_pk_bf16_f32 v112, v100, v101
    v_mul_f32 v106, v103, v81
    v_mul_f32 v108, v89, v71
    v_fma_f32 v93, v86, v75, v111
    v_mfma_f32_32x32x16_bf16 v[48:63], v[152:155], v[156:159], v[48:63]
    ds_write_addtid_b32 v112 offset:1632
    v_mul_f32 v107, v103, v80
    v_mul_f32 v109, v89, v70
    v_fma_f32 v92, v86, v74, -v110
    v_mul_f32_e64 v104, v101, v81
    v_fma_f32 v99, v102, v81, v107
    v_fma_f32 v91, v88, v71, v109
    v_cvt_pk_bf16_f32 v118, v92, -v93
    v_mul_f32_e64 v105, v101, v80
    v_fma_f32 v98, v102, v80, -v106
    v_fma_f32 v90, v88, v70, -v108
    ds_write_addtid_b32 v118 offset:14416
    v_mfma_f32_32x32x16_bf16 v[48:63], v[160:163], v[164:167], v[48:63]
    v_fma_f32 v97, v100, v81, v105
    v_cvt_pk_bf16_f32 v114, v98, v99
    v_cvt_pk_bf16_f32 v116, v90, -v91
    v_mul_f32_e64 v110, v93, v75
    v_fma_f32 v96, v100, v80, -v104
    ds_write_addtid_b32 v114 offset:1904
    ds_write_addtid_b32 v116 offset:9248
    v_mul_f32_e64 v111, v93, v74
    v_cvt_pk_bf16_f32 v113, v96, v97
    v_mul_f32 v106, v99, v81
    v_mul_f32 v108, v91, v71
    v_fma_f32 v95, v92, v75, v111
    v_mfma_f32_32x32x16_bf16 v[48:63], v[168:171], v[172:175], v[48:63]
    ds_write_addtid_b32 v113 offset:2176
    v_mul_f32 v107, v99, v80
    v_mul_f32 v109, v91, v70
    v_fma_f32 v94, v92, v74, -v110
    v_mul_f32_e64 v104, v97, v81
    v_fma_f32 v103, v98, v81, v107
    v_fma_f32 v89, v90, v71, v109
    v_cvt_pk_bf16_f32 v119, v94, -v95
    v_mul_f32_e64 v105, v97, v80
    v_fma_f32 v102, v98, v80, -v106
    v_fma_f32 v88, v90, v70, -v108
    ds_write_addtid_b32 v119 offset:14688
    v_mfma_f32_32x32x16_bf16 v[48:63], v[176:179], v[180:183], v[48:63]
    v_fma_f32 v101, v96, v81, v105
    v_cvt_pk_bf16_f32 v115, v102, v103
    v_cvt_pk_bf16_f32 v117, v88, -v89
    v_mul_f32_e64 v110, v87, v79
    v_fma_f32 v100, v96, v80, -v104
    ds_write_addtid_b32 v115 offset:2448
    ds_write_addtid_b32 v117 offset:9520
    v_mul_f32_e64 v111, v87, v78
    v_cvt_pk_bf16_f32 v112, v100, v101
    v_mul_f32 v106, v103, v81
    v_mul_f32 v108, v89, v71
    v_fma_f32 v87, v86, v79, v111
    ds_write_addtid_b32 v112 offset:2720
    v_mul_f32 v107, v103, v80
    v_mul_f32 v109, v89, v70
    v_fma_f32 v86, v86, v78, -v110
    v_mul_f32_e64 v104, v101, v81
    v_fma_f32 v99, v102, v81, v107
    v_fma_f32 v91, v88, v71, v109
    v_cvt_pk_bf16_f32 v118, v86, -v87
    v_mul_f32_e64 v105, v101, v80
    v_fma_f32 v98, v102, v80, -v106
    v_fma_f32 v90, v88, v70, -v108
    ds_write_addtid_b32 v118 offset:10336
    v_fma_f32 v97, v100, v81, v105
    v_cvt_pk_bf16_f32 v114, v98, v99
    v_cvt_pk_bf16_f32 v116, v90, -v91
    v_mul_f32_e64 v110, v87, v75
    v_fma_f32 v96, v100, v80, -v104
    ds_write_addtid_b32 v114 offset:2992
    ds_write_addtid_b32 v116 offset:13056
    v_mul_f32_e64 v111, v87, v74
    v_cvt_pk_bf16_f32 v113, v96, v97
    v_mul_f32 v106, v99, v81
    v_mul_f32 v108, v91, v71
    v_fma_f32 v93, v86, v75, v111
    ds_write_addtid_b32 v113 offset:3264
    v_mul_f32 v107, v99, v80
    v_mul_f32 v109, v91, v70
    v_fma_f32 v92, v86, v74, -v110
    v_mul_f32_e64 v104, v97, v81
    v_fma_f32 v103, v98, v81, v107
    v_fma_f32 v89, v90, v71, v109
    v_cvt_pk_bf16_f32 v119, v92, -v93
    v_mul_f32_e64 v105, v97, v80
    v_fma_f32 v102, v98, v80, -v106
    v_fma_f32 v88, v90, v70, -v108
    ds_write_addtid_b32 v119 offset:10608
    v_fma_f32 v101, v96, v81, v105
    v_cvt_pk_bf16_f32 v115, v102, v103
    v_cvt_pk_bf16_f32 v117, v88, -v89
    v_mul_f32_e64 v110, v93, v75
    v_fma_f32 v100, v96, v80, -v104
    ds_write_addtid_b32 v115 offset:3536
    ds_write_addtid_b32 v117 offset:13328
    v_mul_f32_e64 v111, v93, v74
    v_cvt_pk_bf16_f32 v112, v100, v101
    v_mul_f32 v106, v103, v81
    v_mul_f32 v108, v89, v71
    v_fma_f32 v95, v92, v75, v111
    ds_write_addtid_b32 v112 offset:3808
    v_mul_f32 v107, v103, v80
    v_mul_f32 v109, v89, v70
    v_fma_f32 v94, v92, v74, -v110
    v_mul_f32_e64 v104, v101, v81
    v_fma_f32 v99, v102, v81, v107
    v_fma_f32 v91, v88, v71, v109
    v_cvt_pk_bf16_f32 v118, v94, -v95
    v_mul_f32_e64 v105, v101, v80
    v_fma_f32 v98, v102, v80, -v106
    v_fma_f32 v90, v88, v70, -v108
    ds_write_addtid_b32 v118 offset:10880
    v_fma_f32 v97, v100, v81, v105
    v_cvt_pk_bf16_f32 v114, v98, v99
    v_cvt_pk_bf16_f32 v116, v90, -v91
    v_mul_f32_e64 v110, v87, v79
    v_fma_f32 v96, v100, v80, -v104
    ds_write_addtid_b32 v114 offset:4080
    ds_write_addtid_b32 v116 offset:13600
    v_mul_f32_e64 v111, v87, v78
    v_cvt_pk_bf16_f32 v113, v96, v97
    v_mul_f32 v106, v99, v81
    v_mul_f32 v108, v91, v71
    v_fma_f32 v87, v86, v79, v111
    ds_write_addtid_b32 v113 offset:4352
    v_mul_f32 v107, v99, v80
    v_mul_f32 v109, v91, v70
    v_fma_f32 v86, v86, v78, -v110
    v_mul_f32_e64 v104, v97, v81
    v_fma_f32 v103, v98, v81, v107
    v_fma_f32 v89, v90, v71, v109
    v_cvt_pk_bf16_f32 v119, v86, -v87
    v_mul_f32_e64 v105, v97, v80
    v_fma_f32 v102, v98, v80, -v106
    v_fma_f32 v88, v90, v70, -v108
    ds_write_addtid_b32 v119 offset:14960
    v_fma_f32 v101, v96, v81, v105
    v_cvt_pk_bf16_f32 v115, v102, v103
    v_cvt_pk_bf16_f32 v117, v88, -v89
    v_mul_f32_e64 v110, v87, v77
    v_fma_f32 v100, v96, v80, -v104
    ds_write_addtid_b32 v115 offset:4624
    ds_write_addtid_b32 v117 offset:13872
    v_mul_f32_e64 v111, v87, v76
    v_cvt_pk_bf16_f32 v112, v100, v101
    v_mul_f32_e64 v106, v103, v81
    v_cvt_pk_bf16_f32 v116, v84, -v85
    v_fma_f32 v93, v86, v77, v111
    ds_write_addtid_b32 v112 offset:4896
    v_mul_f32_e64 v107, v103, v80
    ds_write_addtid_b32 v116 offset:12240
    v_fma_f32 v92, v86, v76, -v110
    v_mul_f32_e64 v104, v101, v81
    v_fma_f32 v99, v102, v81, v107
    v_mul_f32_e64 v108, v85, v73
    v_cvt_pk_bf16_f32 v118, v92, -v93
    v_mul_f32_e64 v105, v101, v80
    v_fma_f32 v98, v102, v80, -v106
    v_mul_f32_e64 v109, v85, v72
    ds_write_addtid_b32 v118 offset:11424
    v_fma_f32 v97, v100, v81, v105
    v_cvt_pk_bf16_f32 v114, v98, v99
    v_fma_f32 v89, v84, v73, v109
    v_mul_f32_e64 v110, v87, v79
    v_fma_f32 v96, v100, v80, -v104
    ds_write_addtid_b32 v114 offset:5168
    v_fma_f32 v88, v84, v72, -v108
    v_mul_f32_e64 v111, v87, v78
    v_cvt_pk_bf16_f32 v113, v96, v97
    v_mul_f32_e64 v106, v99, v81
    v_cvt_pk_bf16_f32 v117, v88, -v89
    v_fma_f32 v87, v86, v79, v111
    ds_write_addtid_b32 v113 offset:5440
    v_mul_f32_e64 v107, v99, v80
    ds_write_addtid_b32 v117 offset:12512
    v_fma_f32 v86, v86, v78, -v110
    v_mul_f32_e64 v104, v97, v81
    v_fma_f32 v103, v98, v81, v107
    v_mul_f32_e64 v108, v89, v73
    v_cvt_pk_bf16_f32 v119, v86, -v87
    v_mul_f32_e64 v105, v97, v80
    v_fma_f32 v102, v98, v80, -v106
    v_mul_f32_e64 v109, v89, v72
    ds_write_addtid_b32 v119 offset:11696
    v_fma_f32 v101, v96, v81, v105
    v_cvt_pk_bf16_f32 v115, v102, v103
    v_fma_f32 v91, v88, v73, v109
    v_mul_f32_e64 v110, v87, v77
    v_fma_f32 v100, v96, v80, -v104
    ds_write_addtid_b32 v115 offset:5712
    v_fma_f32 v90, v88, v72, -v108
    v_mul_f32_e64 v111, v87, v76
    v_cvt_pk_bf16_f32 v112, v100, v101
    v_mul_f32_e64 v106, v103, v81
    v_cvt_pk_bf16_f32 v116, v90, -v91
    v_fma_f32 v93, v86, v77, v111
    ds_write_addtid_b32 v112 offset:5984
    v_mul_f32_e64 v107, v103, v80
    ds_write_addtid_b32 v116 offset:12784
    v_fma_f32 v92, v86, v76, -v110
    v_mul_f32_e64 v104, v101, v81
    v_fma_f32 v99, v102, v81, v107
    v_mul_f32_e64 v108, v91, v73
    v_cvt_pk_bf16_f32 v118, v92, -v93
    v_mul_f32_e64 v105, v101, v80
    v_fma_f32 v98, v102, v80, -v106
    v_mul_f32_e64 v109, v91, v72
    ds_write_addtid_b32 v118 offset:11968
    v_fma_f32 v97, v100, v81, v105
    v_cvt_pk_bf16_f32 v114, v98, v99
    v_fma_f32 v89, v90, v73, v109
    v_mul_f32_e64 v110, v87, v79
    v_fma_f32 v96, v100, v80, -v104
    ds_write_addtid_b32 v114 offset:6256
    v_fma_f32 v88, v90, v72, -v108
    v_mul_f32_e64 v111, v87, v78
    v_cvt_pk_bf16_f32 v113, v96, v97
    v_mul_f32_e64 v106, v99, v81
    v_cvt_pk_bf16_f32 v117, v88, -v89
    v_fma_f32 v87, v86, v79, v111
    ds_write_addtid_b32 v113 offset:6528
    v_mul_f32_e64 v107, v99, v80
    ds_write_addtid_b32 v117 offset:9792
    v_fma_f32 v86, v86, v78, -v110
    v_mul_f32_e64 v104, v97, v81
    v_fma_f32 v103, v98, v81, v107
    v_mul_f32_e64 v108, v89, v73
    v_cvt_pk_bf16_f32 v119, v86, -v87
    v_mul_f32_e64 v105, v97, v80
    v_fma_f32 v102, v98, v80, -v106
    v_mul_f32_e64 v109, v89, v72
    ds_write_addtid_b32 v119 offset:11152
    v_fma_f32 v101, v96, v81, v105
    v_cvt_pk_bf16_f32 v115, v102, v103
    v_fma_f32 v91, v88, v73, v109
    v_mul_f32_e64 v110, v87, v77
    v_fma_f32 v100, v96, v80, -v104
    ds_write_addtid_b32 v115 offset:6800
    v_fma_f32 v90, v88, v72, -v108
    v_mul_f32_e64 v111, v87, v76
    v_cvt_pk_bf16_f32 v112, v100, v101
    v_mul_f32_e64 v106, v103, v81
    v_cvt_pk_bf16_f32 v116, v90, -v91
    v_fma_f32 v93, v86, v77, v111
    ds_write_addtid_b32 v112 offset:7072
    v_mul_f32_e64 v107, v103, v80
    ds_write_addtid_b32 v116 offset:10064
    v_fma_f32 v92, v86, v76, -v110
    v_mul_f32_e64 v104, v101, v81
    v_fma_f32 v99, v102, v81, v107
    v_cvt_pk_bf16_f32 v118, v92, -v93
    v_mul_f32_e64 v105, v101, v80
    v_fma_f32 v98, v102, v80, -v106
    ds_write_addtid_b32 v118 offset:15232
    v_fma_f32 v97, v100, v81, v105
    v_cvt_pk_bf16_f32 v114, v98, v99
    v_mul_f32_e64 v110, v87, v79
    v_fma_f32 v96, v100, v80, -v104
    ds_write_addtid_b32 v114 offset:7344
    v_mul_f32_e64 v111, v87, v78
    v_cvt_pk_bf16_f32 v113, v96, v97
    v_mul_f32_e64 v106, v99, v81
    v_fma_f32 v87, v86, v79, v111
    ds_write_addtid_b32 v113 offset:7616
    v_mul_f32_e64 v107, v99, v80
    v_fma_f32 v86, v86, v78, -v110
    v_mul_f32_e64 v104, v97, v81
    v_fma_f32 v103, v98, v81, v107
    v_cvt_pk_bf16_f32 v119, v86, -v87
    v_mul_f32_e64 v105, v97, v80
    v_fma_f32 v102, v98, v80, -v106
    ds_write_addtid_b32 v119 offset:15504
    v_fma_f32 v101, v96, v81, v105
    v_cvt_pk_bf16_f32 v115, v102, v103
    v_mul_f32_e64 v110, v87, v77
    v_fma_f32 v100, v96, v80, -v104
    ds_write_addtid_b32 v115 offset:7888
    v_mul_f32_e64 v111, v87, v76
    v_cvt_pk_bf16_f32 v112, v100, v101
    v_mul_f32_e64 v106, v103, v81
    v_fma_f32 v93, v86, v77, v111
    ds_write_addtid_b32 v112 offset:8160
    v_mul_f32_e64 v107, v103, v80
    v_fma_f32 v92, v86, v76, -v110
    v_fma_f32 v99, v102, v81, v107
    v_cvt_pk_bf16_f32 v118, v92, -v93
    v_fma_f32 v98, v102, v80, -v106
    ds_write_addtid_b32 v118 offset:15776
    v_cvt_pk_bf16_f32 v114, v98, v99
    ds_write_addtid_b32 v114 offset:8432
    s_waitcnt lgkmcnt(0)
    s_nop 0
    ds_read_b128 v[120:123], v20 offset:0
    ds_read_b128 v[124:127], v21 offset:0
    ds_read_b128 v[128:131], v20 offset:32
    ds_read_b128 v[132:135], v21 offset:32
    ds_read_b128 v[136:139], v20 offset:64
    ds_read_b128 v[140:143], v21 offset:64
    ds_read_b128 v[144:147], v20 offset:96
    ds_read_b128 v[148:151], v21 offset:96
    ds_read_b128 v[152:155], v20 offset:128
    ds_read_b128 v[156:159], v21 offset:128
    ds_read_b128 v[160:163], v20 offset:160
    ds_read_b128 v[164:167], v21 offset:160
    ds_read_b128 v[168:171], v20 offset:192
    ds_read_b128 v[172:175], v21 offset:192
    ds_read_b128 v[176:179], v20 offset:224
    ds_read_b128 v[180:183], v21 offset:224
    v_lshlrev_b32 v64, 16, v14
    v_lshlrev_b32 v65, 16, v15
    v_lshlrev_b32 v66, 16, v16
    v_lshlrev_b32 v67, 16, v17
    v_lshlrev_b32 v68, 16, v18
    v_lshlrev_b32 v69, 16, v19
    v_mul_f32 v64, v47, v64
    v_mul_f32 v65, v47, v65
    v_mul_f32 v66, v47, v66
    v_mul_f32 v67, v47, v67
    v_mul_f32 v64, 0x3fb8aa3b, v64
    v_mul_f32 v65, 0x3e22f983, v65
    v_exp_f32 v96, v64
    v_mul_f32 v98, 0x41000000, v64
    v_mul_f32 v100, 0x43800000, v64
    v_mul_f32 v104, v69, v67
    v_fract_f32 v97, v65
    v_mul_f32 v99, 0x41000000, v65
    v_mul_f32 v101, 0x43800000, v65
    v_mul_f32 v105, v69, v66
    v_cos_f32 v70, v97
    v_exp_f32 v98, v98
    v_exp_f32 v100, v100
    v_fma_f32 v83, v68, v67, v105
    v_sin_f32 v71, v97
    v_fract_f32 v99, v99
    v_fract_f32_e64 v101, v101
    v_fma_f32 v82, v68, v66, -v104
    v_mul_f32 v70, v96, v70
    v_cos_f32 v76, v99
    v_cos_f32 v78, v101
    v_mul_f32 v71, v96, v71
    v_sin_f32 v77, v99
    v_sin_f32 v79, v101
    v_mul_f32 v76, v98, v76
    v_mul_f32 v78, v100, v78
    v_mul_f32 v77, v98, v77
    v_mul_f32 v79, v100, v79
    s_waitcnt lgkmcnt(0)
    v_mul_f32 v104, v71, v71
    v_mul_f32_e64 v106, v77, v77
    ds_write_addtid_b32 v184 offset:0
    v_mul_f32 v105, v71, v70
    v_mul_f32 v107, v77, v76
    v_cvt_pk_bf16_f32 v117, v76, v77
    v_fma_f32 v73, v70, v71, v105
    v_fma_f32 v81, v76, v77, v107
    ds_write_addtid_b32 v117 offset:272
    v_fma_f32 v72, v70, v70, -v104
    v_fma_f32 v80, v76, v76, -v106
    v_mul_f32 v104, v73, v73
    v_mul_f32 v105, v73, v72
    v_fma_f32 v75, v72, v73, v105
    v_fma_f32 v74, v72, v72, -v104
    v_cvt_pk_bf16_f32 v113, v80, v81
    v_mul_f32 v106, v77, v81
    v_mul_f32 v108, v83, v79
    v_mfma_f32_32x32x16_bf16 v[48:63], v[120:123], v[124:127], v[48:63]
    ds_write_addtid_b32 v113 offset:544
    v_mul_f32 v107, v77, v80
    v_mul_f32 v109, v83, v78
    v_mul_f32_e64 v104, v81, v81
    v_fma_f32 v99, v76, v81, v107
    v_fma_f32 v85, v82, v79, v109
    v_mul_f32_e64 v105, v81, v80
    v_fma_f32 v98, v76, v80, -v106
    v_fma_f32 v84, v82, v78, -v108
    v_mfma_f32_32x32x16_bf16 v[48:63], v[128:131], v[132:135], v[48:63]
    v_fma_f32 v97, v80, v81, v105
    v_cvt_pk_bf16_f32 v115, v98, v99
    v_cvt_pk_bf16_f32 v116, v82, -v83
    v_mul_f32_e64 v110, v85, v79
    v_fma_f32 v96, v80, v80, -v104
    ds_write_addtid_b32 v115 offset:816
    ds_write_addtid_b32 v116 offset:8704
    v_mul_f32_e64 v111, v85, v78
    v_cvt_pk_bf16_f32 v112, v96, v97
    v_mul_f32 v106, v99, v81
    v_mul_f32 v108, v83, v71
    v_fma_f32 v87, v84, v79, v111
    v_mfma_f32_32x32x16_bf16 v[48:63], v[136:139], v[140:143], v[48:63]
    ds_write_addtid_b32 v112 offset:1088
    v_mul_f32 v107, v99, v80
    v_mul_f32 v109, v83, v70
    v_fma_f32 v86, v84, v78, -v110
    v_mul_f32_e64 v104, v97, v81
    v_fma_f32 v103, v98, v81, v107
    v_fma_f32 v89, v82, v71, v109
    v_cvt_pk_bf16_f32 v119, v86, -v87
    v_mul_f32_e64 v105, v97, v80
    v_fma_f32 v102, v98, v80, -v106
    v_fma_f32 v88, v82, v70, -v108
    ds_write_addtid_b32 v119 offset:14144
    v_mfma_f32_32x32x16_bf16 v[48:63], v[144:147], v[148:151], v[48:63]
    v_fma_f32 v101, v96, v81, v105
    v_cvt_pk_bf16_f32 v114, v102, v103
    v_cvt_pk_bf16_f32 v117, v88, -v89
    v_mul_f32_e64 v110, v87, v75
    v_fma_f32 v100, v96, v80, -v104
    ds_write_addtid_b32 v114 offset:1360
    ds_write_addtid_b32 v117 offset:8976
    v_mul_f32_e64 v111, v87, v74
    v_cvt_pk_bf16_f32 v113, v100, v101
    v_mul_f32 v106, v103, v81
    v_mul_f32 v108, v89, v71
    v_fma_f32 v93, v86, v75, v111
    v_mfma_f32_32x32x16_bf16 v[48:63], v[152:155], v[156:159], v[48:63]
    ds_write_addtid_b32 v113 offset:1632
    v_mul_f32 v107, v103, v80
    v_mul_f32 v109, v89, v70
    v_fma_f32 v92, v86, v74, -v110
    v_mul_f32_e64 v104, v101, v81
    v_fma_f32 v99, v102, v81, v107
    v_fma_f32 v91, v88, v71, v109
    v_cvt_pk_bf16_f32 v118, v92, -v93
    v_mul_f32_e64 v105, v101, v80
    v_fma_f32 v98, v102, v80, -v106
    v_fma_f32 v90, v88, v70, -v108
    ds_write_addtid_b32 v118 offset:14416
    v_mfma_f32_32x32x16_bf16 v[48:63], v[160:163], v[164:167], v[48:63]
    v_fma_f32 v97, v100, v81, v105
    v_cvt_pk_bf16_f32 v115, v98, v99
    v_cvt_pk_bf16_f32 v116, v90, -v91
    v_mul_f32_e64 v110, v93, v75
    v_fma_f32 v96, v100, v80, -v104
    ds_write_addtid_b32 v115 offset:1904
    ds_write_addtid_b32 v116 offset:9248
    v_mul_f32_e64 v111, v93, v74
    v_cvt_pk_bf16_f32 v112, v96, v97
    v_mul_f32 v106, v99, v81
    v_mul_f32 v108, v91, v71
    v_fma_f32 v95, v92, v75, v111
    v_mfma_f32_32x32x16_bf16 v[48:63], v[168:171], v[172:175], v[48:63]
    ds_write_addtid_b32 v112 offset:2176
    v_mul_f32 v107, v99, v80
    v_mul_f32 v109, v91, v70
    v_fma_f32 v94, v92, v74, -v110
    v_mul_f32_e64 v104, v97, v81
    v_fma_f32 v103, v98, v81, v107
    v_fma_f32 v89, v90, v71, v109
    v_cvt_pk_bf16_f32 v119, v94, -v95
    v_mul_f32_e64 v105, v97, v80
    v_fma_f32 v102, v98, v80, -v106
    v_fma_f32 v88, v90, v70, -v108
    ds_write_addtid_b32 v119 offset:14688
    v_mfma_f32_32x32x16_bf16 v[48:63], v[176:179], v[180:183], v[48:63]
    v_fma_f32 v101, v96, v81, v105
    v_cvt_pk_bf16_f32 v114, v102, v103
    v_cvt_pk_bf16_f32 v117, v88, -v89
    v_mul_f32_e64 v110, v87, v79
    v_fma_f32 v100, v96, v80, -v104
    ds_write_addtid_b32 v114 offset:2448
    ds_write_addtid_b32 v117 offset:9520
    v_mul_f32_e64 v111, v87, v78
    v_cvt_pk_bf16_f32 v113, v100, v101
    v_mul_f32 v106, v103, v81
    v_mul_f32 v108, v89, v71
    v_fma_f32 v87, v86, v79, v111
    ds_write_addtid_b32 v113 offset:2720
    v_mul_f32 v107, v103, v80
    v_mul_f32 v109, v89, v70
    v_fma_f32 v86, v86, v78, -v110
    v_mul_f32_e64 v104, v101, v81
    v_fma_f32 v99, v102, v81, v107
    v_fma_f32 v91, v88, v71, v109
    v_cvt_pk_bf16_f32 v118, v86, -v87
    v_mul_f32_e64 v105, v101, v80
    v_fma_f32 v98, v102, v80, -v106
    v_fma_f32 v90, v88, v70, -v108
    ds_write_addtid_b32 v118 offset:10336
    v_fma_f32 v97, v100, v81, v105
    v_cvt_pk_bf16_f32 v115, v98, v99
    v_cvt_pk_bf16_f32 v116, v90, -v91
    v_mul_f32_e64 v110, v87, v75
    v_fma_f32 v96, v100, v80, -v104
    ds_write_addtid_b32 v115 offset:2992
    ds_write_addtid_b32 v116 offset:13056
    v_mul_f32_e64 v111, v87, v74
    v_cvt_pk_bf16_f32 v112, v96, v97
    v_mul_f32 v106, v99, v81
    v_mul_f32 v108, v91, v71
    v_fma_f32 v93, v86, v75, v111
    ds_write_addtid_b32 v112 offset:3264
    v_mul_f32 v107, v99, v80
    v_mul_f32 v109, v91, v70
    v_fma_f32 v92, v86, v74, -v110
    v_mul_f32_e64 v104, v97, v81
    v_fma_f32 v103, v98, v81, v107
    v_fma_f32 v89, v90, v71, v109
    v_cvt_pk_bf16_f32 v119, v92, -v93
    v_mul_f32_e64 v105, v97, v80
    v_fma_f32 v102, v98, v80, -v106
    v_fma_f32 v88, v90, v70, -v108
    ds_write_addtid_b32 v119 offset:10608
    v_fma_f32 v101, v96, v81, v105
    v_cvt_pk_bf16_f32 v114, v102, v103
    v_cvt_pk_bf16_f32 v117, v88, -v89
    v_mul_f32_e64 v110, v93, v75
    v_fma_f32 v100, v96, v80, -v104
    ds_write_addtid_b32 v114 offset:3536
    ds_write_addtid_b32 v117 offset:13328
    v_mul_f32_e64 v111, v93, v74
    v_cvt_pk_bf16_f32 v113, v100, v101
    v_mul_f32 v106, v103, v81
    v_mul_f32 v108, v89, v71
    v_fma_f32 v95, v92, v75, v111
    ds_write_addtid_b32 v113 offset:3808
    v_mul_f32 v107, v103, v80
    v_mul_f32 v109, v89, v70
    v_fma_f32 v94, v92, v74, -v110
    v_mul_f32_e64 v104, v101, v81
    v_fma_f32 v99, v102, v81, v107
    v_fma_f32 v91, v88, v71, v109
    v_cvt_pk_bf16_f32 v118, v94, -v95
    v_mul_f32_e64 v105, v101, v80
    v_fma_f32 v98, v102, v80, -v106
    v_fma_f32 v90, v88, v70, -v108
    ds_write_addtid_b32 v118 offset:10880
    v_fma_f32 v97, v100, v81, v105
    v_cvt_pk_bf16_f32 v115, v98, v99
    v_cvt_pk_bf16_f32 v116, v90, -v91
    v_mul_f32_e64 v110, v87, v79
    v_fma_f32 v96, v100, v80, -v104
    ds_write_addtid_b32 v115 offset:4080
    ds_write_addtid_b32 v116 offset:13600
    v_mul_f32_e64 v111, v87, v78
    v_cvt_pk_bf16_f32 v112, v96, v97
    v_mul_f32 v106, v99, v81
    v_mul_f32 v108, v91, v71
    v_fma_f32 v87, v86, v79, v111
    ds_write_addtid_b32 v112 offset:4352
    v_mul_f32 v107, v99, v80
    v_mul_f32 v109, v91, v70
    v_fma_f32 v86, v86, v78, -v110
    v_mul_f32_e64 v104, v97, v81
    v_fma_f32 v103, v98, v81, v107
    v_fma_f32 v89, v90, v71, v109
    v_cvt_pk_bf16_f32 v119, v86, -v87
    v_mul_f32_e64 v105, v97, v80
    v_fma_f32 v102, v98, v80, -v106
    v_fma_f32 v88, v90, v70, -v108
    ds_write_addtid_b32 v119 offset:14960
    v_fma_f32 v101, v96, v81, v105
    v_cvt_pk_bf16_f32 v114, v102, v103
    v_cvt_pk_bf16_f32 v117, v88, -v89
    v_mul_f32_e64 v110, v87, v77
    v_fma_f32 v100, v96, v80, -v104
    ds_write_addtid_b32 v114 offset:4624
    ds_write_addtid_b32 v117 offset:13872
    v_mul_f32_e64 v111, v87, v76
    v_cvt_pk_bf16_f32 v113, v100, v101
    v_mul_f32_e64 v106, v103, v81
    v_cvt_pk_bf16_f32 v116, v84, -v85
    v_fma_f32 v93, v86, v77, v111
    ds_write_addtid_b32 v113 offset:4896
    v_mul_f32_e64 v107, v103, v80
    ds_write_addtid_b32 v116 offset:12240
    v_fma_f32 v92, v86, v76, -v110
    v_mul_f32_e64 v104, v101, v81
    v_fma_f32 v99, v102, v81, v107
    v_mul_f32_e64 v108, v85, v73
    v_cvt_pk_bf16_f32 v118, v92, -v93
    v_mul_f32_e64 v105, v101, v80
    v_fma_f32 v98, v102, v80, -v106
    v_mul_f32_e64 v109, v85, v72
    ds_write_addtid_b32 v118 offset:11424
    v_fma_f32 v97, v100, v81, v105
    v_cvt_pk_bf16_f32 v115, v98, v99
    v_fma_f32 v89, v84, v73, v109
    v_mul_f32_e64 v110, v87, v79
    v_fma_f32 v96, v100, v80, -v104
    ds_write_addtid_b32 v115 offset:5168
    v_fma_f32 v88, v84, v72, -v108
    v_mul_f32_e64 v111, v87, v78
    v_cvt_pk_bf16_f32 v112, v96, v97
    v_mul_f32_e64 v106, v99, v81
    v_cvt_pk_bf16_f32 v117, v88, -v89
    v_fma_f32 v87, v86, v79, v111
    ds_write_addtid_b32 v112 offset:5440
    v_mul_f32_e64 v107, v99, v80
    ds_write_addtid_b32 v117 offset:12512
    v_fma_f32 v86, v86, v78, -v110
    v_mul_f32_e64 v104, v97, v81
    v_fma_f32 v103, v98, v81, v107
    v_mul_f32_e64 v108, v89, v73
    v_cvt_pk_bf16_f32 v119, v86, -v87
    v_mul_f32_e64 v105, v97, v80
    v_fma_f32 v102, v98, v80, -v106
    v_mul_f32_e64 v109, v89, v72
    ds_write_addtid_b32 v119 offset:11696
    v_fma_f32 v101, v96, v81, v105
    v_cvt_pk_bf16_f32 v114, v102, v103
    v_fma_f32 v91, v88, v73, v109
    v_mul_f32_e64 v110, v87, v77
    v_fma_f32 v100, v96, v80, -v104
    ds_write_addtid_b32 v114 offset:5712
    v_fma_f32 v90, v88, v72, -v108
    v_mul_f32_e64 v111, v87, v76
    v_cvt_pk_bf16_f32 v113, v100, v101
    v_mul_f32_e64 v106, v103, v81
    v_cvt_pk_bf16_f32 v116, v90, -v91
    v_fma_f32 v93, v86, v77, v111
    ds_write_addtid_b32 v113 offset:5984
    v_mul_f32_e64 v107, v103, v80
    ds_write_addtid_b32 v116 offset:12784
    v_fma_f32 v92, v86, v76, -v110
    v_mul_f32_e64 v104, v101, v81
    v_fma_f32 v99, v102, v81, v107
    v_mul_f32_e64 v108, v91, v73
    v_cvt_pk_bf16_f32 v118, v92, -v93
    v_mul_f32_e64 v105, v101, v80
    v_fma_f32 v98, v102, v80, -v106
    v_mul_f32_e64 v109, v91, v72
    ds_write_addtid_b32 v118 offset:11968
    v_fma_f32 v97, v100, v81, v105
    v_cvt_pk_bf16_f32 v115, v98, v99
    v_fma_f32 v89, v90, v73, v109
    v_mul_f32_e64 v110, v87, v79
    v_fma_f32 v96, v100, v80, -v104
    ds_write_addtid_b32 v115 offset:6256
    v_fma_f32 v88, v90, v72, -v108
    v_mul_f32_e64 v111, v87, v78
    v_cvt_pk_bf16_f32 v112, v96, v97
    v_mul_f32_e64 v106, v99, v81
    v_cvt_pk_bf16_f32 v117, v88, -v89
    v_fma_f32 v87, v86, v79, v111
    ds_write_addtid_b32 v112 offset:6528
    v_mul_f32_e64 v107, v99, v80
    ds_write_addtid_b32 v117 offset:9792
    v_fma_f32 v86, v86, v78, -v110
    v_mul_f32_e64 v104, v97, v81
    v_fma_f32 v103, v98, v81, v107
    v_mul_f32_e64 v108, v89, v73
    v_cvt_pk_bf16_f32 v119, v86, -v87
    v_mul_f32_e64 v105, v97, v80
    v_fma_f32 v102, v98, v80, -v106
    v_mul_f32_e64 v109, v89, v72
    ds_write_addtid_b32 v119 offset:11152
    v_fma_f32 v101, v96, v81, v105
    v_cvt_pk_bf16_f32 v114, v102, v103
    v_fma_f32 v91, v88, v73, v109
    v_mul_f32_e64 v110, v87, v77
    v_fma_f32 v100, v96, v80, -v104
    ds_write_addtid_b32 v114 offset:6800
    v_fma_f32 v90, v88, v72, -v108
    v_mul_f32_e64 v111, v87, v76
    v_cvt_pk_bf16_f32 v113, v100, v101
    v_mul_f32_e64 v106, v103, v81
    v_cvt_pk_bf16_f32 v116, v90, -v91
    v_fma_f32 v93, v86, v77, v111
    ds_write_addtid_b32 v113 offset:7072
    v_mul_f32_e64 v107, v103, v80
    ds_write_addtid_b32 v116 offset:10064
    v_fma_f32 v92, v86, v76, -v110
    v_mul_f32_e64 v104, v101, v81
    v_fma_f32 v99, v102, v81, v107
    v_cvt_pk_bf16_f32 v118, v92, -v93
    v_mul_f32_e64 v105, v101, v80
    v_fma_f32 v98, v102, v80, -v106
    ds_write_addtid_b32 v118 offset:15232
    v_fma_f32 v97, v100, v81, v105
    v_cvt_pk_bf16_f32 v115, v98, v99
    v_mul_f32_e64 v110, v87, v79
    v_fma_f32 v96, v100, v80, -v104
    ds_write_addtid_b32 v115 offset:7344
    v_mul_f32_e64 v111, v87, v78
    v_cvt_pk_bf16_f32 v112, v96, v97
    v_mul_f32_e64 v106, v99, v81
    v_fma_f32 v87, v86, v79, v111
    ds_write_addtid_b32 v112 offset:7616
    v_mul_f32_e64 v107, v99, v80
    v_fma_f32 v86, v86, v78, -v110
    v_mul_f32_e64 v104, v97, v81
    v_fma_f32 v103, v98, v81, v107
    v_cvt_pk_bf16_f32 v119, v86, -v87
    v_mul_f32_e64 v105, v97, v80
    v_fma_f32 v102, v98, v80, -v106
    ds_write_addtid_b32 v119 offset:15504
    v_fma_f32 v101, v96, v81, v105
    v_cvt_pk_bf16_f32 v114, v102, v103
    v_mul_f32_e64 v110, v87, v77
    v_fma_f32 v100, v96, v80, -v104
    ds_write_addtid_b32 v114 offset:7888
    v_mul_f32_e64 v111, v87, v76
    v_cvt_pk_bf16_f32 v113, v100, v101
    v_mul_f32_e64 v106, v103, v81
    v_fma_f32 v93, v86, v77, v111
    ds_write_addtid_b32 v113 offset:8160
    v_mul_f32_e64 v107, v103, v80
    v_fma_f32 v92, v86, v76, -v110
    v_fma_f32 v99, v102, v81, v107
    v_cvt_pk_bf16_f32 v118, v92, -v93
    v_fma_f32 v98, v102, v80, -v106
    ds_write_addtid_b32 v118 offset:15776
    v_cvt_pk_bf16_f32 v115, v98, v99
    ds_write_addtid_b32 v115 offset:8432
    s_waitcnt lgkmcnt(0)
    s_nop 0
    ds_read_b128 v[120:123], v20 offset:0
    ds_read_b128 v[124:127], v21 offset:0
    ds_read_b128 v[128:131], v20 offset:32
    ds_read_b128 v[132:135], v21 offset:32
    ds_read_b128 v[136:139], v20 offset:64
    ds_read_b128 v[140:143], v21 offset:64
    ds_read_b128 v[144:147], v20 offset:96
    ds_read_b128 v[148:151], v21 offset:96
    ds_read_b128 v[152:155], v20 offset:128
    ds_read_b128 v[156:159], v21 offset:128
    ds_read_b128 v[160:163], v20 offset:160
    ds_read_b128 v[164:167], v21 offset:160
    ds_read_b128 v[168:171], v20 offset:192
    ds_read_b128 v[172:175], v21 offset:192
    ds_read_b128 v[176:179], v20 offset:224
    ds_read_b128 v[180:183], v21 offset:224
    s_waitcnt lgkmcnt(0)
    s_nop 0
    v_mfma_f32_32x32x16_bf16 v[48:63], v[120:123], v[124:127], v[48:63]
    v_mfma_f32_32x32x16_bf16 v[48:63], v[128:131], v[132:135], v[48:63]
    v_mfma_f32_32x32x16_bf16 v[48:63], v[136:139], v[140:143], v[48:63]
    v_mfma_f32_32x32x16_bf16 v[48:63], v[144:147], v[148:151], v[48:63]
    v_mfma_f32_32x32x16_bf16 v[48:63], v[152:155], v[156:159], v[48:63]
    v_mfma_f32_32x32x16_bf16 v[48:63], v[160:163], v[164:167], v[48:63]
    v_mfma_f32_32x32x16_bf16 v[48:63], v[168:171], v[172:175], v[48:63]
    v_mfma_f32_32x32x16_bf16 v[48:63], v[176:179], v[180:183], v[48:63]
    buffer_load_dwordx2 v[2:3], off, s[32:35], 0 sc1
    v_and_b32 v1, 1, v0
    v_cmp_eq_u32 vcc, 1, v1
    s_mov_b64 exec, 1
    s_nop 7
    v_add_f32 v48, s95, v48
    s_mov_b64 exec, -1
    v_cvt_pk_bf16_f32 v120, v55, v54
    v_cvt_pk_bf16_f32 v121, v53, v52
    v_cvt_pk_bf16_f32 v122, v51, v50
    v_cvt_pk_bf16_f32 v123, v49, v48
    ds_write_b128 v22, v[120:123] offset:1024
    v_cvt_pk_bf16_f32 v124, v58, v58
    v_cvt_pk_bf16_f32 v125, v57, v57
    v_cvt_pk_bf16_f32 v126, v57, v56
    v_cvt_pk_bf16_f32 v127, v56, v56
    ds_write_b128 v22, v[124:127]
    v_cndmask_b32_e64 v1, v59, v60, vcc
    v_cvt_pk_bf16_f32 v128, v60, v60
    v_cvt_pk_bf16_f32 v130, v59, v59
    v_cvt_pk_bf16_f32 v131, v59, v59
    v_cvt_pk_bf16_f32 v129, v60, v1
    ds_write_b128 v23, v[128:131] offset:512
    v_cndmask_b32_e64 v1, v61, v62, vcc
    v_cvt_pk_bf16_f32 v132, v62, v62
    v_cvt_pk_bf16_f32 v134, v61, v61
    v_cvt_pk_bf16_f32 v135, v61, v61
    v_cvt_pk_bf16_f32 v133, v62, v1
    ds_write_b128 v23, v[132:135] offset:0
    s_waitcnt lgkmcnt(0)
    s_nop 0
    ds_read_b128 v[48:51], v28 offset:0
    ds_read_b64 v[52:53], v28 offset:16
    ds_read_b128 v[54:57], v28 offset:1024
    ds_read_b64 v[58:59], v28 offset:1040
    ds_read_b128 v[60:63], v28 offset:2048
    ds_read_b64 v[64:65], v28 offset:2064
    ds_read_b128 v[66:69], v28 offset:3072
    ds_read_b64 v[70:71], v28 offset:3088
    s_waitcnt lgkmcnt(6)
    s_nop 0
    ds_write_b128 v24, v[48:51] offset:0
    v_alignbit_b32 v120, v49, v48, 16
    v_alignbit_b32 v121, v50, v49, 16
    v_alignbit_b32 v122, v51, v50, 16
    v_alignbit_b32 v123, v52, v51, 16
    ds_write_b128 v25, v[120:123] offset:0
    v_mov_b32 v124, v49
    v_mov_b32 v125, v50
    v_mov_b32 v126, v51
    v_mov_b32 v127, v52
    ds_write_b128 v26, v[124:127] offset:0
    v_alignbit_b32 v128, v50, v49, 16
    v_alignbit_b32 v129, v51, v50, 16
    v_alignbit_b32 v130, v52, v51, 16
    v_alignbit_b32 v131, v53, v52, 16
    ds_write_b128 v27, v[128:131] offset:0
    s_waitcnt lgkmcnt(8)
    s_nop 0
    ds_write_b128 v24, v[54:57] offset:4096
    v_alignbit_b32 v132, v55, v54, 16
    v_alignbit_b32 v133, v56, v55, 16
    v_alignbit_b32 v134, v57, v56, 16
    v_alignbit_b32 v135, v58, v57, 16
    ds_write_b128 v25, v[132:135] offset:4096
    v_mov_b32 v136, v55
    v_mov_b32 v137, v56
    v_mov_b32 v138, v57
    v_mov_b32 v139, v58
    ds_write_b128 v26, v[136:139] offset:4096
    v_alignbit_b32 v140, v56, v55, 16
    v_alignbit_b32 v141, v57, v56, 16
    v_alignbit_b32 v142, v58, v57, 16
    v_alignbit_b32 v143, v59, v58, 16
    ds_write_b128 v27, v[140:143] offset:4096
    s_waitcnt lgkmcnt(10)
    s_waitcnt lgkmcnt(4)
    ds_write_b128 v24, v[60:63] offset:8192
    v_alignbit_b32 v120, v61, v60, 16
    v_alignbit_b32 v121, v62, v61, 16
    v_alignbit_b32 v122, v63, v62, 16
    v_alignbit_b32 v123, v64, v63, 16
    ds_write_b128 v25, v[120:123] offset:8192
    v_mov_b32 v124, v61
    v_mov_b32 v125, v62
    v_mov_b32 v126, v63
    v_mov_b32 v127, v64
    ds_write_b128 v26, v[124:127] offset:8192
    v_alignbit_b32 v128, v62, v61, 16
    v_alignbit_b32 v129, v63, v62, 16
    v_alignbit_b32 v130, v64, v63, 16
    v_alignbit_b32 v131, v65, v64, 16
    ds_write_b128 v27, v[128:131] offset:8192
    s_waitcnt lgkmcnt(4)
    s_nop 0
    ds_write_b128 v24, v[66:69] offset:12288
    v_alignbit_b32 v132, v67, v66, 16
    v_alignbit_b32 v133, v68, v67, 16
    v_alignbit_b32 v134, v69, v68, 16
    v_alignbit_b32 v135, v70, v69, 16
    ds_write_b128 v25, v[132:135] offset:12288
    v_mov_b32 v136, v67
    v_mov_b32 v137, v68
    v_mov_b32 v138, v69
    v_mov_b32 v139, v70
    ds_write_b128 v26, v[136:139] offset:12288
    v_alignbit_b32 v140, v68, v67, 16
    v_alignbit_b32 v141, v69, v68, 16
    v_alignbit_b32 v142, v70, v69, 16
    v_alignbit_b32 v143, v71, v70, 16
    ds_write_b128 v27, v[140:143] offset:12288
    s_waitcnt vmcnt(0) lgkmcnt(0)
    s_mov_b32 s56, 0
L_nv_48:
    v_readfirstlane_b32 s48, v3
    v_readfirstlane_b32 s45, v2
    s_add_u32 s56, s56, 1
    s_cmp_lg_u32 s48, 0
    s_cbranch_scc1 L_nvok_49
    s_sleep 2
    buffer_load_dwordx2 v[2:3], off, s[32:35], 0 sc1
    s_waitcnt vmcnt(0)
    s_cmp_lt_u32 s56, 100000
    s_cbranch_scc1 L_nv_48
L_nvok_49:
    s_cmp_lg_u32 s36, 0
    s_cbranch_scc1 L_np_50
    s_mov_b64 s[58:59], exec
    s_mov_b32 exec_lo, 0x3fffff
    s_mov_b32 exec_hi, 0
    s_mov_b32 s56, 0
L_poll_51:
    buffer_load_dword v4, v46, s[24:27], 0 offen sc1
    s_waitcnt vmcnt(0)
    v_cmp_ne_u32_e64 vcc, s45, v4
    s_add_u32 s56, s56, 1
    s_nop 2
    s_cbranch_vccz L_polled_52
    s_sleep 4
    s_cmp_lt_u32 s56, 100000
    s_cbranch_scc1 L_poll_51
L_polled_52:
    s_mov_b64 exec, s[58:59]
L_np_50:
    s_barrier
    s_add_u32 m0, s64, 65536
    s_nop 0
    buffer_load_dwordx4 v44, s[24:27], s65 offen offset:0 sc1 lds
    s_add_u32 s65, s65, 162816
    buffer_load_dwordx4 v45, s[24:27], s65 offen offset:1024 sc1 lds
    s_add_u32 s65, s65, 162816
    buffer_load_dwordx4 v44, s[24:27], s65 offen offset:2048 sc1 lds
    s_add_u32 s65, s65, 162816
    buffer_load_dwordx4 v45, s[24:27], s65 offen offset:3072 sc1 lds
    ds_read_b64 v[80:81], v29 offset:15872
    ds_read_b64 v[82:83], v30 offset:15872
    ds_read_b64 v[84:85], v29 offset:13824
    ds_read_b64 v[86:87], v30 offset:13824
    ds_read_b64 v[88:89], v29 offset:11776
    ds_read_b64 v[90:91], v30 offset:11776
    ds_read_b64 v[92:93], v29 offset:9728
    ds_read_b64 v[94:95], v30 offset:9728
    ds_read_b64 v[96:97], v29 offset:7680
    ds_read_b64 v[98:99], v30 offset:7680
    ds_read_b64 v[100:101], v29 offset:5632
    ds_read_b64 v[102:103], v30 offset:5632
    ds_read_b64 v[104:105], v29 offset:3584
    ds_read_b64 v[106:107], v30 offset:3584
    ds_read_b64 v[108:109], v29 offset:1536
    ds_read_b64 v[110:111], v30 offset:1536
    v_subrev_u32_e64 v1, 0, v35
    v_bfe_u32 v4, v1, 1, 3
    v_xor_b32 v4, v4, v40
    v_lshlrev_b32 v4, 4, v4
    v_lshl_add_u32 v4, v1, 7, v4
    v_add_u32 v33, 65536, v4
    v_subrev_u32 v5, 2048, v33
    s_waitcnt vmcnt(0)
    s_barrier
    ds_read_b128 v[8:11], v5
    ds_read_b128 v[148:151], v33 offset:0
    ds_read_b128 v[152:155], v33 offset:2048
    ds_read_b128 v[156:159], v33 offset:4096
    ds_read_b128 v[160:163], v33 offset:6144
    ds_read_b128 v[164:167], v33 offset:8192
    ds_read_b128 v[168:171], v33 offset:10240
    ds_read_b128 v[172:175], v33 offset:12288
    s_waitcnt lgkmcnt(7)
    s_mov_b64 exec, 0x10001
    v_mov_b32 v8, 0
    v_mov_b32 v9, 0
    v_mov_b32 v10, 0
    v_mov_b32 v11, 0
    s_mov_b64 exec, -1
    v_and_b32 v80, v80, v36
    v_and_b32 v81, v81, v37
    v_and_b32 v82, v82, v38
    v_and_b32 v83, v83, v39
    v_mov_b32 v144, v8
    v_mov_b32 v145, v9
    v_mov_b32 v146, v10
    v_mov_b32 v147, v11
    s_waitcnt lgkmcnt(0)
    s_nop 0
    v_mfma_f32_16x16x32_bf16 v[48:51], v[80:83], v[144:147], 0
    ds_read_b64 v[112:113], v31 offset:15872
    v_subrev_u32_e64 v1, 2, v35
    v_mfma_f32_16x16x32_bf16 v[52:55], v[84:87], v[144:147], 0
    ds_read_b64 v[114:115], v32 offset:15872
    v_bfe_u32 v4, v1, 1, 3
    v_mfma_f32_16x16x32_bf16 v[56:59], v[88:91], v[144:147], 0
    ds_read_b64 v[116:117], v31 offset:13824
    v_xor_b32_e64 v4, v4, v40
    v_mfma_f32_16x16x32_bf16 v[60:63], v[92:95], v[144:147], 0
    ds_read_b64 v[118:119], v32 offset:13824
    v_lshlrev_b32_e64 v4, 4, v4
    v_mfma_f32_16x16x32_bf16 v[64:67], v[96:99], v[144:147], 0
    ds_read_b64 v[120:121], v31 offset:11776
    v_lshl_add_u32 v4, v1, 7, v4
    v_mfma_f32_16x16x32_bf16 v[68:71], v[100:103], v[144:147], 0
    ds_read_b64 v[122:123], v32 offset:11776
    v_add_u32 v34, 65536, v4
    v_mfma_f32_16x16x32_bf16 v[72:75], v[104:107], v[144:147], 0
    ds_read_b64 v[124:125], v31 offset:9728
    v_mfma_f32_16x16x32_bf16 v[76:79], v[108:111], v[144:147], 0
    ds_read_b64 v[126:127], v32 offset:9728
    v_mfma_f32_16x16x32_bf16 v[52:55], v[80:83], v[148:151], v[52:55]
    ds_read_b64 v[128:129], v31 offset:7680
    v_mov_b32_dpp v176, v8 row_shr:2 row_mask:0xf bank_mask:0xf bound_ctrl:1
    v_mfma_f32_16x16x32_bf16 v[56:59], v[84:87], v[148:151], v[56:59]
    ds_read_b64 v[130:131], v32 offset:7680
    v_mov_b32_dpp v177, v9 row_shr:2 row_mask:0xf bank_mask:0xf bound_ctrl:1
    v_mfma_f32_16x16x32_bf16 v[60:63], v[88:91], v[148:151], v[60:63]
    ds_read_b64 v[132:133], v31 offset:5632
    v_mov_b32_dpp v178, v10 row_shr:2 row_mask:0xf bank_mask:0xf bound_ctrl:1
    v_mfma_f32_16x16x32_bf16 v[64:67], v[92:95], v[148:151], v[64:67]
    ds_read_b64 v[134:135], v32 offset:5632
    v_mov_b32_dpp v179, v11 row_shr:2 row_mask:0xf bank_mask:0xf bound_ctrl:1
    v_mfma_f32_16x16x32_bf16 v[68:71], v[96:99], v[148:151], v[68:71]
    ds_read_b64 v[136:137], v31 offset:3584
    v_mfma_f32_16x16x32_bf16 v[72:75], v[100:103], v[148:151], v[72:75]
    ds_read_b64 v[138:139], v32 offset:3584
    v_mfma_f32_16x16x32_bf16 v[76:79], v[104:107], v[148:151], v[76:79]
    ds_read_b64 v[140:141], v31 offset:1536
    v_mfma_f32_16x16x32_bf16 v[56:59], v[80:83], v[152:155], v[56:59]
    ds_read_b64 v[142:143], v32 offset:1536
    v_mfma_f32_16x16x32_bf16 v[60:63], v[84:87], v[152:155], v[60:63]
    ds_read_b128 v[180:183], v34 offset:0
    v_mfma_f32_16x16x32_bf16 v[64:67], v[88:91], v[152:155], v[64:67]
    ds_read_b128 v[184:187], v34 offset:2048
    v_mfma_f32_16x16x32_bf16 v[68:71], v[92:95], v[152:155], v[68:71]
    ds_read_b128 v[188:191], v34 offset:4096
    v_mfma_f32_16x16x32_bf16 v[72:75], v[96:99], v[152:155], v[72:75]
    ds_read_b128 v[192:195], v34 offset:6144
    v_mfma_f32_16x16x32_bf16 v[76:79], v[100:103], v[152:155], v[76:79]
    ds_read_b128 v[196:199], v34 offset:8192
    v_mfma_f32_16x16x32_bf16 v[60:63], v[80:83], v[156:159], v[60:63]
    ds_read_b128 v[200:203], v34 offset:10240
    v_mfma_f32_16x16x32_bf16 v[64:67], v[84:87], v[156:159], v[64:67]
    ds_read_b128 v[204:207], v34 offset:12288
    v_mfma_f32_16x16x32_bf16 v[68:71], v[88:91], v[156:159], v[68:71]
    v_mfma_f32_16x16x32_bf16 v[72:75], v[92:95], v[156:159], v[72:75]
    v_mfma_f32_16x16x32_bf16 v[76:79], v[96:99], v[156:159], v[76:79]
    v_mfma_f32_16x16x32_bf16 v[64:67], v[80:83], v[160:163], v[64:67]
    v_mfma_f32_16x16x32_bf16 v[68:71], v[84:87], v[160:163], v[68:71]
    v_mfma_f32_16x16x32_bf16 v[72:75], v[88:91], v[160:163], v[72:75]
    v_mfma_f32_16x16x32_bf16 v[76:79], v[92:95], v[160:163], v[76:79]
    v_mfma_f32_16x16x32_bf16 v[68:71], v[80:83], v[164:167], v[68:71]
    v_mfma_f32_16x16x32_bf16 v[72:75], v[84:87], v[164:167], v[72:75]
    v_mfma_f32_16x16x32_bf16 v[76:79], v[88:91], v[164:167], v[76:79]
    v_mfma_f32_16x16x32_bf16 v[72:75], v[80:83], v[168:171], v[72:75]
    v_mfma_f32_16x16x32_bf16 v[76:79], v[84:87], v[168:171], v[76:79]
    v_mfma_f32_16x16x32_bf16 v[76:79], v[80:83], v[172:175], v[76:79]
    s_waitcnt lgkmcnt(0)
    v_mfma_f32_16x16x32_bf16 v[48:51], v[112:115], v[176:179], v[48:51]
    ds_read_b64 v[80:81], v29 offset:15360
    v_subrev_u32 v1, 4, v35
    v_mfma_f32_16x16x32_bf16 v[52:55], v[116:119], v[176:179], v[52:55]
    ds_read_b64 v[82:83], v30 offset:15360
    v_bfe_u32 v4, v1, 1, 3
    v_mfma_f32_16x16x32_bf16 v[56:59], v[120:123], v[176:179], v[56:59]
    ds_read_b64 v[84:85], v29 offset:13312
    v_xor_b32_e64 v4, v4, v40
    v_mfma_f32_16x16x32_bf16 v[60:63], v[124:127], v[176:179], v[60:63]
    ds_read_b64 v[86:87], v30 offset:13312
    v_lshlrev_b32_e64 v4, 4, v4
    v_mfma_f32_16x16x32_bf16 v[64:67], v[128:131], v[176:179], v[64:67]
    ds_read_b64 v[88:89], v29 offset:11264
    v_lshl_add_u32 v4, v1, 7, v4
    v_mfma_f32_16x16x32_bf16 v[68:71], v[132:135], v[176:179], v[68:71]
    ds_read_b64 v[90:91], v30 offset:11264
    v_add_u32 v33, 65536, v4
    v_mfma_f32_16x16x32_bf16 v[72:75], v[136:139], v[176:179], v[72:75]
    ds_read_b64 v[92:93], v29 offset:9216
    v_mfma_f32_16x16x32_bf16 v[76:79], v[140:143], v[176:179], v[76:79]
    ds_read_b64 v[94:95], v30 offset:9216
    v_mfma_f32_16x16x32_bf16 v[52:55], v[112:115], v[180:183], v[52:55]
    ds_read_b64 v[96:97], v29 offset:7168
    v_mov_b32_dpp v144, v8 row_shr:4 row_mask:0xf bank_mask:0xf bound_ctrl:1
    v_mfma_f32_16x16x32_bf16 v[56:59], v[116:119], v[180:183], v[56:59]
    ds_read_b64 v[98:99], v30 offset:7168
    v_mov_b32_dpp v145, v9 row_shr:4 row_mask:0xf bank_mask:0xf bound_ctrl:1
    v_mfma_f32_16x16x32_bf16 v[60:63], v[120:123], v[180:183], v[60:63]
    ds_read_b64 v[100:101], v29 offset:5120
    v_mov_b32_dpp v146, v10 row_shr:4 row_mask:0xf bank_mask:0xf bound_ctrl:1
    v_mfma_f32_16x16x32_bf16 v[64:67], v[124:127], v[180:183], v[64:67]
    ds_read_b64 v[102:103], v30 offset:5120
    v_mov_b32_dpp v147, v11 row_shr:4 row_mask:0xf bank_mask:0xf bound_ctrl:1
    v_mfma_f32_16x16x32_bf16 v[68:71], v[128:131], v[180:183], v[68:71]
    ds_read_b64 v[104:105], v29 offset:3072
    v_mfma_f32_16x16x32_bf16 v[72:75], v[132:135], v[180:183], v[72:75]
    ds_read_b64 v[106:107], v30 offset:3072
    v_mfma_f32_16x16x32_bf16 v[76:79], v[136:139], v[180:183], v[76:79]
    ds_read_b64 v[108:109], v29 offset:1024
    v_mfma_f32_16x16x32_bf16 v[56:59], v[112:115], v[184:187], v[56:59]
    ds_read_b64 v[110:111], v30 offset:1024
    v_mfma_f32_16x16x32_bf16 v[60:63], v[116:119], v[184:187], v[60:63]
    ds_read_b128 v[148:151], v33 offset:0
    v_mfma_f32_16x16x32_bf16 v[64:67], v[120:123], v[184:187], v[64:67]
    ds_read_b128 v[152:155], v33 offset:2048
    v_mfma_f32_16x16x32_bf16 v[68:71], v[124:127], v[184:187], v[68:71]
    ds_read_b128 v[156:159], v33 offset:4096
    v_mfma_f32_16x16x32_bf16 v[72:75], v[128:131], v[184:187], v[72:75]
    ds_read_b128 v[160:163], v33 offset:6144
    v_mfma_f32_16x16x32_bf16 v[76:79], v[132:135], v[184:187], v[76:79]
    ds_read_b128 v[164:167], v33 offset:8192
    v_mfma_f32_16x16x32_bf16 v[60:63], v[112:115], v[188:191], v[60:63]
    ds_read_b128 v[168:171], v33 offset:10240
    v_mfma_f32_16x16x32_bf16 v[64:67], v[116:119], v[188:191], v[64:67]
    ds_read_b128 v[172:175], v33 offset:12288
    v_mfma_f32_16x16x32_bf16 v[68:71], v[120:123], v[188:191], v[68:71]
    v_mfma_f32_16x16x32_bf16 v[72:75], v[124:127], v[188:191], v[72:75]
    v_mfma_f32_16x16x32_bf16 v[76:79], v[128:131], v[188:191], v[76:79]
    v_mfma_f32_16x16x32_bf16 v[64:67], v[112:115], v[192:195], v[64:67]
    v_mfma_f32_16x16x32_bf16 v[68:71], v[116:119], v[192:195], v[68:71]
    v_mfma_f32_16x16x32_bf16 v[72:75], v[120:123], v[192:195], v[72:75]
    v_mfma_f32_16x16x32_bf16 v[76:79], v[124:127], v[192:195], v[76:79]
    v_mfma_f32_16x16x32_bf16 v[68:71], v[112:115], v[196:199], v[68:71]
    v_mfma_f32_16x16x32_bf16 v[72:75], v[116:119], v[196:199], v[72:75]
    v_mfma_f32_16x16x32_bf16 v[76:79], v[120:123], v[196:199], v[76:79]
    v_mfma_f32_16x16x32_bf16 v[72:75], v[112:115], v[200:203], v[72:75]
    v_mfma_f32_16x16x32_bf16 v[76:79], v[116:119], v[200:203], v[76:79]
    v_mfma_f32_16x16x32_bf16 v[76:79], v[112:115], v[204:207], v[76:79]
    s_waitcnt lgkmcnt(0)
    v_mfma_f32_16x16x32_bf16 v[48:51], v[80:83], v[144:147], v[48:51]
    ds_read_b64 v[112:113], v31 offset:15360
    v_subrev_u32 v1, 6, v35
    v_mfma_f32_16x16x32_bf16 v[52:55], v[84:87], v[144:147], v[52:55]
    ds_read_b64 v[114:115], v32 offset:15360
    v_bfe_u32 v4, v1, 1, 3
    v_mfma_f32_16x16x32_bf16 v[56:59], v[88:91], v[144:147], v[56:59]
    ds_read_b64 v[116:117], v31 offset:13312
    v_xor_b32_e64 v4, v4, v40
    v_mfma_f32_16x16x32_bf16 v[60:63], v[92:95], v[144:147], v[60:63]
    ds_read_b64 v[118:119], v32 offset:13312
    v_lshlrev_b32_e64 v4, 4, v4
    v_mfma_f32_16x16x32_bf16 v[64:67], v[96:99], v[144:147], v[64:67]
    ds_read_b64 v[120:121], v31 offset:11264
    v_lshl_add_u32 v4, v1, 7, v4
    v_mfma_f32_16x16x32_bf16 v[68:71], v[100:103], v[144:147], v[68:71]
    ds_read_b64 v[122:123], v32 offset:11264
    v_add_u32 v34, 65536, v4
    v_mfma_f32_16x16x32_bf16 v[72:75], v[104:107], v[144:147], v[72:75]
    ds_read_b64 v[124:125], v31 offset:9216
    v_mfma_f32_16x16x32_bf16 v[76:79], v[108:111], v[144:147], v[76:79]
    ds_read_b64 v[126:127], v32 offset:9216
    v_mfma_f32_16x16x32_bf16 v[52:55], v[80:83], v[148:151], v[52:55]
    ds_read_b64 v[128:129], v31 offset:7168
    v_mov_b32_dpp v176, v8 row_shr:6 row_mask:0xf bank_mask:0xf bound_ctrl:1
    v_mfma_f32_16x16x32_bf16 v[56:59], v[84:87], v[148:151], v[56:59]
    ds_read_b64 v[130:131], v32 offset:7168
    v_mov_b32_dpp v177, v9 row_shr:6 row_mask:0xf bank_mask:0xf bound_ctrl:1
    v_mfma_f32_16x16x32_bf16 v[60:63], v[88:91], v[148:151], v[60:63]
    ds_read_b64 v[132:133], v31 offset:5120
    v_mov_b32_dpp v178, v10 row_shr:6 row_mask:0xf bank_mask:0xf bound_ctrl:1
    v_mfma_f32_16x16x32_bf16 v[64:67], v[92:95], v[148:151], v[64:67]
    ds_read_b64 v[134:135], v32 offset:5120
    v_mov_b32_dpp v179, v11 row_shr:6 row_mask:0xf bank_mask:0xf bound_ctrl:1
    v_mfma_f32_16x16x32_bf16 v[68:71], v[96:99], v[148:151], v[68:71]
    ds_read_b64 v[136:137], v31 offset:3072
    v_mfma_f32_16x16x32_bf16 v[72:75], v[100:103], v[148:151], v[72:75]
    ds_read_b64 v[138:139], v32 offset:3072
    v_mfma_f32_16x16x32_bf16 v[76:79], v[104:107], v[148:151], v[76:79]
    ds_read_b64 v[140:141], v31 offset:1024
    v_mfma_f32_16x16x32_bf16 v[56:59], v[80:83], v[152:155], v[56:59]
    ds_read_b64 v[142:143], v32 offset:1024
    v_mfma_f32_16x16x32_bf16 v[60:63], v[84:87], v[152:155], v[60:63]
    ds_read_b128 v[180:183], v34 offset:0
    v_mfma_f32_16x16x32_bf16 v[64:67], v[88:91], v[152:155], v[64:67]
    ds_read_b128 v[184:187], v34 offset:2048
    v_mfma_f32_16x16x32_bf16 v[68:71], v[92:95], v[152:155], v[68:71]
    ds_read_b128 v[188:191], v34 offset:4096
    v_mfma_f32_16x16x32_bf16 v[72:75], v[96:99], v[152:155], v[72:75]
    ds_read_b128 v[192:195], v34 offset:6144
    v_mfma_f32_16x16x32_bf16 v[76:79], v[100:103], v[152:155], v[76:79]
    ds_read_b128 v[196:199], v34 offset:8192
    v_mfma_f32_16x16x32_bf16 v[60:63], v[80:83], v[156:159], v[60:63]
    ds_read_b128 v[200:203], v34 offset:10240
    v_mfma_f32_16x16x32_bf16 v[64:67], v[84:87], v[156:159], v[64:67]
    ds_read_b128 v[204:207], v34 offset:12288
    v_mfma_f32_16x16x32_bf16 v[68:71], v[88:91], v[156:159], v[68:71]
    v_mfma_f32_16x16x32_bf16 v[72:75], v[92:95], v[156:159], v[72:75]
    v_mfma_f32_16x16x32_bf16 v[76:79], v[96:99], v[156:159], v[76:79]
    v_mfma_f32_16x16x32_bf16 v[64:67], v[80:83], v[160:163], v[64:67]
    v_mfma_f32_16x16x32_bf16 v[68:71], v[84:87], v[160:163], v[68:71]
    v_mfma_f32_16x16x32_bf16 v[72:75], v[88:91], v[160:163], v[72:75]
    v_mfma_f32_16x16x32_bf16 v[76:79], v[92:95], v[160:163], v[76:79]
    v_mfma_f32_16x16x32_bf16 v[68:71], v[80:83], v[164:167], v[68:71]
    v_mfma_f32_16x16x32_bf16 v[72:75], v[84:87], v[164:167], v[72:75]
    v_mfma_f32_16x16x32_bf16 v[76:79], v[88:91], v[164:167], v[76:79]
    v_mfma_f32_16x16x32_bf16 v[72:75], v[80:83], v[168:171], v[72:75]
    v_mfma_f32_16x16x32_bf16 v[76:79], v[84:87], v[168:171], v[76:79]
    v_mfma_f32_16x16x32_bf16 v[76:79], v[80:83], v[172:175], v[76:79]
    s_waitcnt lgkmcnt(0)
    v_mfma_f32_16x16x32_bf16 v[48:51], v[112:115], v[176:179], v[48:51]
    ds_read_b64 v[80:81], v29 offset:14848
    v_subrev_u32 v1, 8, v35
    v_mfma_f32_16x16x32_bf16 v[52:55], v[116:119], v[176:179], v[52:55]
    ds_read_b64 v[82:83], v30 offset:14848
    v_bfe_u32 v4, v1, 1, 3
    v_mfma_f32_16x16x32_bf16 v[56:59], v[120:123], v[176:179], v[56:59]
    ds_read_b64 v[84:85], v29 offset:12800
    v_xor_b32_e64 v4, v4, v40
    v_mfma_f32_16x16x32_bf16 v[60:63], v[124:127], v[176:179], v[60:63]
    ds_read_b64 v[86:87], v30 offset:12800
    v_lshlrev_b32_e64 v4, 4, v4
    v_mfma_f32_16x16x32_bf16 v[64:67], v[128:131], v[176:179], v[64:67]
    ds_read_b64 v[88:89], v29 offset:10752
    v_lshl_add_u32 v4, v1, 7, v4
    v_mfma_f32_16x16x32_bf16 v[68:71], v[132:135], v[176:179], v[68:71]
    ds_read_b64 v[90:91], v30 offset:10752
    v_add_u32 v33, 65536, v4
    v_mfma_f32_16x16x32_bf16 v[72:75], v[136:139], v[176:179], v[72:75]
    ds_read_b64 v[92:93], v29 offset:8704
    v_mfma_f32_16x16x32_bf16 v[76:79], v[140:143], v[176:179], v[76:79]
    ds_read_b64 v[94:95], v30 offset:8704
    v_mfma_f32_16x16x32_bf16 v[52:55], v[112:115], v[180:183], v[52:55]
    ds_read_b64 v[96:97], v29 offset:6656
    v_mov_b32_dpp v144, v8 row_shr:8 row_mask:0xf bank_mask:0xf bound_ctrl:1
    v_mfma_f32_16x16x32_bf16 v[56:59], v[116:119], v[180:183], v[56:59]
    ds_read_b64 v[98:99], v30 offset:6656
    v_mov_b32_dpp v145, v9 row_shr:8 row_mask:0xf bank_mask:0xf bound_ctrl:1
    v_mfma_f32_16x16x32_bf16 v[60:63], v[120:123], v[180:183], v[60:63]
    ds_read_b64 v[100:101], v29 offset:4608
    v_mov_b32_dpp v146, v10 row_shr:8 row_mask:0xf bank_mask:0xf bound_ctrl:1
    v_mfma_f32_16x16x32_bf16 v[64:67], v[124:127], v[180:183], v[64:67]
    ds_read_b64 v[102:103], v30 offset:4608
    v_mov_b32_dpp v147, v11 row_shr:8 row_mask:0xf bank_mask:0xf bound_ctrl:1
    v_mfma_f32_16x16x32_bf16 v[68:71], v[128:131], v[180:183], v[68:71]
    ds_read_b64 v[104:105], v29 offset:2560
    v_mfma_f32_16x16x32_bf16 v[72:75], v[132:135], v[180:183], v[72:75]
    ds_read_b64 v[106:107], v30 offset:2560
    v_mfma_f32_16x16x32_bf16 v[76:79], v[136:139], v[180:183], v[76:79]
    ds_read_b64 v[108:109], v29 offset:512
    v_mfma_f32_16x16x32_bf16 v[56:59], v[112:115], v[184:187], v[56:59]
    ds_read_b64 v[110:111], v30 offset:512
    v_mfma_f32_16x16x32_bf16 v[60:63], v[116:119], v[184:187], v[60:63]
    ds_read_b128 v[148:151], v33 offset:0
    v_mfma_f32_16x16x32_bf16 v[64:67], v[120:123], v[184:187], v[64:67]
    ds_read_b128 v[152:155], v33 offset:2048
    v_mfma_f32_16x16x32_bf16 v[68:71], v[124:127], v[184:187], v[68:71]
    ds_read_b128 v[156:159], v33 offset:4096
    v_mfma_f32_16x16x32_bf16 v[72:75], v[128:131], v[184:187], v[72:75]
    ds_read_b128 v[160:163], v33 offset:6144
    v_mfma_f32_16x16x32_bf16 v[76:79], v[132:135], v[184:187], v[76:79]
    ds_read_b128 v[164:167], v33 offset:8192
    v_mfma_f32_16x16x32_bf16 v[60:63], v[112:115], v[188:191], v[60:63]
    ds_read_b128 v[168:171], v33 offset:10240
    v_mfma_f32_16x16x32_bf16 v[64:67], v[116:119], v[188:191], v[64:67]
    ds_read_b128 v[172:175], v33 offset:12288
    v_mfma_f32_16x16x32_bf16 v[68:71], v[120:123], v[188:191], v[68:71]
    v_mfma_f32_16x16x32_bf16 v[72:75], v[124:127], v[188:191], v[72:75]
    v_mfma_f32_16x16x32_bf16 v[76:79], v[128:131], v[188:191], v[76:79]
    v_mfma_f32_16x16x32_bf16 v[64:67], v[112:115], v[192:195], v[64:67]
    v_mfma_f32_16x16x32_bf16 v[68:71], v[116:119], v[192:195], v[68:71]
    v_mfma_f32_16x16x32_bf16 v[72:75], v[120:123], v[192:195], v[72:75]
    v_mfma_f32_16x16x32_bf16 v[76:79], v[124:127], v[192:195], v[76:79]
    v_mfma_f32_16x16x32_bf16 v[68:71], v[112:115], v[196:199], v[68:71]
    v_mfma_f32_16x16x32_bf16 v[72:75], v[116:119], v[196:199], v[72:75]
    v_mfma_f32_16x16x32_bf16 v[76:79], v[120:123], v[196:199], v[76:79]
    v_mfma_f32_16x16x32_bf16 v[72:75], v[112:115], v[200:203], v[72:75]
    v_mfma_f32_16x16x32_bf16 v[76:79], v[116:119], v[200:203], v[76:79]
    v_mfma_f32_16x16x32_bf16 v[76:79], v[112:115], v[204:207], v[76:79]
    s_waitcnt lgkmcnt(0)
    v_mfma_f32_16x16x32_bf16 v[48:51], v[80:83], v[144:147], v[48:51]
    ds_read_b64 v[112:113], v31 offset:14848
    v_subrev_u32 v1, 10, v35
    v_mfma_f32_16x16x32_bf16 v[52:55], v[84:87], v[144:147], v[52:55]
    ds_read_b64 v[114:115], v32 offset:14848
    v_bfe_u32 v4, v1, 1, 3
    v_mfma_f32_16x16x32_bf16 v[56:59], v[88:91], v[144:147], v[56:59]
    ds_read_b64 v[116:117], v31 offset:12800
    v_xor_b32_e64 v4, v4, v40
    v_mfma_f32_16x16x32_bf16 v[60:63], v[92:95], v[144:147], v[60:63]
    ds_read_b64 v[118:119], v32 offset:12800
    v_lshlrev_b32_e64 v4, 4, v4
    v_mfma_f32_16x16x32_bf16 v[64:67], v[96:99], v[144:147], v[64:67]
    ds_read_b64 v[120:121], v31 offset:10752
    v_lshl_add_u32 v4, v1, 7, v4
    v_mfma_f32_16x16x32_bf16 v[68:71], v[100:103], v[144:147], v[68:71]
    ds_read_b64 v[122:123], v32 offset:10752
    v_add_u32 v34, 65536, v4
    v_mfma_f32_16x16x32_bf16 v[72:75], v[104:107], v[144:147], v[72:75]
    ds_read_b64 v[124:125], v31 offset:8704
    v_mfma_f32_16x16x32_bf16 v[76:79], v[108:111], v[144:147], v[76:79]
    ds_read_b64 v[126:127], v32 offset:8704
    v_mfma_f32_16x16x32_bf16 v[52:55], v[80:83], v[148:151], v[52:55]
    ds_read_b64 v[128:129], v31 offset:6656
    v_mov_b32_dpp v176, v8 row_shr:10 row_mask:0xf bank_mask:0xf bound_ctrl:1
    v_mfma_f32_16x16x32_bf16 v[56:59], v[84:87], v[148:151], v[56:59]
    ds_read_b64 v[130:131], v32 offset:6656
    v_mov_b32_dpp v177, v9 row_shr:10 row_mask:0xf bank_mask:0xf bound_ctrl:1
    v_mfma_f32_16x16x32_bf16 v[60:63], v[88:91], v[148:151], v[60:63]
    ds_read_b64 v[132:133], v31 offset:4608
    v_mov_b32_dpp v178, v10 row_shr:10 row_mask:0xf bank_mask:0xf bound_ctrl:1
    v_mfma_f32_16x16x32_bf16 v[64:67], v[92:95], v[148:151], v[64:67]
    ds_read_b64 v[134:135], v32 offset:4608
    v_mov_b32_dpp v179, v11 row_shr:10 row_mask:0xf bank_mask:0xf bound_ctrl:1
    v_mfma_f32_16x16x32_bf16 v[68:71], v[96:99], v[148:151], v[68:71]
    ds_read_b64 v[136:137], v31 offset:2560
    v_mfma_f32_16x16x32_bf16 v[72:75], v[100:103], v[148:151], v[72:75]
    ds_read_b64 v[138:139], v32 offset:2560
    v_mfma_f32_16x16x32_bf16 v[76:79], v[104:107], v[148:151], v[76:79]
    ds_read_b64 v[140:141], v31 offset:512
    v_mfma_f32_16x16x32_bf16 v[56:59], v[80:83], v[152:155], v[56:59]
    ds_read_b64 v[142:143], v32 offset:512
    v_mfma_f32_16x16x32_bf16 v[60:63], v[84:87], v[152:155], v[60:63]
    ds_read_b128 v[180:183], v34 offset:0
    v_mfma_f32_16x16x32_bf16 v[64:67], v[88:91], v[152:155], v[64:67]
    ds_read_b128 v[184:187], v34 offset:2048
    v_mfma_f32_16x16x32_bf16 v[68:71], v[92:95], v[152:155], v[68:71]
    ds_read_b128 v[188:191], v34 offset:4096
    v_mfma_f32_16x16x32_bf16 v[72:75], v[96:99], v[152:155], v[72:75]
    ds_read_b128 v[192:195], v34 offset:6144
    v_mfma_f32_16x16x32_bf16 v[76:79], v[100:103], v[152:155], v[76:79]
    ds_read_b128 v[196:199], v34 offset:8192
    v_mfma_f32_16x16x32_bf16 v[60:63], v[80:83], v[156:159], v[60:63]
    ds_read_b128 v[200:203], v34 offset:10240
    v_mfma_f32_16x16x32_bf16 v[64:67], v[84:87], v[156:159], v[64:67]
    ds_read_b128 v[204:207], v34 offset:12288
    v_mfma_f32_16x16x32_bf16 v[68:71], v[88:91], v[156:159], v[68:71]
    v_mfma_f32_16x16x32_bf16 v[72:75], v[92:95], v[156:159], v[72:75]
    v_mfma_f32_16x16x32_bf16 v[76:79], v[96:99], v[156:159], v[76:79]
    v_mfma_f32_16x16x32_bf16 v[64:67], v[80:83], v[160:163], v[64:67]
    v_mfma_f32_16x16x32_bf16 v[68:71], v[84:87], v[160:163], v[68:71]
    v_mfma_f32_16x16x32_bf16 v[72:75], v[88:91], v[160:163], v[72:75]
    v_mfma_f32_16x16x32_bf16 v[76:79], v[92:95], v[160:163], v[76:79]
    v_mfma_f32_16x16x32_bf16 v[68:71], v[80:83], v[164:167], v[68:71]
    v_mfma_f32_16x16x32_bf16 v[72:75], v[84:87], v[164:167], v[72:75]
    v_mfma_f32_16x16x32_bf16 v[76:79], v[88:91], v[164:167], v[76:79]
    v_mfma_f32_16x16x32_bf16 v[72:75], v[80:83], v[168:171], v[72:75]
    v_mfma_f32_16x16x32_bf16 v[76:79], v[84:87], v[168:171], v[76:79]
    v_mfma_f32_16x16x32_bf16 v[76:79], v[80:83], v[172:175], v[76:79]
    s_waitcnt lgkmcnt(0)
    v_mfma_f32_16x16x32_bf16 v[48:51], v[112:115], v[176:179], v[48:51]
    ds_read_b64 v[80:81], v29 offset:14336
    v_subrev_u32 v1, 12, v35
    v_mfma_f32_16x16x32_bf16 v[52:55], v[116:119], v[176:179], v[52:55]
    ds_read_b64 v[82:83], v30 offset:14336
    v_bfe_u32 v4, v1, 1, 3
    v_mfma_f32_16x16x32_bf16 v[56:59], v[120:123], v[176:179], v[56:59]
    ds_read_b64 v[84:85], v29 offset:12288
    v_xor_b32_e64 v4, v4, v40
    v_mfma_f32_16x16x32_bf16 v[60:63], v[124:127], v[176:179], v[60:63]
    ds_read_b64 v[86:87], v30 offset:12288
    v_lshlrev_b32_e64 v4, 4, v4
    v_mfma_f32_16x16x32_bf16 v[64:67], v[128:131], v[176:179], v[64:67]
    ds_read_b64 v[88:89], v29 offset:10240
    v_lshl_add_u32 v4, v1, 7, v4
    v_mfma_f32_16x16x32_bf16 v[68:71], v[132:135], v[176:179], v[68:71]
    ds_read_b64 v[90:91], v30 offset:10240
    v_add_u32 v33, 65536, v4
    v_mfma_f32_16x16x32_bf16 v[72:75], v[136:139], v[176:179], v[72:75]
    ds_read_b64 v[92:93], v29 offset:8192
    v_mfma_f32_16x16x32_bf16 v[76:79], v[140:143], v[176:179], v[76:79]
    ds_read_b64 v[94:95], v30 offset:8192
    v_mfma_f32_16x16x32_bf16 v[52:55], v[112:115], v[180:183], v[52:55]
    ds_read_b64 v[96:97], v29 offset:6144
    v_mov_b32_dpp v144, v8 row_shr:12 row_mask:0xf bank_mask:0xf bound_ctrl:1
    v_mfma_f32_16x16x32_bf16 v[56:59], v[116:119], v[180:183], v[56:59]
    ds_read_b64 v[98:99], v30 offset:6144
    v_mov_b32_dpp v145, v9 row_shr:12 row_mask:0xf bank_mask:0xf bound_ctrl:1
    v_mfma_f32_16x16x32_bf16 v[60:63], v[120:123], v[180:183], v[60:63]
    ds_read_b64 v[100:101], v29 offset:4096
    v_mov_b32_dpp v146, v10 row_shr:12 row_mask:0xf bank_mask:0xf bound_ctrl:1
    v_mfma_f32_16x16x32_bf16 v[64:67], v[124:127], v[180:183], v[64:67]
    ds_read_b64 v[102:103], v30 offset:4096
    v_mov_b32_dpp v147, v11 row_shr:12 row_mask:0xf bank_mask:0xf bound_ctrl:1
    v_mfma_f32_16x16x32_bf16 v[68:71], v[128:131], v[180:183], v[68:71]
    ds_read_b64 v[104:105], v29 offset:2048
    v_mfma_f32_16x16x32_bf16 v[72:75], v[132:135], v[180:183], v[72:75]
    ds_read_b64 v[106:107], v30 offset:2048
    v_mfma_f32_16x16x32_bf16 v[76:79], v[136:139], v[180:183], v[76:79]
    ds_read_b64 v[108:109], v29 offset:0
    v_mfma_f32_16x16x32_bf16 v[56:59], v[112:115], v[184:187], v[56:59]
    ds_read_b64 v[110:111], v30 offset:0
    v_mfma_f32_16x16x32_bf16 v[60:63], v[116:119], v[184:187], v[60:63]
    ds_read_b128 v[148:151], v33 offset:0
    v_mfma_f32_16x16x32_bf16 v[64:67], v[120:123], v[184:187], v[64:67]
    ds_read_b128 v[152:155], v33 offset:2048
    v_mfma_f32_16x16x32_bf16 v[68:71], v[124:127], v[184:187], v[68:71]
    ds_read_b128 v[156:159], v33 offset:4096
    v_mfma_f32_16x16x32_bf16 v[72:75], v[128:131], v[184:187], v[72:75]
    ds_read_b128 v[160:163], v33 offset:6144
    v_mfma_f32_16x16x32_bf16 v[76:79], v[132:135], v[184:187], v[76:79]
    ds_read_b128 v[164:167], v33 offset:8192
    v_mfma_f32_16x16x32_bf16 v[60:63], v[112:115], v[188:191], v[60:63]
    ds_read_b128 v[168:171], v33 offset:10240
    v_mfma_f32_16x16x32_bf16 v[64:67], v[116:119], v[188:191], v[64:67]
    ds_read_b128 v[172:175], v33 offset:12288
    v_mfma_f32_16x16x32_bf16 v[68:71], v[120:123], v[188:191], v[68:71]
    v_mfma_f32_16x16x32_bf16 v[72:75], v[124:127], v[188:191], v[72:75]
    v_mfma_f32_16x16x32_bf16 v[76:79], v[128:131], v[188:191], v[76:79]
    v_mfma_f32_16x16x32_bf16 v[64:67], v[112:115], v[192:195], v[64:67]
    v_mfma_f32_16x16x32_bf16 v[68:71], v[116:119], v[192:195], v[68:71]
    v_mfma_f32_16x16x32_bf16 v[72:75], v[120:123], v[192:195], v[72:75]
    v_mfma_f32_16x16x32_bf16 v[76:79], v[124:127], v[192:195], v[76:79]
    v_mfma_f32_16x16x32_bf16 v[68:71], v[112:115], v[196:199], v[68:71]
    v_mfma_f32_16x16x32_bf16 v[72:75], v[116:119], v[196:199], v[72:75]
    v_mfma_f32_16x16x32_bf16 v[76:79], v[120:123], v[196:199], v[76:79]
    v_mfma_f32_16x16x32_bf16 v[72:75], v[112:115], v[200:203], v[72:75]
    v_mfma_f32_16x16x32_bf16 v[76:79], v[116:119], v[200:203], v[76:79]
    v_mfma_f32_16x16x32_bf16 v[76:79], v[112:115], v[204:207], v[76:79]
    s_waitcnt lgkmcnt(0)
    v_mfma_f32_16x16x32_bf16 v[48:51], v[80:83], v[144:147], v[48:51]
    ds_read_b64 v[112:113], v31 offset:14336
    v_subrev_u32 v1, 14, v35
    v_mfma_f32_16x16x32_bf16 v[52:55], v[84:87], v[144:147], v[52:55]
    ds_read_b64 v[114:115], v32 offset:14336
    v_bfe_u32 v4, v1, 1, 3
    v_mfma_f32_16x16x32_bf16 v[56:59], v[88:91], v[144:147], v[56:59]
    ds_read_b64 v[116:117], v31 offset:12288
    v_xor_b32_e64 v4, v4, v40
    v_mfma_f32_16x16x32_bf16 v[60:63], v[92:95], v[144:147], v[60:63]
    ds_read_b64 v[118:119], v32 offset:12288
    v_lshlrev_b32_e64 v4, 4, v4
    v_mfma_f32_16x16x32_bf16 v[64:67], v[96:99], v[144:147], v[64:67]
    ds_read_b64 v[120:121], v31 offset:10240
    v_lshl_add_u32 v4, v1, 7, v4
    v_mfma_f32_16x16x32_bf16 v[68:71], v[100:103], v[144:147], v[68:71]
    ds_read_b64 v[122:123], v32 offset:10240
    v_add_u32 v34, 65536, v4
    v_mfma_f32_16x16x32_bf16 v[72:75], v[104:107], v[144:147], v[72:75]
    ds_read_b64 v[124:125], v31 offset:8192
    v_mfma_f32_16x16x32_bf16 v[76:79], v[108:111], v[144:147], v[76:79]
    ds_read_b64 v[126:127], v32 offset:8192
    v_mfma_f32_16x16x32_bf16 v[52:55], v[80:83], v[148:151], v[52:55]
    ds_read_b64 v[128:129], v31 offset:6144
    v_mov_b32_dpp v176, v8 row_shr:14 row_mask:0xf bank_mask:0xf bound_ctrl:1
    v_mfma_f32_16x16x32_bf16 v[56:59], v[84:87], v[148:151], v[56:59]
    ds_read_b64 v[130:131], v32 offset:6144
    v_mov_b32_dpp v177, v9 row_shr:14 row_mask:0xf bank_mask:0xf bound_ctrl:1
    v_mfma_f32_16x16x32_bf16 v[60:63], v[88:91], v[148:151], v[60:63]
    ds_read_b64 v[132:133], v31 offset:4096
    v_mov_b32_dpp v178, v10 row_shr:14 row_mask:0xf bank_mask:0xf bound_ctrl:1
    v_mfma_f32_16x16x32_bf16 v[64:67], v[92:95], v[148:151], v[64:67]
    ds_read_b64 v[134:135], v32 offset:4096
    v_mov_b32_dpp v179, v11 row_shr:14 row_mask:0xf bank_mask:0xf bound_ctrl:1
    v_mfma_f32_16x16x32_bf16 v[68:71], v[96:99], v[148:151], v[68:71]
    ds_read_b64 v[136:137], v31 offset:2048
    v_mfma_f32_16x16x32_bf16 v[72:75], v[100:103], v[148:151], v[72:75]
    ds_read_b64 v[138:139], v32 offset:2048
    v_mfma_f32_16x16x32_bf16 v[76:79], v[104:107], v[148:151], v[76:79]
    ds_read_b64 v[140:141], v31 offset:0
    v_mfma_f32_16x16x32_bf16 v[56:59], v[80:83], v[152:155], v[56:59]
    ds_read_b64 v[142:143], v32 offset:0
    v_mfma_f32_16x16x32_bf16 v[60:63], v[84:87], v[152:155], v[60:63]
    ds_read_b128 v[180:183], v34 offset:0
    v_mfma_f32_16x16x32_bf16 v[64:67], v[88:91], v[152:155], v[64:67]
    ds_read_b128 v[184:187], v34 offset:2048
    v_mfma_f32_16x16x32_bf16 v[68:71], v[92:95], v[152:155], v[68:71]
    ds_read_b128 v[188:191], v34 offset:4096
    v_mfma_f32_16x16x32_bf16 v[72:75], v[96:99], v[152:155], v[72:75]
    ds_read_b128 v[192:195], v34 offset:6144
    v_mfma_f32_16x16x32_bf16 v[76:79], v[100:103], v[152:155], v[76:79]
    ds_read_b128 v[196:199], v34 offset:8192
    v_mfma_f32_16x16x32_bf16 v[60:63], v[80:83], v[156:159], v[60:63]
    ds_read_b128 v[200:203], v34 offset:10240
    v_mfma_f32_16x16x32_bf16 v[64:67], v[84:87], v[156:159], v[64:67]
    ds_read_b128 v[204:207], v34 offset:12288
    v_mfma_f32_16x16x32_bf16 v[68:71], v[88:91], v[156:159], v[68:71]
    v_mfma_f32_16x16x32_bf16 v[72:75], v[92:95], v[156:159], v[72:75]
    v_mfma_f32_16x16x32_bf16 v[76:79], v[96:99], v[156:159], v[76:79]
    v_mfma_f32_16x16x32_bf16 v[64:67], v[80:83], v[160:163], v[64:67]
    v_mfma_f32_16x16x32_bf16 v[68:71], v[84:87], v[160:163], v[68:71]
    v_mfma_f32_16x16x32_bf16 v[72:75], v[88:91], v[160:163], v[72:75]
    v_mfma_f32_16x16x32_bf16 v[76:79], v[92:95], v[160:163], v[76:79]
    v_mfma_f32_16x16x32_bf16 v[68:71], v[80:83], v[164:167], v[68:71]
    v_mfma_f32_16x16x32_bf16 v[72:75], v[84:87], v[164:167], v[72:75]
    v_mfma_f32_16x16x32_bf16 v[76:79], v[88:91], v[164:167], v[76:79]
    v_mfma_f32_16x16x32_bf16 v[72:75], v[80:83], v[168:171], v[72:75]
    v_mfma_f32_16x16x32_bf16 v[76:79], v[84:87], v[168:171], v[76:79]
    v_mfma_f32_16x16x32_bf16 v[76:79], v[80:83], v[172:175], v[76:79]
    s_waitcnt lgkmcnt(0)
    s_nop 0
    v_mfma_f32_16x16x32_bf16 v[48:51], v[112:115], v[176:179], v[48:51]
    v_mfma_f32_16x16x32_bf16 v[52:55], v[116:119], v[176:179], v[52:55]
    v_mfma_f32_16x16x32_bf16 v[56:59], v[120:123], v[176:179], v[56:59]
    v_mfma_f32_16x16x32_bf16 v[60:63], v[124:127], v[176:179], v[60:63]
    v_mfma_f32_16x16x32_bf16 v[64:67], v[128:131], v[176:179], v[64:67]
    v_mfma_f32_16x16x32_bf16 v[68:71], v[132:135], v[176:179], v[68:71]
    v_mfma_f32_16x16x32_bf16 v[72:75], v[136:139], v[176:179], v[72:75]
    v_mfma_f32_16x16x32_bf16 v[76:79], v[140:143], v[176:179], v[76:79]
    v_mfma_f32_16x16x32_bf16 v[52:55], v[112:115], v[180:183], v[52:55]
    v_mfma_f32_16x16x32_bf16 v[56:59], v[116:119], v[180:183], v[56:59]
    v_mfma_f32_16x16x32_bf16 v[60:63], v[120:123], v[180:183], v[60:63]
    v_mfma_f32_16x16x32_bf16 v[64:67], v[124:127], v[180:183], v[64:67]
    v_mfma_f32_16x16x32_bf16 v[68:71], v[128:131], v[180:183], v[68:71]
    v_mfma_f32_16x16x32_bf16 v[72:75], v[132:135], v[180:183], v[72:75]
    v_mfma_f32_16x16x32_bf16 v[76:79], v[136:139], v[180:183], v[76:79]
    v_mfma_f32_16x16x32_bf16 v[56:59], v[112:115], v[184:187], v[56:59]
    v_mfma_f32_16x16x32_bf16 v[60:63], v[116:119], v[184:187], v[60:63]
    v_mfma_f32_16x16x32_bf16 v[64:67], v[120:123], v[184:187], v[64:67]
    v_mfma_f32_16x16x32_bf16 v[68:71], v[124:127], v[184:187], v[68:71]
    v_mfma_f32_16x16x32_bf16 v[72:75], v[128:131], v[184:187], v[72:75]
    v_mfma_f32_16x16x32_bf16 v[76:79], v[132:135], v[184:187], v[76:79]
    v_mfma_f32_16x16x32_bf16 v[60:63], v[112:115], v[188:191], v[60:63]
    v_mfma_f32_16x16x32_bf16 v[64:67], v[116:119], v[188:191], v[64:67]
    v_mfma_f32_16x16x32_bf16 v[68:71], v[120:123], v[188:191], v[68:71]
    v_mfma_f32_16x16x32_bf16 v[72:75], v[124:127], v[188:191], v[72:75]
    v_mfma_f32_16x16x32_bf16 v[76:79], v[128:131], v[188:191], v[76:79]
    v_mfma_f32_16x16x32_bf16 v[64:67], v[112:115], v[192:195], v[64:67]
    v_mfma_f32_16x16x32_bf16 v[68:71], v[116:119], v[192:195], v[68:71]
    v_mfma_f32_16x16x32_bf16 v[72:75], v[120:123], v[192:195], v[72:75]
    v_mfma_f32_16x16x32_bf16 v[76:79], v[124:127], v[192:195], v[76:79]
    v_mfma_f32_16x16x32_bf16 v[68:71], v[112:115], v[196:199], v[68:71]
    v_mfma_f32_16x16x32_bf16 v[72:75], v[116:119], v[196:199], v[72:75]
    v_mfma_f32_16x16x32_bf16 v[76:79], v[120:123], v[196:199], v[76:79]
    v_mfma_f32_16x16x32_bf16 v[72:75], v[112:115], v[200:203], v[72:75]
    v_mfma_f32_16x16x32_bf16 v[76:79], v[116:119], v[200:203], v[76:79]
    v_mfma_f32_16x16x32_bf16 v[76:79], v[112:115], v[204:207], v[76:79]
    v_and_b32 v1, 1, v42
    v_lshlrev_b32 v1, 9, v1
    v_lshl_add_u32 v1, v41, 5, v1
    v_lshrrev_b32_e64 v4, 1, v42
    v_lshl_add_u32 v1, v4, 4, v1
    s_lshl_b32 s48, s92, 12
    s_nop 0
    s_add_u32 s48, s48, 10485760
    v_cvt_pk_bf16_f32 v80, v48, v49
    v_cvt_pk_bf16_f32 v81, v50, v51
    v_cvt_pk_bf16_f32 v82, v52, v53
    v_cvt_pk_bf16_f32 v83, v54, v55
    v_cvt_pk_bf16_f32 v84, v56, v57
    v_cvt_pk_bf16_f32 v85, v58, v59
    v_cvt_pk_bf16_f32 v86, v60, v61
    v_cvt_pk_bf16_f32 v87, v62, v63
    v_cvt_pk_bf16_f32 v88, v64, v65
    v_cvt_pk_bf16_f32 v89, v66, v67
    v_cvt_pk_bf16_f32 v90, v68, v69
    v_cvt_pk_bf16_f32 v91, v70, v71
    v_cvt_pk_bf16_f32 v92, v72, v73
    v_cvt_pk_bf16_f32 v93, v74, v75
    v_cvt_pk_bf16_f32 v94, v76, v77
    v_cvt_pk_bf16_f32 v95, v78, v79
    v_permlane16_swap_b32 v80, v82
    v_permlane16_swap_b32 v81, v83
    buffer_store_dwordx4 v[80:83], v1, s[24:27], s48 offen offset:0 sc1
    v_permlane16_swap_b32 v84, v86
    v_permlane16_swap_b32 v85, v87
    buffer_store_dwordx4 v[84:87], v1, s[24:27], s48 offen offset:1024 sc1
    v_permlane16_swap_b32 v88, v90
    v_permlane16_swap_b32 v89, v91
    buffer_store_dwordx4 v[88:91], v1, s[24:27], s48 offen offset:2048 sc1
    v_permlane16_swap_b32 v92, v94
    v_permlane16_swap_b32 v93, v95
    buffer_store_dwordx4 v[92:95], v1, s[24:27], s48 offen offset:3072 sc1
L_fsig:
    s_lshr_b32 s48, s92, 2
    s_lshl_b32 s48, s48, 7
    s_add_u32 s48, s48, 21168128
    s_waitcnt vmcnt(0) lgkmcnt(0)
    s_barrier
    s_cmp_lg_u32 s36, 0
    s_cbranch_scc1 L_sig_53
    v_mov_b32_e64 v1, s45
    s_mov_b64 s[58:59], exec
    s_mov_b64 exec, 1
    buffer_store_dword v1, off, s[24:27], s48 sc1
    s_mov_b64 exec, s[58:59]
L_sig_53:
    s_endpgm
L_helper:
    s_sub_u32 s48, s47, 20
    s_lshl_b32 s48, s48, 2
    s_add_u32 s48, s48, s36
    s_lshl_b32 s48, s48, 13
    s_getpc_b64 s[72:73]
L_pc:
    s_sub_u32 s72, s72, L_pc-recurrent_scan__ssm_conv_s4__mixer_s_mlp__prompt_kernel
    s_subb_u32 s73, s73, 0
    v_lshl_add_u32 v1, v0, 7, s48
    v_cmp_gt_u32 vcc, L_codeend-recurrent_scan__ssm_conv_s4__mixer_s_mlp__prompt_kernel, v1
    s_and_saveexec_b64 s[58:59], vcc
    s_cbranch_execz L_nopf_54
    global_load_dword v4, v1, s[72:73]
L_nopf_54:
    s_mov_b64 exec, s[58:59]
    s_cmp_ge_u32 s46, 4
    s_cselect_b32 s48, 25, 30
    s_cmp_lt_u32 s47, s48
    s_cbranch_scc1 L_end
    s_cmp_ge_u32 s46, 4
    s_cselect_b32 s48, 26, 32
    s_cmp_ge_u32 s47, s48
    s_cbranch_scc1 L_cs_55
    s_mov_b32 s14, 0xc8000
    s_mov_b32 s15, 0x20000
    s_mov_b32 s22, 0x1e0000
    s_mov_b32 s23, 0x20000
    s_lshl_b32 s48, s46, 1
    s_add_u32 s48, s48, s47
    s_sub_u32 s48, s48, 30
    s_add_u32 s49, s46, 4
    s_cmp_ge_u32 s46, 4
    s_cselect_b32 s48, s49, s48
    s_lshl_b32 s48, s48, 2
    s_add_u32 s48, s48, s36
    s_lshl_b32 s48, s48, 13
    v_lshl_add_u32 v1, v0, 7, s48
    s_waitcnt vmcnt(0) lgkmcnt(0)
    s_mov_b32 s54, 0
    buffer_load_dword v4, v1, s[20:23], s54 offen
    s_mov_b32 s54, 393216
    buffer_load_dword v4, v1, s[20:23], s54 offen
    s_mov_b32 s54, 786432
    buffer_load_dword v4, v1, s[20:23], s54 offen
    s_mov_b32 s54, 1179648
    buffer_load_dword v4, v1, s[20:23], s54 offen
    s_mov_b32 s54, 1572864
    buffer_load_dword v4, v1, s[20:23], s54 offen
    s_endpgm
L_cs_55:
    s_sub_u32 s48, s46, 4
    s_mul_i32 s48, s48, 6
    s_add_u32 s48, s48, s47
    s_sub_u32 s92, s48, 26
    v_lshrrev_b32 v1, 3, v0
    s_mul_i32 s48, s36, 160
    v_add_u32_e64 v1, s48, v1
    v_mul_u32_u24 v1, 3072, v1
    v_and_b32_e64 v5, 7, v0
    v_lshl_add_u32 v1, v5, 4, v1
    s_lshl_b32 s48, s92, 7
    v_add_u32_e64 v1, s48, v1
    s_waitcnt vmcnt(0) lgkmcnt(0)
    buffer_load_dwordx2 v[2:3], off, s[32:35], 0 sc1
    s_waitcnt vmcnt(0) lgkmcnt(0)
    s_mov_b32 s56, 0
L_nv_56:
    v_readfirstlane_b32 s48, v3
    v_readfirstlane_b32 s45, v2
    s_add_u32 s56, s56, 1
    s_cmp_lg_u32 s48, 0
    s_cbranch_scc1 L_nvok_57
    s_sleep 2
    buffer_load_dwordx2 v[2:3], off, s[32:35], 0 sc1
    s_waitcnt vmcnt(0)
    s_cmp_lt_u32 s56, 100000
    s_cbranch_scc1 L_nv_56
L_nvok_57:
    s_mov_b32 s54, 0
    s_nop 0
    buffer_load_dwordx4 v[40:43], v1, s[16:19], s54 offen
    s_mov_b32 s54, 24576
    buffer_load_dwordx4 v[44:47], v1, s[16:19], s54 offen
    s_mov_b32 s54, 49152
    buffer_load_dwordx4 v[48:51], v1, s[16:19], s54 offen
    s_mov_b32 s54, 73728
    buffer_load_dwordx4 v[52:55], v1, s[16:19], s54 offen
    s_mov_b32 s54, 98304
    buffer_load_dwordx4 v[56:59], v1, s[16:19], s54 offen
    s_mov_b32 s54, 122880
    buffer_load_dwordx4 v[60:63], v1, s[16:19], s54 offen
    s_mov_b32 s54, 147456
    buffer_load_dwordx4 v[64:67], v1, s[16:19], s54 offen
    s_mov_b32 s54, 172032
    buffer_load_dwordx4 v[68:71], v1, s[16:19], s54 offen
    s_mov_b32 s54, 196608
    buffer_load_dwordx4 v[72:75], v1, s[16:19], s54 offen
    s_mov_b32 s54, 221184
    buffer_load_dwordx4 v[76:79], v1, s[16:19], s54 offen
    s_mov_b32 s54, 245760
    buffer_load_dwordx4 v[80:83], v1, s[16:19], s54 offen
    s_mov_b32 s54, 270336
    buffer_load_dwordx4 v[84:87], v1, s[16:19], s54 offen
    s_mov_b32 s54, 294912
    buffer_load_dwordx4 v[88:91], v1, s[16:19], s54 offen
    s_mov_b32 s54, 319488
    buffer_load_dwordx4 v[92:95], v1, s[16:19], s54 offen
    s_mov_b32 s54, 344064
    buffer_load_dwordx4 v[96:99], v1, s[16:19], s54 offen
    s_mov_b32 s54, 368640
    buffer_load_dwordx4 v[100:103], v1, s[16:19], s54 offen
    s_mov_b32 s54, 393216
    buffer_load_dwordx4 v[104:107], v1, s[16:19], s54 offen
    s_mov_b32 s54, 417792
    buffer_load_dwordx4 v[108:111], v1, s[16:19], s54 offen
    s_mov_b32 s54, 442368
    buffer_load_dwordx4 v[112:115], v1, s[16:19], s54 offen
    s_mov_b32 s54, 466944
    buffer_load_dwordx4 v[116:119], v1, s[16:19], s54 offen
    s_waitcnt vmcnt(19)
    v_lshlrev_b32 v130, 16, v40
    v_and_b32 v131, 0xffff0000, v40
    v_lshlrev_b32_e64 v132, 16, v41
    v_and_b32 v133, 0xffff0000, v41
    v_lshlrev_b32_e64 v134, 16, v42
    v_and_b32 v135, 0xffff0000, v42
    v_lshlrev_b32_e64 v136, 16, v43
    v_and_b32 v137, 0xffff0000, v43
    s_waitcnt vmcnt(18)
    v_lshlrev_b32 v5, 16, v44
    v_and_b32 v6, 0xffff0000, v44
    v_add_f32 v130, v130, v5
    v_add_f32 v131, v131, v6
    v_lshlrev_b32_e64 v5, 16, v45
    v_and_b32 v6, 0xffff0000, v45
    v_add_f32 v132, v132, v5
    v_add_f32 v133, v133, v6
    v_lshlrev_b32_e64 v5, 16, v46
    v_and_b32 v6, 0xffff0000, v46
    v_add_f32 v134, v134, v5
    v_add_f32 v135, v135, v6
    v_lshlrev_b32_e64 v5, 16, v47
    v_and_b32 v6, 0xffff0000, v47
    v_add_f32 v136, v136, v5
    v_add_f32 v137, v137, v6
    s_waitcnt vmcnt(17)
    v_lshlrev_b32 v5, 16, v48
    v_and_b32 v6, 0xffff0000, v48
    v_add_f32 v130, v130, v5
    v_add_f32 v131, v131, v6
    v_lshlrev_b32_e64 v5, 16, v49
    v_and_b32 v6, 0xffff0000, v49
    v_add_f32 v132, v132, v5
    v_add_f32 v133, v133, v6
    v_lshlrev_b32_e64 v5, 16, v50
    v_and_b32 v6, 0xffff0000, v50
    v_add_f32 v134, v134, v5
    v_add_f32 v135, v135, v6
    v_lshlrev_b32_e64 v5, 16, v51
    v_and_b32 v6, 0xffff0000, v51
    v_add_f32 v136, v136, v5
    v_add_f32 v137, v137, v6
    s_waitcnt vmcnt(16)
    v_lshlrev_b32 v5, 16, v52
    v_and_b32 v6, 0xffff0000, v52
    v_add_f32 v130, v130, v5
    v_add_f32 v131, v131, v6
    v_lshlrev_b32_e64 v5, 16, v53
    v_and_b32 v6, 0xffff0000, v53
    v_add_f32 v132, v132, v5
    v_add_f32 v133, v133, v6
    v_lshlrev_b32_e64 v5, 16, v54
    v_and_b32 v6, 0xffff0000, v54
    v_add_f32 v134, v134, v5
    v_add_f32 v135, v135, v6
    v_lshlrev_b32_e64 v5, 16, v55
    v_and_b32 v6, 0xffff0000, v55
    v_add_f32 v136, v136, v5
    v_add_f32 v137, v137, v6
    s_waitcnt vmcnt(15)
    v_lshlrev_b32 v5, 16, v56
    v_and_b32 v6, 0xffff0000, v56
    v_add_f32 v130, v130, v5
    v_add_f32 v131, v131, v6
    v_lshlrev_b32_e64 v5, 16, v57
    v_and_b32 v6, 0xffff0000, v57
    v_add_f32 v132, v132, v5
    v_add_f32 v133, v133, v6
    v_lshlrev_b32_e64 v5, 16, v58
    v_and_b32 v6, 0xffff0000, v58
    v_add_f32 v134, v134, v5
    v_add_f32 v135, v135, v6
    v_lshlrev_b32_e64 v5, 16, v59
    v_and_b32 v6, 0xffff0000, v59
    v_add_f32 v136, v136, v5
    v_add_f32 v137, v137, v6
    s_waitcnt vmcnt(14)
    v_lshlrev_b32 v5, 16, v60
    v_and_b32 v6, 0xffff0000, v60
    v_add_f32 v130, v130, v5
    v_add_f32 v131, v131, v6
    v_lshlrev_b32_e64 v5, 16, v61
    v_and_b32 v6, 0xffff0000, v61
    v_add_f32 v132, v132, v5
    v_add_f32 v133, v133, v6
    v_lshlrev_b32_e64 v5, 16, v62
    v_and_b32 v6, 0xffff0000, v62
    v_add_f32 v134, v134, v5
    v_add_f32 v135, v135, v6
    v_lshlrev_b32_e64 v5, 16, v63
    v_and_b32 v6, 0xffff0000, v63
    v_add_f32 v136, v136, v5
    v_add_f32 v137, v137, v6
    s_waitcnt vmcnt(13)
    v_lshlrev_b32 v5, 16, v64
    v_and_b32 v6, 0xffff0000, v64
    v_add_f32 v130, v130, v5
    v_add_f32 v131, v131, v6
    v_lshlrev_b32_e64 v5, 16, v65
    v_and_b32 v6, 0xffff0000, v65
    v_add_f32 v132, v132, v5
    v_add_f32 v133, v133, v6
    v_lshlrev_b32_e64 v5, 16, v66
    v_and_b32 v6, 0xffff0000, v66
    v_add_f32 v134, v134, v5
    v_add_f32 v135, v135, v6
    v_lshlrev_b32_e64 v5, 16, v67
    v_and_b32 v6, 0xffff0000, v67
    v_add_f32 v136, v136, v5
    v_add_f32 v137, v137, v6
    s_waitcnt vmcnt(12)
    v_lshlrev_b32 v5, 16, v68
    v_and_b32 v6, 0xffff0000, v68
    v_add_f32 v130, v130, v5
    v_add_f32 v131, v131, v6
    v_lshlrev_b32_e64 v5, 16, v69
    v_and_b32 v6, 0xffff0000, v69
    v_add_f32 v132, v132, v5
    v_add_f32 v133, v133, v6
    v_lshlrev_b32_e64 v5, 16, v70
    v_and_b32 v6, 0xffff0000, v70
    v_add_f32 v134, v134, v5
    v_add_f32 v135, v135, v6
    v_lshlrev_b32_e64 v5, 16, v71
    v_and_b32 v6, 0xffff0000, v71
    v_add_f32 v136, v136, v5
    v_add_f32 v137, v137, v6
    s_waitcnt vmcnt(11)
    v_lshlrev_b32 v5, 16, v72
    v_and_b32 v6, 0xffff0000, v72
    v_add_f32 v130, v130, v5
    v_add_f32 v131, v131, v6
    v_lshlrev_b32_e64 v5, 16, v73
    v_and_b32 v6, 0xffff0000, v73
    v_add_f32 v132, v132, v5
    v_add_f32 v133, v133, v6
    v_lshlrev_b32_e64 v5, 16, v74
    v_and_b32 v6, 0xffff0000, v74
    v_add_f32 v134, v134, v5
    v_add_f32 v135, v135, v6
    v_lshlrev_b32_e64 v5, 16, v75
    v_and_b32 v6, 0xffff0000, v75
    v_add_f32 v136, v136, v5
    v_add_f32 v137, v137, v6
    s_waitcnt vmcnt(10)
    v_lshlrev_b32 v5, 16, v76
    v_and_b32 v6, 0xffff0000, v76
    v_add_f32 v130, v130, v5
    v_add_f32 v131, v131, v6
    v_lshlrev_b32_e64 v5, 16, v77
    v_and_b32 v6, 0xffff0000, v77
    v_add_f32 v132, v132, v5
    v_add_f32 v133, v133, v6
    v_lshlrev_b32_e64 v5, 16, v78
    v_and_b32 v6, 0xffff0000, v78
    v_add_f32 v134, v134, v5
    v_add_f32 v135, v135, v6
    v_lshlrev_b32_e64 v5, 16, v79
    v_and_b32 v6, 0xffff0000, v79
    v_add_f32 v136, v136, v5
    v_add_f32 v137, v137, v6
    s_waitcnt vmcnt(9)
    v_lshlrev_b32 v5, 16, v80
    v_and_b32 v6, 0xffff0000, v80
    v_add_f32 v130, v130, v5
    v_add_f32 v131, v131, v6
    v_lshlrev_b32_e64 v5, 16, v81
    v_and_b32 v6, 0xffff0000, v81
    v_add_f32 v132, v132, v5
    v_add_f32 v133, v133, v6
    v_lshlrev_b32_e64 v5, 16, v82
    v_and_b32 v6, 0xffff0000, v82
    v_add_f32 v134, v134, v5
    v_add_f32 v135, v135, v6
    v_lshlrev_b32_e64 v5, 16, v83
    v_and_b32 v6, 0xffff0000, v83
    v_add_f32 v136, v136, v5
    v_add_f32 v137, v137, v6
    s_waitcnt vmcnt(8)
    v_lshlrev_b32 v5, 16, v84
    v_and_b32 v6, 0xffff0000, v84
    v_add_f32 v130, v130, v5
    v_add_f32 v131, v131, v6
    v_lshlrev_b32_e64 v5, 16, v85
    v_and_b32 v6, 0xffff0000, v85
    v_add_f32 v132, v132, v5
    v_add_f32 v133, v133, v6
    v_lshlrev_b32_e64 v5, 16, v86
    v_and_b32 v6, 0xffff0000, v86
    v_add_f32 v134, v134, v5
    v_add_f32 v135, v135, v6
    v_lshlrev_b32_e64 v5, 16, v87
    v_and_b32 v6, 0xffff0000, v87
    v_add_f32 v136, v136, v5
    v_add_f32 v137, v137, v6
    s_waitcnt vmcnt(7)
    v_lshlrev_b32 v5, 16, v88
    v_and_b32 v6, 0xffff0000, v88
    v_add_f32 v130, v130, v5
    v_add_f32 v131, v131, v6
    v_lshlrev_b32_e64 v5, 16, v89
    v_and_b32 v6, 0xffff0000, v89
    v_add_f32 v132, v132, v5
    v_add_f32 v133, v133, v6
    v_lshlrev_b32_e64 v5, 16, v90
    v_and_b32 v6, 0xffff0000, v90
    v_add_f32 v134, v134, v5
    v_add_f32 v135, v135, v6
    v_lshlrev_b32_e64 v5, 16, v91
    v_and_b32 v6, 0xffff0000, v91
    v_add_f32 v136, v136, v5
    v_add_f32 v137, v137, v6
    s_waitcnt vmcnt(6)
    v_lshlrev_b32 v5, 16, v92
    v_and_b32 v6, 0xffff0000, v92
    v_add_f32 v130, v130, v5
    v_add_f32 v131, v131, v6
    v_lshlrev_b32_e64 v5, 16, v93
    v_and_b32 v6, 0xffff0000, v93
    v_add_f32 v132, v132, v5
    v_add_f32 v133, v133, v6
    v_lshlrev_b32_e64 v5, 16, v94
    v_and_b32 v6, 0xffff0000, v94
    v_add_f32 v134, v134, v5
    v_add_f32 v135, v135, v6
    v_lshlrev_b32_e64 v5, 16, v95
    v_and_b32 v6, 0xffff0000, v95
    v_add_f32 v136, v136, v5
    v_add_f32 v137, v137, v6
    s_waitcnt vmcnt(5)
    v_lshlrev_b32 v5, 16, v96
    v_and_b32 v6, 0xffff0000, v96
    v_add_f32 v130, v130, v5
    v_add_f32 v131, v131, v6
    v_lshlrev_b32_e64 v5, 16, v97
    v_and_b32 v6, 0xffff0000, v97
    v_add_f32 v132, v132, v5
    v_add_f32 v133, v133, v6
    v_lshlrev_b32_e64 v5, 16, v98
    v_and_b32 v6, 0xffff0000, v98
    v_add_f32 v134, v134, v5
    v_add_f32 v135, v135, v6
    v_lshlrev_b32_e64 v5, 16, v99
    v_and_b32 v6, 0xffff0000, v99
    v_add_f32 v136, v136, v5
    v_add_f32 v137, v137, v6
    s_waitcnt vmcnt(4)
    v_lshlrev_b32 v5, 16, v100
    v_and_b32 v6, 0xffff0000, v100
    v_add_f32 v130, v130, v5
    v_add_f32 v131, v131, v6
    v_lshlrev_b32_e64 v5, 16, v101
    v_and_b32 v6, 0xffff0000, v101
    v_add_f32 v132, v132, v5
    v_add_f32 v133, v133, v6
    v_lshlrev_b32_e64 v5, 16, v102
    v_and_b32 v6, 0xffff0000, v102
    v_add_f32 v134, v134, v5
    v_add_f32 v135, v135, v6
    v_lshlrev_b32_e64 v5, 16, v103
    v_and_b32 v6, 0xffff0000, v103
    v_add_f32 v136, v136, v5
    v_add_f32 v137, v137, v6
    s_waitcnt vmcnt(3)
    v_lshlrev_b32 v5, 16, v104
    v_and_b32 v6, 0xffff0000, v104
    v_add_f32 v130, v130, v5
    v_add_f32 v131, v131, v6
    v_lshlrev_b32_e64 v5, 16, v105
    v_and_b32 v6, 0xffff0000, v105
    v_add_f32 v132, v132, v5
    v_add_f32 v133, v133, v6
    v_lshlrev_b32_e64 v5, 16, v106
    v_and_b32 v6, 0xffff0000, v106
    v_add_f32 v134, v134, v5
    v_add_f32 v135, v135, v6
    v_lshlrev_b32_e64 v5, 16, v107
    v_and_b32 v6, 0xffff0000, v107
    v_add_f32 v136, v136, v5
    v_add_f32 v137, v137, v6
    s_waitcnt vmcnt(2)
    v_lshlrev_b32 v5, 16, v108
    v_and_b32 v6, 0xffff0000, v108
    v_add_f32 v130, v130, v5
    v_add_f32 v131, v131, v6
    v_lshlrev_b32_e64 v5, 16, v109
    v_and_b32 v6, 0xffff0000, v109
    v_add_f32 v132, v132, v5
    v_add_f32 v133, v133, v6
    v_lshlrev_b32_e64 v5, 16, v110
    v_and_b32 v6, 0xffff0000, v110
    v_add_f32 v134, v134, v5
    v_add_f32 v135, v135, v6
    v_lshlrev_b32_e64 v5, 16, v111
    v_and_b32 v6, 0xffff0000, v111
    v_add_f32 v136, v136, v5
    v_add_f32 v137, v137, v6
    s_waitcnt vmcnt(1)
    v_lshlrev_b32 v5, 16, v112
    v_and_b32 v6, 0xffff0000, v112
    v_add_f32 v130, v130, v5
    v_add_f32 v131, v131, v6
    v_lshlrev_b32_e64 v5, 16, v113
    v_and_b32 v6, 0xffff0000, v113
    v_add_f32 v132, v132, v5
    v_add_f32 v133, v133, v6
    v_lshlrev_b32_e64 v5, 16, v114
    v_and_b32 v6, 0xffff0000, v114
    v_add_f32 v134, v134, v5
    v_add_f32 v135, v135, v6
    v_lshlrev_b32_e64 v5, 16, v115
    v_and_b32 v6, 0xffff0000, v115
    v_add_f32 v136, v136, v5
    v_add_f32 v137, v137, v6
    s_waitcnt vmcnt(0)
    v_lshlrev_b32 v5, 16, v116
    v_and_b32 v6, 0xffff0000, v116
    v_add_f32 v130, v130, v5
    v_add_f32 v131, v131, v6
    v_lshlrev_b32_e64 v5, 16, v117
    v_and_b32 v6, 0xffff0000, v117
    v_add_f32 v132, v132, v5
    v_add_f32 v133, v133, v6
    v_lshlrev_b32_e64 v5, 16, v118
    v_and_b32 v6, 0xffff0000, v118
    v_add_f32 v134, v134, v5
    v_add_f32 v135, v135, v6
    v_lshlrev_b32_e64 v5, 16, v119
    v_and_b32 v6, 0xffff0000, v119
    v_add_f32 v136, v136, v5
    v_add_f32_e64 v137, v137, v6
    s_lshl_b32 s48, s36, 11
    v_lshl_add_u32 v1, v0, 5, s48
    ds_write_b128 v1, v[130:133]
    ds_write_b128 v1, v[134:137] offset:16
    s_waitcnt vmcnt(0) lgkmcnt(0)
    s_barrier
    s_cmp_lg_u32 s36, 0
    s_cbranch_scc1 L_end
    v_lshlrev_b32_e64 v1, 2, v0
    ds_read_b32 v40, v1 offset:0
    ds_read_b32 v41, v1 offset:256
    ds_read_b32 v42, v1 offset:512
    ds_read_b32 v43, v1 offset:768
    ds_read_b32 v44, v1 offset:1024
    ds_read_b32 v45, v1 offset:1280
    ds_read_b32 v46, v1 offset:1536
    ds_read_b32 v47, v1 offset:1792
    s_waitcnt lgkmcnt(0)
    s_nop 0
    ds_read_b32 v48, v1 offset:2048
    ds_read_b32 v49, v1 offset:2304
    ds_read_b32 v50, v1 offset:2560
    ds_read_b32 v51, v1 offset:2816
    ds_read_b32 v52, v1 offset:3072
    ds_read_b32 v53, v1 offset:3328
    ds_read_b32 v54, v1 offset:3584
    ds_read_b32 v55, v1 offset:3840
    s_waitcnt lgkmcnt(0)
    s_nop 0
    ds_read_b32 v56, v1 offset:4096
    ds_read_b32 v57, v1 offset:4352
    ds_read_b32 v58, v1 offset:4608
    ds_read_b32 v59, v1 offset:4864
    ds_read_b32 v60, v1 offset:5120
    ds_read_b32 v61, v1 offset:5376
    ds_read_b32 v62, v1 offset:5632
    ds_read_b32 v63, v1 offset:5888
    s_waitcnt lgkmcnt(0)
    s_nop 0
    ds_read_b32 v64, v1 offset:6144
    ds_read_b32 v65, v1 offset:6400
    ds_read_b32 v66, v1 offset:6656
    ds_read_b32 v67, v1 offset:6912
    ds_read_b32 v68, v1 offset:7168
    ds_read_b32 v69, v1 offset:7424
    ds_read_b32 v70, v1 offset:7680
    ds_read_b32 v71, v1 offset:7936
    s_waitcnt lgkmcnt(0)
    v_add_f32 v40, v40, v41
    v_add_f32 v40, v40, v42
    v_add_f32 v40, v40, v43
    v_add_f32 v40, v40, v44
    v_add_f32 v40, v40, v45
    v_add_f32 v40, v40, v46
    v_add_f32 v40, v40, v47
    v_add_f32 v40, v40, v48
    v_add_f32 v40, v40, v49
    v_add_f32 v40, v40, v50
    v_add_f32 v40, v40, v51
    v_add_f32 v40, v40, v52
    v_add_f32 v40, v40, v53
    v_add_f32 v40, v40, v54
    v_add_f32 v40, v40, v55
    v_add_f32 v40, v40, v56
    v_add_f32 v40, v40, v57
    v_add_f32 v40, v40, v58
    v_add_f32 v40, v40, v59
    v_add_f32 v40, v40, v60
    v_add_f32 v40, v40, v61
    v_add_f32 v40, v40, v62
    v_add_f32 v40, v40, v63
    v_add_f32 v40, v40, v64
    v_add_f32 v40, v40, v65
    v_add_f32 v40, v40, v66
    v_add_f32 v40, v40, v67
    v_add_f32 v40, v40, v68
    v_add_f32 v40, v40, v69
    v_add_f32 v40, v40, v70
    v_add_f32_e64 v40, v40, v71
    s_lshl_b32 s48, s92, 8
    s_add_u32 s48, s48, 32768
    buffer_store_dword v40, v1, s[24:27], s48 offen sc1
    s_lshl_b32 s48, s92, 7
    s_add_u32 s48, s48, 21200896
    v_mov_b32 v1, s45
    s_waitcnt vmcnt(0)
    s_mov_b64 exec, 1
    buffer_store_dword v1, off, s[24:27], s48 sc1
L_end:
    s_endpgm
L_codeend:
.section .rodata,"a"
.p2align 6
.amdhsa_kernel recurrent_scan__ssm_conv_s4__mixer_s_mlp__prompt_kernel
  .amdhsa_next_free_vgpr 256
  .amdhsa_next_free_sgpr 96
  .amdhsa_accum_offset 256
  .amdhsa_group_segment_fixed_size 0
  .amdhsa_kernarg_size 136
  .amdhsa_user_sgpr_count 2
  .amdhsa_user_sgpr_kernarg_segment_ptr 1
  .amdhsa_system_sgpr_workgroup_id_x 1
.end_amdhsa_kernel
```
